```python
import torch

def _softmax(x, axis=-1):
    return torch.softmax(x, dim=axis)
def _gelu(x):
    return torch.nn.functional.gelu(x, approximate="tanh")
def _silu(x):
    return torch.nn.functional.silu(x)
def _sigmoid(x):
    return torch.sigmoid(x)
def _layernorm(x, axis=-1, eps=1e-5):
    m = x.mean(dim=axis, keepdim=True)
    v = x.var(dim=axis, keepdim=True, unbiased=False)
    return (x - m) / torch.sqrt(v + eps)
def _scatter_add(tgt, idx, src, axis=0):
    return tgt.clone().index_add_(axis, idx, src)
def _segment_sum(src, seg, n):
    out = torch.zeros((n,) + src.shape[1:], dtype=src.dtype)
    return out.index_add_(0, seg, src)
def _pad(x, pw):
    flat = tuple(v for pair in reversed(pw) for v in pair)
    return torch.nn.functional.pad(x, flat)

kernel_name = 'standalone__mha_block_cached__near_ridge'

def setup_inputs():

    _w = (lambda a: (lambda t: t.to(torch.bfloat16) if t.is_floating_point() else t)(torch.as_tensor(a)))
    B, Sq, D = 16, 144, 576
    H, Sk, Dh = 32, 512, 128
    return {
        "x": _w((lambda *s: torch.randn(*s, dtype=torch.bfloat16) * 0.8)(B, Sq, D)),
        "k_cache": _w((lambda *s: torch.randn(*s, dtype=torch.bfloat16) * 0.8)(B, H, Sk, Dh)),
        "v_cache": _w((lambda *s: torch.randn(*s, dtype=torch.bfloat16) * 0.05)(B, H, Sk, Dh)),
        "wq": _w((lambda *s: torch.randn(*s, dtype=torch.bfloat16) * 0.8)(D, H * Dh) * (D ** -0.5)),
        "wo": _w((lambda *s: torch.randn(*s, dtype=torch.bfloat16) * 0.05)(H * Dh, D) * ((H * Dh) ** -0.5)),
    }

def reference(x, k_cache, v_cache, wq, wo):
    B, Sq, D = x.shape
    H, Dh = 32, 128
    q = (lambda x, *d: x.permute(*d))((x @ wq).reshape(B, Sq, H, Dh), 0, 2, 1, 3)
    scores = torch.einsum("bhqd,bhkd->bhqk", q, k_cache) * (Dh ** -0.5)
    p = _softmax(scores, axis=-1)
    o = torch.einsum("bhqk,bhkd->bhqd", p, v_cache)
    return (lambda x, *d: x.permute(*d))(o, 0, 2, 1, 3).reshape(B, Sq, H * Dh) @ wo
```

```asm
; @launch grid=(256,1,1) block=(512,1,1) lds=163840
.amdgcn_target "amdgcn-amd-amdhsa--gfx950"
.text
.globl standalone__mha_block_cached__near_ridge_kernel
.p2align 8
.type standalone__mha_block_cached__near_ridge_kernel,@function
standalone__mha_block_cached__near_ridge_kernel:

    s_cmp_ge_u32 s2, 256
    s_cbranch_scc1 L_end
    s_load_dwordx4 s[84:87], s[0:1], 0
    s_load_dwordx4 s[88:91], s[0:1], 16
    s_load_dwordx4 s[92:95], s[0:1], 32
    s_load_dwordx4 s[96:99], s[0:1], 48
    v_lshrrev_b32 v1, 6, v0
    v_and_b32 v222, 63, v0
    s_getpc_b64 s[70:71]
L_pc0:
    s_lshr_b32 s72, s2, 3
    s_and_b32 s72, s72, 31
    v_lshlrev_b32 v2, 5, v222
    v_add_u32 v2, s72, v2
    v_lshlrev_b32 v2, 7, v2
    v_cmp_gt_u32 vcc, L_end-L_pc0, v2
    v_cmp_gt_u32 s[72:73], 64, v0
    s_nop 1
    s_and_b64 vcc, vcc, s[72:73]
    s_and_saveexec_b64 s[72:73], vcc
    s_cbranch_execz L_pc1
    global_load_dword v255, v2, s[70:71]
L_pc1:
    s_mov_b64 exec, s[72:73]
    s_and_b32 s47, s2, 7
    v_readfirstlane_b32 s3, v1
    s_lshr_b32 s48, s2, 3
    s_and_b32 s4, s47, 1
    s_lshl_b32 s4, s4, 3
    s_lshr_b32 s49, s48, 2
    s_add_u32 s4, s4, s49
    s_and_b32 s5, s48, 3
    s_lshr_b32 s6, s47, 1
    s_lshl_b32 s7, s6, 3
    s_lshl_b32 s49, s5, 1
    s_add_u32 s7, s7, s49
    s_and_b32 s46, s3, 3
    s_waitcnt lgkmcnt(0)
    s_mul_i32 s47, s4, 165888
    s_add_u32 s8, s84, s47
    s_addc_u32 s9, s85, 0
    s_mov_b32 s10, 165888
    s_mov_b32 s11, 0x20000
    s_mov_b32 s12, s90
    s_mov_b32 s13, s91
    s_mov_b32 s14, 4718592
    s_mov_b32 s15, 0x20000

    v_mov_b32 v216, v222
    v_lshrrev_b32 v72, 4, v216
    v_and_b32 v73, 1, v72
    v_lshlrev_b32 v73, 1, v73
    v_lshrrev_b32 v74, 1, v72
    v_mul_u32_u24 v74, 3, v74
    v_xor_b32 v73, v73, v74
    v_and_b32 v74, 3, v216
    v_xor_b32 v73, v73, v74
    v_lshrrev_b32 v74, 2, v216
    v_mul_u32_u24 v74, 1152, v74
    v_lshl_add_u32 v74, v73, 4, v74
    s_mul_i32 s47, s46, 18432
    v_add_u32 v223, s47, v74
    v_add_u32 v80, 73728, v223
    v_add_u32 v224, 147456, v74
    v_and_b32 v73, 15, v216
    v_lshlrev_b32 v74, 2, v72
    v_xor_b32 v73, v73, v74
    s_and_b32 s47, s46, 2
    v_xor_b32 v73, s47, v73
    s_lshl_b32 s47, s46, 2
    v_add_u32 v72, s47, v72
    v_lshlrev_b32 v72, 13, v72
    v_lshl_add_u32 v225, v73, 4, v72
    v_add_u32 v81, 131072, v225
    s_lshl_b32 s54, s7, 8
    s_lshl_b32 s63, s46, 10

    s_cmp_ge_u32 s3, 4
    s_cbranch_scc1 L_hw_1
    v_mul_u32_u24 v76, 43, v216
    v_lshrrev_b32 v76, 7, v76
    v_mul_u32_u24 v77, 3, v76
    v_sub_u32 v77, v216, v77
    s_mul_i32 s47, s5, 36
    s_mul_i32 s48, s46, 9
    s_add_u32 s47, s47, s48
    v_add_u32 v76, s47, v76
    v_mul_u32_u24 v76, 1152, v76
    v_lshl_add_u32 v76, v77, 7, v76
    s_mov_b64 exec, 0x7ffffff
    buffer_load_dword v255, v76, s[8:11], 0 offen offset:0

    s_branch L_hwe_2

L_hw_1:

    s_mul_i32 s47, s46, 24
    v_add_u32 v76, s47, v216
    v_lshrrev_b32 v77, 4, v76
    v_add_u32 v77, 0, v77
    v_lshlrev_b32 v77, 5, v77
    s_lshr_b32 s47, s2, 3
    v_add_u32 v77, s47, v77
    v_lshlrev_b32 v77, 13, v77
    v_and_b32 v76, 15, v76
    v_lshl_add_u32 v76, v76, 7, v77
    s_lshl_b32 s47, s6, 11
    s_mov_b64 exec, 0xffffff
    buffer_load_dword v255, v76, s[12:15], s47 offen

L_hwe_2:
    s_mov_b64 exec, -1
    s_cmp_ge_u32 s3, 4
    s_cbranch_scc1 L_ao_3
    s_add_u32 m0, s63, 61440
    s_nop 0
    buffer_load_dwordx4 v223, s[8:11], 0 offen offset:0 lds
    s_add_u32 m0, s63, 65536
    s_nop 0
    buffer_load_dwordx4 v80, s[8:11], 0 offen offset:0 lds
    s_add_u32 m0, s63, 70656
    s_nop 0
    buffer_load_dwordx4 v225, s[12:15], s54 offen lds
    s_add_u32 m0, s63, 74752
    s_nop 0
    buffer_load_dwordx4 v81, s[12:15], s54 offen lds
    s_add_u32 m0, s63, 78592
    s_nop 0
    buffer_load_dwordx4 v225, s[12:15], s54 offen offset:256 lds
    s_add_u32 m0, s63, 82688
    s_nop 0
    buffer_load_dwordx4 v81, s[12:15], s54 offen offset:256 lds
    s_add_u32 s54, s54, 262144
    s_mov_b32 m0, 69632
    s_cmp_eq_u32 s46, 0
    s_cselect_b64 exec, -1, 0
    buffer_load_dwordx4 v224, s[8:11], 0 offen offset:0 lds
    s_mov_b64 exec, -1
    s_add_u32 m0, s63, 86976
    s_nop 0
    buffer_load_dwordx4 v223, s[8:11], 0 offen offset:64 lds
    s_add_u32 m0, s63, 91072
    s_nop 0
    buffer_load_dwordx4 v80, s[8:11], 0 offen offset:64 lds
    s_add_u32 m0, s63, 96256
    s_nop 0
    buffer_load_dwordx4 v225, s[12:15], s54 offen lds
    s_add_u32 m0, s63, 100352
    s_nop 0
    buffer_load_dwordx4 v81, s[12:15], s54 offen lds
    s_add_u32 m0, s63, 104192
    s_nop 0
    buffer_load_dwordx4 v225, s[12:15], s54 offen offset:256 lds
    s_add_u32 m0, s63, 108288
    s_nop 0
    buffer_load_dwordx4 v81, s[12:15], s54 offen offset:256 lds
    s_add_u32 s54, s54, 262144
    s_mov_b32 m0, 95168
    s_cmp_eq_u32 s46, 1
    s_cselect_b64 exec, -1, 0
    buffer_load_dwordx4 v224, s[8:11], 0 offen offset:64 lds
    s_mov_b64 exec, -1
L_ao_3:

    s_lshl_b32 s47, s4, 5
    s_add_u32 s47, s47, s7
    s_lshl_b32 s47, s47, 17
    s_add_u32 s16, s86, s47
    s_addc_u32 s17, s87, 0
    s_mov_b32 s18, 262144
    s_mov_b32 s19, 0x20000
    s_add_u32 s20, s88, s47
    s_addc_u32 s21, s89, 0
    s_mov_b32 s22, 262144
    s_mov_b32 s23, 0x20000
    s_mov_b32 s24, s92
    s_mov_b32 s25, s93
    s_mov_b32 s26, 4718592
    s_mov_b32 s27, 0x20000
    s_mov_b32 s36, s94
    s_mov_b32 s37, s95
    s_mov_b32 s38, 2654208
    s_mov_b32 s39, 0x20000
    s_mov_b32 s42, s96
    s_mov_b32 s43, s97
    s_mov_b32 s40, s98
    s_mov_b32 s41, s99
    s_mov_b32 s28, s98
    s_mov_b32 s29, s99
    s_mov_b32 s30, 18874368
    s_mov_b32 s31, 0x20000
    s_add_u32 s32, s98, 20971520
    s_addc_u32 s33, s99, 0
    s_mov_b32 s34, 10616832
    s_mov_b32 s35, 0x20000

    s_cmp_ge_u32 s3, 4
    s_cselect_b32 s60, 8192, 0
    s_add_u32 s60, s60, 70656
    v_bfe_u32 v72, v216, 2, 2
    v_and_b32 v73, 1, v72
    v_lshlrev_b32 v73, 1, v73
    v_lshrrev_b32 v74, 1, v72
    v_mul_u32_u24 v74, 3, v74
    v_xor_b32 v73, v73, v74
    v_lshrrev_b32 v74, 4, v216
    v_xor_b32 v74, v74, v73
    v_and_b32 v75, 15, v216
    v_lshlrev_b32 v75, 6, v75
    v_lshl_add_u32 v217, v74, 4, v75
    v_add_u32 v217, 61440, v217
    v_add_u32 v220, 51200, v217
    v_lshrrev_b32 v72, 4, v216
    v_bfe_u32 v73, v216, 2, 2
    v_lshl_add_u32 v74, v72, 3, v73
    v_lshlrev_b32 v74, 8, v74
    v_xor_b32 v73, s46, v73
    v_lshl_add_u32 v74, v73, 6, v74
    v_and_b32 v72, 1, v72
    v_lshl_add_u32 v74, v72, 5, v74
    v_bfe_u32 v73, v216, 1, 1
    v_lshl_add_u32 v74, v73, 4, v74
    v_and_b32 v73, 1, v216
    v_lshl_add_u32 v74, v73, 3, v74
    v_add_u32 v218, s60, v74
    v_xor_b32 v74, 32, v74
    v_add_u32 v219, s60, v74
    v_add_u32 v221, 51200, v218
    v_add_u32 v222, 51200, v219

    s_cmp_ge_u32 s3, 4
    s_cbranch_scc1 L_ao_4
    s_add_u32 m0, s63, 112512
    s_nop 0
    buffer_load_dwordx4 v223, s[8:11], 0 offen offset:128 lds
    s_add_u32 m0, s63, 116608
    s_nop 0
    buffer_load_dwordx4 v80, s[8:11], 0 offen offset:128 lds
    s_add_u32 m0, s63, 121856
    s_nop 0
    buffer_load_dwordx4 v225, s[12:15], s54 offen lds
    s_add_u32 m0, s63, 125952
    s_nop 0
    buffer_load_dwordx4 v81, s[12:15], s54 offen lds
    s_add_u32 m0, s63, 129792
    s_nop 0
    buffer_load_dwordx4 v225, s[12:15], s54 offen offset:256 lds
    s_add_u32 m0, s63, 133888
    s_nop 0
    buffer_load_dwordx4 v81, s[12:15], s54 offen offset:256 lds
    s_add_u32 s54, s54, 262144
    s_mov_b32 m0, 120704
    s_cmp_eq_u32 s46, 2
    s_cselect_b64 exec, -1, 0
    buffer_load_dwordx4 v224, s[8:11], 0 offen offset:128 lds
    s_mov_b64 exec, -1
L_ao_4:
    v_mov_b32 v236, 0
    v_mov_b32 v237, 0
    v_mov_b32 v254, 0

    s_cmp_lg_u32 s2, 0
    s_cbranch_scc1 L_nw_5
    s_cmp_lg_u32 s3, 4
    s_cbranch_scc1 L_nw_5
    s_memrealtime s[68:69]
    s_waitcnt lgkmcnt(0)
    s_or_b32 s68, s68, 1
    v_mov_b32 v82, s68
    v_mov_b32 v83, s69
    v_mov_b32 v75, 0
    global_store_dwordx2 v75, v[82:83], s[42:43] sc1

L_nw_5:
    s_waitcnt vmcnt(12)
L_head_b:
    s_barrier
    ds_read_b64_tr_b16 v[120:121], v218 offset:0
    ds_read_b64_tr_b16 v[122:123], v218 offset:1024
    ds_read_b64_tr_b16 v[124:125], v219 offset:0
    ds_read_b64_tr_b16 v[126:127], v219 offset:1024
    ds_read_b128 v[84:87], v217 offset:0
    ds_read_b128 v[88:91], v217 offset:1024
    ds_read_b128 v[92:95], v217 offset:2048
    ds_read_b128 v[96:99], v217 offset:3072
    ds_read_b128 v[100:103], v217 offset:4096
    ds_read_b128 v[104:107], v217 offset:5120
    ds_read_b128 v[108:111], v217 offset:6144
    ds_read_b128 v[112:115], v217 offset:7168
    ds_read_b128 v[116:119], v217 offset:8192
    s_cmp_ge_u32 s3, 4
    s_cbranch_scc1 L_ao_6
    s_add_u32 m0, s63, 138048
    s_nop 0
    buffer_load_dwordx4 v223, s[8:11], 0 offen offset:192 lds
    s_add_u32 m0, s63, 142144
    s_nop 0
    buffer_load_dwordx4 v80, s[8:11], 0 offen offset:192 lds
    s_add_u32 m0, s63, 147456
    s_nop 0
    buffer_load_dwordx4 v225, s[12:15], s54 offen lds
    s_add_u32 m0, s63, 151552
    s_nop 0
    buffer_load_dwordx4 v81, s[12:15], s54 offen lds
    s_add_u32 m0, s63, 155392
    s_nop 0
    buffer_load_dwordx4 v225, s[12:15], s54 offen offset:256 lds
    s_add_u32 m0, s63, 159488
    s_nop 0
    buffer_load_dwordx4 v81, s[12:15], s54 offen offset:256 lds
    s_add_u32 s54, s54, 262144
    s_mov_b32 m0, 146240
    s_cmp_eq_u32 s46, 3
    s_cselect_b64 exec, -1, 0
    buffer_load_dwordx4 v224, s[8:11], 0 offen offset:192 lds
    s_mov_b64 exec, -1
    s_waitcnt vmcnt(12)
L_ao_6:

    s_cmp_ge_u32 s3, 4
    s_cbranch_scc1 L_hw_7
    v_mul_u32_u24 v76, 43, v216
    v_lshrrev_b32 v76, 7, v76
    v_mul_u32_u24 v77, 3, v76
    v_sub_u32 v77, v216, v77
    s_mul_i32 s47, s5, 36
    s_mul_i32 s48, s46, 9
    s_add_u32 s47, s47, s48
    v_add_u32 v76, s47, v76
    v_mul_u32_u24 v76, 1152, v76
    v_lshl_add_u32 v76, v77, 7, v76
    s_mov_b64 exec, 0x7ffffff
    buffer_load_dword v255, v76, s[8:11], 0 offen offset:384

    s_branch L_hwe_8

L_hw_7:

    s_mul_i32 s47, s46, 24
    v_add_u32 v76, s47, v216
    v_lshrrev_b32 v77, 4, v76
    v_add_u32 v77, 6, v77
    v_lshlrev_b32 v77, 5, v77
    s_lshr_b32 s47, s2, 3
    v_add_u32 v77, s47, v77
    v_lshlrev_b32 v77, 13, v77
    v_and_b32 v76, 15, v76
    v_lshl_add_u32 v76, v76, 7, v77
    s_lshl_b32 s47, s6, 11
    s_mov_b64 exec, 0xffffff
    buffer_load_dword v255, v76, s[12:15], s47 offen

L_hwe_8:
    s_mov_b64 exec, -1
    s_waitcnt lgkmcnt(0)
    s_barrier
    v_mfma_f32_16x16x32_bf16 v[0:3], v[120:123], v[84:87], 0
    ds_read_b64_tr_b16 v[168:169], v218 offset:25600
    v_mfma_f32_16x16x32_bf16 v[36:39], v[124:127], v[84:87], 0
    ds_read_b64_tr_b16 v[170:171], v218 offset:26624
    v_mfma_f32_16x16x32_bf16 v[4:7], v[120:123], v[88:91], 0
    ds_read_b64_tr_b16 v[172:173], v219 offset:25600
    v_mfma_f32_16x16x32_bf16 v[40:43], v[124:127], v[88:91], 0
    ds_read_b64_tr_b16 v[174:175], v219 offset:26624
    v_mfma_f32_16x16x32_bf16 v[8:11], v[120:123], v[92:95], 0
    ds_read_b128 v[132:135], v217 offset:25600
    v_mfma_f32_16x16x32_bf16 v[44:47], v[124:127], v[92:95], 0
    ds_read_b128 v[136:139], v217 offset:26624
    v_mfma_f32_16x16x32_bf16 v[12:15], v[120:123], v[96:99], 0
    ds_read_b128 v[140:143], v217 offset:27648
    v_mfma_f32_16x16x32_bf16 v[48:51], v[124:127], v[96:99], 0
    ds_read_b128 v[144:147], v217 offset:28672
    v_mfma_f32_16x16x32_bf16 v[16:19], v[120:123], v[100:103], 0
    ds_read_b128 v[148:151], v217 offset:29696
    v_mfma_f32_16x16x32_bf16 v[52:55], v[124:127], v[100:103], 0
    ds_read_b128 v[152:155], v217 offset:30720
    v_mfma_f32_16x16x32_bf16 v[20:23], v[120:123], v[104:107], 0
    ds_read_b128 v[156:159], v217 offset:31744
    v_mfma_f32_16x16x32_bf16 v[56:59], v[124:127], v[104:107], 0
    ds_read_b128 v[160:163], v217 offset:32768
    v_mfma_f32_16x16x32_bf16 v[24:27], v[120:123], v[108:111], 0
    ds_read_b128 v[164:167], v217 offset:33792
    v_mfma_f32_16x16x32_bf16 v[60:63], v[124:127], v[108:111], 0
    v_mfma_f32_16x16x32_bf16 v[28:31], v[120:123], v[112:115], 0
    v_mfma_f32_16x16x32_bf16 v[64:67], v[124:127], v[112:115], 0
    v_mfma_f32_16x16x32_bf16 v[32:35], v[120:123], v[116:119], 0
    v_mfma_f32_16x16x32_bf16 v[68:71], v[124:127], v[116:119], 0
    s_cmp_ge_u32 s3, 4
    s_cbranch_scc1 L_ao_9
    s_add_u32 m0, s63, 61184
    s_nop 0
    buffer_load_dwordx4 v223, s[8:11], 0 offen offset:256 lds
    s_add_u32 m0, s63, 65280
    s_nop 0
    buffer_load_dwordx4 v80, s[8:11], 0 offen offset:256 lds
    s_add_u32 m0, s63, 70656
    s_nop 0
    buffer_load_dwordx4 v225, s[12:15], s54 offen lds
    s_add_u32 m0, s63, 74752
    s_nop 0
    buffer_load_dwordx4 v81, s[12:15], s54 offen lds
    s_add_u32 m0, s63, 78592
    s_nop 0
    buffer_load_dwordx4 v225, s[12:15], s54 offen offset:256 lds
    s_add_u32 m0, s63, 82688
    s_nop 0
    buffer_load_dwordx4 v81, s[12:15], s54 offen offset:256 lds
    s_add_u32 s54, s54, 262144
    s_mov_b32 m0, 69376
    s_cmp_eq_u32 s46, 0
    s_cselect_b64 exec, -1, 0
    buffer_load_dwordx4 v224, s[8:11], 0 offen offset:256 lds
    s_mov_b64 exec, -1
    s_waitcnt vmcnt(12)
L_ao_9:
    s_waitcnt lgkmcnt(0)
    s_barrier
    v_mfma_f32_16x16x32_bf16 v[0:3], v[168:171], v[132:135], v[0:3]
    ds_read_b64_tr_b16 v[120:121], v221 offset:0
    v_mfma_f32_16x16x32_bf16 v[36:39], v[172:175], v[132:135], v[36:39]
    ds_read_b64_tr_b16 v[122:123], v221 offset:1024
    v_mfma_f32_16x16x32_bf16 v[4:7], v[168:171], v[136:139], v[4:7]
    ds_read_b64_tr_b16 v[124:125], v222 offset:0
    v_mfma_f32_16x16x32_bf16 v[40:43], v[172:175], v[136:139], v[40:43]
    ds_read_b64_tr_b16 v[126:127], v222 offset:1024
    v_mfma_f32_16x16x32_bf16 v[8:11], v[168:171], v[140:143], v[8:11]
    ds_read_b128 v[84:87], v220 offset:0
    v_mfma_f32_16x16x32_bf16 v[44:47], v[172:175], v[140:143], v[44:47]
    ds_read_b128 v[88:91], v220 offset:1024
    v_mfma_f32_16x16x32_bf16 v[12:15], v[168:171], v[144:147], v[12:15]
    ds_read_b128 v[92:95], v220 offset:2048
    v_mfma_f32_16x16x32_bf16 v[48:51], v[172:175], v[144:147], v[48:51]
    ds_read_b128 v[96:99], v220 offset:3072
    v_mfma_f32_16x16x32_bf16 v[16:19], v[168:171], v[148:151], v[16:19]
    ds_read_b128 v[100:103], v220 offset:4096
    v_mfma_f32_16x16x32_bf16 v[52:55], v[172:175], v[148:151], v[52:55]
    ds_read_b128 v[104:107], v220 offset:5120
    v_mfma_f32_16x16x32_bf16 v[20:23], v[168:171], v[152:155], v[20:23]
    ds_read_b128 v[108:111], v220 offset:6144
    v_mfma_f32_16x16x32_bf16 v[56:59], v[172:175], v[152:155], v[56:59]
    ds_read_b128 v[112:115], v220 offset:7168
    v_mfma_f32_16x16x32_bf16 v[24:27], v[168:171], v[156:159], v[24:27]
    ds_read_b128 v[116:119], v220 offset:8192
    v_mfma_f32_16x16x32_bf16 v[60:63], v[172:175], v[156:159], v[60:63]
    v_mfma_f32_16x16x32_bf16 v[28:31], v[168:171], v[160:163], v[28:31]
    v_mfma_f32_16x16x32_bf16 v[64:67], v[172:175], v[160:163], v[64:67]
    v_mfma_f32_16x16x32_bf16 v[32:35], v[168:171], v[164:167], v[32:35]
    v_mfma_f32_16x16x32_bf16 v[68:71], v[172:175], v[164:167], v[68:71]
    s_cmp_ge_u32 s3, 4
    s_cbranch_scc1 L_ao_10
    s_add_u32 m0, s63, 86720
    s_nop 0
    buffer_load_dwordx4 v223, s[8:11], 0 offen offset:320 lds
    s_add_u32 m0, s63, 90816
    s_nop 0
    buffer_load_dwordx4 v80, s[8:11], 0 offen offset:320 lds
    s_add_u32 m0, s63, 96256
    s_nop 0
    buffer_load_dwordx4 v225, s[12:15], s54 offen lds
    s_add_u32 m0, s63, 100352
    s_nop 0
    buffer_load_dwordx4 v81, s[12:15], s54 offen lds
    s_add_u32 m0, s63, 104192
    s_nop 0
    buffer_load_dwordx4 v225, s[12:15], s54 offen offset:256 lds
    s_add_u32 m0, s63, 108288
    s_nop 0
    buffer_load_dwordx4 v81, s[12:15], s54 offen offset:256 lds
    s_add_u32 s54, s54, 262144
    s_mov_b32 m0, 94912
    s_cmp_eq_u32 s46, 1
    s_cselect_b64 exec, -1, 0
    buffer_load_dwordx4 v224, s[8:11], 0 offen offset:320 lds
    s_mov_b64 exec, -1
    s_waitcnt vmcnt(12)
L_ao_10:
    s_waitcnt lgkmcnt(0)
    s_barrier
    v_mfma_f32_16x16x32_bf16 v[0:3], v[120:123], v[84:87], v[0:3]
    ds_read_b64_tr_b16 v[168:169], v221 offset:25600
    v_mfma_f32_16x16x32_bf16 v[36:39], v[124:127], v[84:87], v[36:39]
    ds_read_b64_tr_b16 v[170:171], v221 offset:26624
    v_mfma_f32_16x16x32_bf16 v[4:7], v[120:123], v[88:91], v[4:7]
    ds_read_b64_tr_b16 v[172:173], v222 offset:25600
    v_mfma_f32_16x16x32_bf16 v[40:43], v[124:127], v[88:91], v[40:43]
    ds_read_b64_tr_b16 v[174:175], v222 offset:26624
    v_mfma_f32_16x16x32_bf16 v[8:11], v[120:123], v[92:95], v[8:11]
    ds_read_b128 v[132:135], v220 offset:25600
    v_mfma_f32_16x16x32_bf16 v[44:47], v[124:127], v[92:95], v[44:47]
    ds_read_b128 v[136:139], v220 offset:26624
    v_mfma_f32_16x16x32_bf16 v[12:15], v[120:123], v[96:99], v[12:15]
    ds_read_b128 v[140:143], v220 offset:27648
    v_mfma_f32_16x16x32_bf16 v[48:51], v[124:127], v[96:99], v[48:51]
    ds_read_b128 v[144:147], v220 offset:28672
    v_mfma_f32_16x16x32_bf16 v[16:19], v[120:123], v[100:103], v[16:19]
    ds_read_b128 v[148:151], v220 offset:29696
    v_mfma_f32_16x16x32_bf16 v[52:55], v[124:127], v[100:103], v[52:55]
    ds_read_b128 v[152:155], v220 offset:30720
    v_mfma_f32_16x16x32_bf16 v[20:23], v[120:123], v[104:107], v[20:23]
    ds_read_b128 v[156:159], v220 offset:31744
    v_mfma_f32_16x16x32_bf16 v[56:59], v[124:127], v[104:107], v[56:59]
    ds_read_b128 v[160:163], v220 offset:32768
    v_mfma_f32_16x16x32_bf16 v[24:27], v[120:123], v[108:111], v[24:27]
    ds_read_b128 v[164:167], v220 offset:33792
    v_mfma_f32_16x16x32_bf16 v[60:63], v[124:127], v[108:111], v[60:63]
    v_mfma_f32_16x16x32_bf16 v[28:31], v[120:123], v[112:115], v[28:31]
    v_mfma_f32_16x16x32_bf16 v[64:67], v[124:127], v[112:115], v[64:67]
    v_mfma_f32_16x16x32_bf16 v[32:35], v[120:123], v[116:119], v[32:35]
    v_mfma_f32_16x16x32_bf16 v[68:71], v[124:127], v[116:119], v[68:71]
    s_cmp_ge_u32 s3, 4
    s_cbranch_scc1 L_ao_11
    s_add_u32 m0, s63, 112256
    s_nop 0
    buffer_load_dwordx4 v223, s[8:11], 0 offen offset:384 lds
    s_add_u32 m0, s63, 116352
    s_nop 0
    buffer_load_dwordx4 v80, s[8:11], 0 offen offset:384 lds
    s_add_u32 m0, s63, 121856
    s_nop 0
    buffer_load_dwordx4 v225, s[12:15], s54 offen lds
    s_add_u32 m0, s63, 125952
    s_nop 0
    buffer_load_dwordx4 v81, s[12:15], s54 offen lds
    s_add_u32 m0, s63, 129792
    s_nop 0
    buffer_load_dwordx4 v225, s[12:15], s54 offen offset:256 lds
    s_add_u32 m0, s63, 133888
    s_nop 0
    buffer_load_dwordx4 v81, s[12:15], s54 offen offset:256 lds
    s_add_u32 s54, s54, 262144
    s_mov_b32 m0, 120448
    s_cmp_eq_u32 s46, 2
    s_cselect_b64 exec, -1, 0
    buffer_load_dwordx4 v224, s[8:11], 0 offen offset:384 lds
    s_mov_b64 exec, -1
    v_mov_b32 v238, v216

    v_lshrrev_b32 v243, 4, v238
    v_and_b32 v244, 15, v238
    v_xor_b32 v245, v244, v243
    v_lshlrev_b32 v245, 4, v245
    v_lshl_add_u32 v254, v243, 8, v245
    s_lshl_b32 s47, s46, 11
    v_add_u32 v254, s47, v254
    v_add_u32 v236, 8192, v254
    v_and_b32 v245, 1, v243
    v_lshlrev_b32 v245, 1, v245
    v_xor_b32 v245, v244, v245
    v_lshlrev_b32 v245, 4, v245
    v_lshl_add_u32 v237, v243, 10, v245
    s_lshr_b32 s47, s46, 1
    s_lshl_b32 s47, s47, 4
    s_and_b32 s48, s46, 1
    s_lshl_b32 s48, s48, 1
    s_add_u32 s47, s47, s48
    s_lshl_b32 s47, s47, 8
    v_add_u32 v237, s47, v237
    s_mul_i32 s96, s46, 2176
    s_lshr_b32 s47, s46, 1
    s_lshl_b32 s47, s47, 2
    s_add_u32 s47, s47, s48
    s_mul_i32 s97, s47, 1088
    s_add_u32 s97, s97, 8704

    v_and_b32 v243, 3, v238
    v_bfe_u32 v244, v238, 2, 3
    v_mul_u32_u24 v244, 1088, v244
    v_lshl_add_u32 v244, v243, 8, v244
    v_lshrrev_b32 v245, 5, v238
    v_xor_b32 v246, v245, v243
    v_lshl_add_u32 v230, v246, 4, v244
    v_add_u32 v245, 2, v245
    v_xor_b32 v246, v245, v243
    v_lshl_add_u32 v231, v246, 4, v244
    v_bfe_u32 v244, v238, 2, 2
    v_mul_u32_u24 v244, 1088, v244
    v_lshl_add_u32 v244, v243, 8, v244
    v_lshrrev_b32 v245, 4, v238
    v_xor_b32 v246, v245, v243
    v_lshl_add_u32 v232, v246, 4, v244
    s_and_b32 s47, s46, 1
    s_mul_i32 s47, s47, 4352
    v_add_u32 v232, s47, v232
    v_bfe_u32 v244, v238, 2, 2
    v_mul_u32_u24 v244, 1088, v244
    v_add_u32 v244, 8704, v244
    v_lshrrev_b32 v245, 5, v238
    v_lshl_add_u32 v233, v245, 8, v244
    v_lshlrev_b32 v245, 1, v245
    v_xor_b32 v245, v245, v243
    v_lshl_add_u32 v233, v245, 4, v233
    v_bfe_u32 v245, v238, 4, 1
    v_lshl_add_u32 v233, v245, 3, v233
    v_lshrrev_b32 v245, 4, v238
    v_lshl_add_u32 v234, v245, 8, v244
    s_lshl_b32 s47, s46, 6
    v_add_u32 v234, s47, v234
    v_bfe_u32 v246, v238, 1, 1
    v_lshl_add_u32 v234, v246, 4, v234
    v_and_b32 v246, 1, v238
    v_lshl_add_u32 v234, v246, 3, v234
    v_and_b32 v245, 1, v245
    v_lshlrev_b32 v245, 5, v245
    v_sub_u32 v235, v234, v245
    v_add_u32 v235, 32, v235
    v_add_u32 v234, v234, v245
    v_lshlrev_b32 v241, 4, v238
    v_add_u32 v241, 161792, v241
    s_and_b32 s47, s46, 1
    s_lshl_b32 s47, s47, 3
    v_add_u32 v242, s47, v241
    s_mov_b32 s89, 0

    s_waitcnt vmcnt(12)
L_ao_11:
    s_waitcnt lgkmcnt(0)
    s_barrier
    v_mfma_f32_16x16x32_bf16 v[0:3], v[168:171], v[132:135], v[0:3]
    ds_read_b64_tr_b16 v[120:121], v218 offset:0
    v_mfma_f32_16x16x32_bf16 v[36:39], v[172:175], v[132:135], v[36:39]
    ds_read_b64_tr_b16 v[122:123], v218 offset:1024
    v_mfma_f32_16x16x32_bf16 v[4:7], v[168:171], v[136:139], v[4:7]
    ds_read_b64_tr_b16 v[124:125], v219 offset:0
    v_mfma_f32_16x16x32_bf16 v[40:43], v[172:175], v[136:139], v[40:43]
    ds_read_b64_tr_b16 v[126:127], v219 offset:1024
    v_mfma_f32_16x16x32_bf16 v[8:11], v[168:171], v[140:143], v[8:11]
    ds_read_b128 v[84:87], v217 offset:0
    v_mfma_f32_16x16x32_bf16 v[44:47], v[172:175], v[140:143], v[44:47]
    ds_read_b128 v[88:91], v217 offset:1024
    v_mfma_f32_16x16x32_bf16 v[12:15], v[168:171], v[144:147], v[12:15]
    ds_read_b128 v[92:95], v217 offset:2048
    v_mfma_f32_16x16x32_bf16 v[48:51], v[172:175], v[144:147], v[48:51]
    ds_read_b128 v[96:99], v217 offset:3072
    v_mfma_f32_16x16x32_bf16 v[16:19], v[168:171], v[148:151], v[16:19]
    ds_read_b128 v[100:103], v217 offset:4096
    v_mfma_f32_16x16x32_bf16 v[52:55], v[172:175], v[148:151], v[52:55]
    ds_read_b128 v[104:107], v217 offset:5120
    v_mfma_f32_16x16x32_bf16 v[20:23], v[168:171], v[152:155], v[20:23]
    ds_read_b128 v[108:111], v217 offset:6144
    v_mfma_f32_16x16x32_bf16 v[56:59], v[172:175], v[152:155], v[56:59]
    ds_read_b128 v[112:115], v217 offset:7168
    v_mfma_f32_16x16x32_bf16 v[24:27], v[168:171], v[156:159], v[24:27]
    ds_read_b128 v[116:119], v217 offset:8192
    v_mfma_f32_16x16x32_bf16 v[60:63], v[172:175], v[156:159], v[60:63]
    v_mfma_f32_16x16x32_bf16 v[28:31], v[168:171], v[160:163], v[28:31]
    v_mfma_f32_16x16x32_bf16 v[64:67], v[172:175], v[160:163], v[64:67]
    v_mfma_f32_16x16x32_bf16 v[32:35], v[168:171], v[164:167], v[32:35]
    v_mfma_f32_16x16x32_bf16 v[68:71], v[172:175], v[164:167], v[68:71]
    s_cmp_ge_u32 s3, 4
    s_cbranch_scc1 L_ao_12
    s_add_u32 m0, s63, 137792
    s_nop 0
    buffer_load_dwordx4 v223, s[8:11], 0 offen offset:448 lds
    s_add_u32 m0, s63, 141888
    s_nop 0
    buffer_load_dwordx4 v80, s[8:11], 0 offen offset:448 lds
    s_add_u32 m0, s63, 147456
    s_nop 0
    buffer_load_dwordx4 v225, s[12:15], s54 offen lds
    s_add_u32 m0, s63, 151552
    s_nop 0
    buffer_load_dwordx4 v81, s[12:15], s54 offen lds
    s_add_u32 m0, s63, 155392
    s_nop 0
    buffer_load_dwordx4 v225, s[12:15], s54 offen offset:256 lds
    s_add_u32 m0, s63, 159488
    s_nop 0
    buffer_load_dwordx4 v81, s[12:15], s54 offen offset:256 lds
    s_add_u32 s54, s54, 262144
    s_mov_b32 m0, 145984
    s_cmp_eq_u32 s46, 3
    s_cselect_b64 exec, -1, 0
    buffer_load_dwordx4 v224, s[8:11], 0 offen offset:448 lds
    s_mov_b64 exec, -1
    s_waitcnt vmcnt(12)
L_ao_12:
    s_waitcnt lgkmcnt(0)
    s_barrier
    v_mfma_f32_16x16x32_bf16 v[0:3], v[120:123], v[84:87], v[0:3]
    ds_read_b64_tr_b16 v[168:169], v218 offset:25600
    v_mfma_f32_16x16x32_bf16 v[36:39], v[124:127], v[84:87], v[36:39]
    ds_read_b64_tr_b16 v[170:171], v218 offset:26624
    v_mfma_f32_16x16x32_bf16 v[4:7], v[120:123], v[88:91], v[4:7]
    ds_read_b64_tr_b16 v[172:173], v219 offset:25600
    v_mfma_f32_16x16x32_bf16 v[40:43], v[124:127], v[88:91], v[40:43]
    ds_read_b64_tr_b16 v[174:175], v219 offset:26624
    v_mfma_f32_16x16x32_bf16 v[8:11], v[120:123], v[92:95], v[8:11]
    ds_read_b128 v[132:135], v217 offset:25600
    v_mfma_f32_16x16x32_bf16 v[44:47], v[124:127], v[92:95], v[44:47]
    ds_read_b128 v[136:139], v217 offset:26624
    v_mfma_f32_16x16x32_bf16 v[12:15], v[120:123], v[96:99], v[12:15]
    ds_read_b128 v[140:143], v217 offset:27648
    v_mfma_f32_16x16x32_bf16 v[48:51], v[124:127], v[96:99], v[48:51]
    ds_read_b128 v[144:147], v217 offset:28672
    v_mfma_f32_16x16x32_bf16 v[16:19], v[120:123], v[100:103], v[16:19]
    ds_read_b128 v[148:151], v217 offset:29696
    v_mfma_f32_16x16x32_bf16 v[52:55], v[124:127], v[100:103], v[52:55]
    ds_read_b128 v[152:155], v217 offset:30720
    v_mfma_f32_16x16x32_bf16 v[20:23], v[120:123], v[104:107], v[20:23]
    ds_read_b128 v[156:159], v217 offset:31744
    v_mfma_f32_16x16x32_bf16 v[56:59], v[124:127], v[104:107], v[56:59]
    ds_read_b128 v[160:163], v217 offset:32768
    v_mfma_f32_16x16x32_bf16 v[24:27], v[120:123], v[108:111], v[24:27]
    ds_read_b128 v[164:167], v217 offset:33792
    v_mfma_f32_16x16x32_bf16 v[60:63], v[124:127], v[108:111], v[60:63]
    v_mfma_f32_16x16x32_bf16 v[28:31], v[120:123], v[112:115], v[28:31]
    v_mfma_f32_16x16x32_bf16 v[64:67], v[124:127], v[112:115], v[64:67]
    v_mfma_f32_16x16x32_bf16 v[32:35], v[120:123], v[116:119], v[32:35]
    v_mfma_f32_16x16x32_bf16 v[68:71], v[124:127], v[116:119], v[68:71]
    s_cmp_ge_u32 s3, 4
    s_cbranch_scc1 L_ao_13
    s_add_u32 m0, s63, 60928
    s_nop 0
    buffer_load_dwordx4 v223, s[8:11], 0 offen offset:512 lds
    s_add_u32 m0, s63, 65024
    s_nop 0
    buffer_load_dwordx4 v80, s[8:11], 0 offen offset:512 lds
    s_add_u32 m0, s63, 70656
    s_nop 0
    buffer_load_dwordx4 v225, s[12:15], s54 offen lds
    s_add_u32 m0, s63, 74752
    s_nop 0
    buffer_load_dwordx4 v81, s[12:15], s54 offen lds
    s_add_u32 m0, s63, 78592
    s_nop 0
    buffer_load_dwordx4 v225, s[12:15], s54 offen offset:256 lds
    s_add_u32 m0, s63, 82688
    s_nop 0
    buffer_load_dwordx4 v81, s[12:15], s54 offen offset:256 lds
    s_add_u32 s54, s54, 262144
    s_mov_b32 m0, 69120
    s_cmp_eq_u32 s46, 0
    s_cselect_b64 exec, -1, 0
    buffer_load_dwordx4 v224, s[8:11], 0 offen offset:512 lds
    s_mov_b64 exec, -1
    s_waitcnt vmcnt(12)
L_ao_13:

    s_cmp_ge_u32 s3, 4
    s_cbranch_scc1 L_hw_14
    v_mul_u32_u24 v76, 43, v216
    v_lshrrev_b32 v76, 7, v76
    v_mul_u32_u24 v77, 3, v76
    v_sub_u32 v77, v216, v77
    s_mul_i32 s47, s5, 36
    s_mul_i32 s48, s46, 9
    s_add_u32 s47, s47, s48
    v_add_u32 v76, s47, v76
    v_mul_u32_u24 v76, 1152, v76
    v_lshl_add_u32 v76, v77, 7, v76
    s_mov_b64 exec, 0x7ffffff
    buffer_load_dword v255, v76, s[8:11], 0 offen offset:768

    s_branch L_hwe_15

L_hw_14:

    s_mul_i32 s47, s46, 24
    v_add_u32 v76, s47, v216
    v_lshrrev_b32 v77, 4, v76
    v_add_u32 v77, 12, v77
    v_lshlrev_b32 v77, 5, v77
    s_lshr_b32 s47, s2, 3
    v_add_u32 v77, s47, v77
    v_lshlrev_b32 v77, 13, v77
    v_and_b32 v76, 15, v76
    v_lshl_add_u32 v76, v76, 7, v77
    s_lshl_b32 s47, s6, 11
    s_mov_b64 exec, 0xffffff
    buffer_load_dword v255, v76, s[12:15], s47 offen

L_hwe_15:
    s_mov_b64 exec, -1
    s_waitcnt lgkmcnt(0)
    s_barrier
    v_mfma_f32_16x16x32_bf16 v[0:3], v[168:171], v[132:135], v[0:3]
    ds_read_b64_tr_b16 v[120:121], v221 offset:0
    v_mfma_f32_16x16x32_bf16 v[36:39], v[172:175], v[132:135], v[36:39]
    ds_read_b64_tr_b16 v[122:123], v221 offset:1024
    v_mfma_f32_16x16x32_bf16 v[4:7], v[168:171], v[136:139], v[4:7]
    ds_read_b64_tr_b16 v[124:125], v222 offset:0
    v_mfma_f32_16x16x32_bf16 v[40:43], v[172:175], v[136:139], v[40:43]
    ds_read_b64_tr_b16 v[126:127], v222 offset:1024
    v_mfma_f32_16x16x32_bf16 v[8:11], v[168:171], v[140:143], v[8:11]
    ds_read_b128 v[84:87], v220 offset:0
    v_mfma_f32_16x16x32_bf16 v[44:47], v[172:175], v[140:143], v[44:47]
    ds_read_b128 v[88:91], v220 offset:1024
    v_mfma_f32_16x16x32_bf16 v[12:15], v[168:171], v[144:147], v[12:15]
    ds_read_b128 v[92:95], v220 offset:2048
    v_mfma_f32_16x16x32_bf16 v[48:51], v[172:175], v[144:147], v[48:51]
    ds_read_b128 v[96:99], v220 offset:3072
    v_mfma_f32_16x16x32_bf16 v[16:19], v[168:171], v[148:151], v[16:19]
    ds_read_b128 v[100:103], v220 offset:4096
    v_mfma_f32_16x16x32_bf16 v[52:55], v[172:175], v[148:151], v[52:55]
    ds_read_b128 v[104:107], v220 offset:5120
    v_mfma_f32_16x16x32_bf16 v[20:23], v[168:171], v[152:155], v[20:23]
    ds_read_b128 v[108:111], v220 offset:6144
    v_mfma_f32_16x16x32_bf16 v[56:59], v[172:175], v[152:155], v[56:59]
    ds_read_b128 v[112:115], v220 offset:7168
    v_mfma_f32_16x16x32_bf16 v[24:27], v[168:171], v[156:159], v[24:27]
    ds_read_b128 v[116:119], v220 offset:8192
    v_mfma_f32_16x16x32_bf16 v[60:63], v[172:175], v[156:159], v[60:63]
    v_mfma_f32_16x16x32_bf16 v[28:31], v[168:171], v[160:163], v[28:31]
    v_mfma_f32_16x16x32_bf16 v[64:67], v[172:175], v[160:163], v[64:67]
    v_mfma_f32_16x16x32_bf16 v[32:35], v[168:171], v[164:167], v[32:35]
    v_mfma_f32_16x16x32_bf16 v[68:71], v[172:175], v[164:167], v[68:71]
    s_cmp_ge_u32 s3, 4
    s_cbranch_scc1 L_ao_16
    s_add_u32 m0, s63, 86464
    s_nop 0
    buffer_load_dwordx4 v223, s[8:11], 0 offen offset:576 lds
    s_add_u32 m0, s63, 90560
    s_nop 0
    buffer_load_dwordx4 v80, s[8:11], 0 offen offset:576 lds
    s_add_u32 m0, s63, 96256
    s_nop 0
    buffer_load_dwordx4 v225, s[12:15], s54 offen lds
    s_add_u32 m0, s63, 100352
    s_nop 0
    buffer_load_dwordx4 v81, s[12:15], s54 offen lds
    s_add_u32 m0, s63, 104192
    s_nop 0
    buffer_load_dwordx4 v225, s[12:15], s54 offen offset:256 lds
    s_add_u32 m0, s63, 108288
    s_nop 0
    buffer_load_dwordx4 v81, s[12:15], s54 offen offset:256 lds
    s_add_u32 s54, s54, 262144
    s_mov_b32 m0, 94656
    s_cmp_eq_u32 s46, 1
    s_cselect_b64 exec, -1, 0
    buffer_load_dwordx4 v224, s[8:11], 0 offen offset:576 lds
    s_mov_b64 exec, -1
    s_waitcnt vmcnt(12)
L_ao_16:
    s_waitcnt lgkmcnt(0)
    s_barrier
    v_mfma_f32_16x16x32_bf16 v[0:3], v[120:123], v[84:87], v[0:3]
    ds_read_b64_tr_b16 v[168:169], v221 offset:25600
    v_mfma_f32_16x16x32_bf16 v[36:39], v[124:127], v[84:87], v[36:39]
    ds_read_b64_tr_b16 v[170:171], v221 offset:26624
    v_mfma_f32_16x16x32_bf16 v[4:7], v[120:123], v[88:91], v[4:7]
    ds_read_b64_tr_b16 v[172:173], v222 offset:25600
    v_mfma_f32_16x16x32_bf16 v[40:43], v[124:127], v[88:91], v[40:43]
    ds_read_b64_tr_b16 v[174:175], v222 offset:26624
    v_mfma_f32_16x16x32_bf16 v[8:11], v[120:123], v[92:95], v[8:11]
    ds_read_b128 v[132:135], v220 offset:25600
    v_mfma_f32_16x16x32_bf16 v[44:47], v[124:127], v[92:95], v[44:47]
    ds_read_b128 v[136:139], v220 offset:26624
    v_mfma_f32_16x16x32_bf16 v[12:15], v[120:123], v[96:99], v[12:15]
    ds_read_b128 v[140:143], v220 offset:27648
    v_mfma_f32_16x16x32_bf16 v[48:51], v[124:127], v[96:99], v[48:51]
    ds_read_b128 v[144:147], v220 offset:28672
    v_mfma_f32_16x16x32_bf16 v[16:19], v[120:123], v[100:103], v[16:19]
    ds_read_b128 v[148:151], v220 offset:29696
    v_mfma_f32_16x16x32_bf16 v[52:55], v[124:127], v[100:103], v[52:55]
    ds_read_b128 v[152:155], v220 offset:30720
    v_mfma_f32_16x16x32_bf16 v[20:23], v[120:123], v[104:107], v[20:23]
    ds_read_b128 v[156:159], v220 offset:31744
    v_mfma_f32_16x16x32_bf16 v[56:59], v[124:127], v[104:107], v[56:59]
    ds_read_b128 v[160:163], v220 offset:32768
    v_mfma_f32_16x16x32_bf16 v[24:27], v[120:123], v[108:111], v[24:27]
    ds_read_b128 v[164:167], v220 offset:33792
    v_mfma_f32_16x16x32_bf16 v[60:63], v[124:127], v[108:111], v[60:63]
    v_mfma_f32_16x16x32_bf16 v[28:31], v[120:123], v[112:115], v[28:31]
    v_mfma_f32_16x16x32_bf16 v[64:67], v[124:127], v[112:115], v[64:67]
    v_mfma_f32_16x16x32_bf16 v[32:35], v[120:123], v[116:119], v[32:35]
    v_mfma_f32_16x16x32_bf16 v[68:71], v[124:127], v[116:119], v[68:71]
    s_cmp_ge_u32 s3, 4
    s_cbranch_scc1 L_ao_17
    s_add_u32 m0, s63, 112000
    s_nop 0
    buffer_load_dwordx4 v223, s[8:11], 0 offen offset:640 lds
    s_add_u32 m0, s63, 116096
    s_nop 0
    buffer_load_dwordx4 v80, s[8:11], 0 offen offset:640 lds
    s_add_u32 m0, s63, 121856
    s_nop 0
    buffer_load_dwordx4 v225, s[12:15], s54 offen lds
    s_add_u32 m0, s63, 125952
    s_nop 0
    buffer_load_dwordx4 v81, s[12:15], s54 offen lds
    s_add_u32 m0, s63, 129792
    s_nop 0
    buffer_load_dwordx4 v225, s[12:15], s54 offen offset:256 lds
    s_add_u32 m0, s63, 133888
    s_nop 0
    buffer_load_dwordx4 v81, s[12:15], s54 offen offset:256 lds
    s_add_u32 s54, s54, 262144
    s_mov_b32 m0, 120192
    s_cmp_eq_u32 s46, 2
    s_cselect_b64 exec, -1, 0
    buffer_load_dwordx4 v224, s[8:11], 0 offen offset:640 lds
    s_mov_b64 exec, -1
    s_waitcnt vmcnt(12)
L_ao_17:
    s_waitcnt lgkmcnt(0)
    s_barrier
    v_mfma_f32_16x16x32_bf16 v[0:3], v[168:171], v[132:135], v[0:3]
    ds_read_b64_tr_b16 v[120:121], v218 offset:0
    v_mfma_f32_16x16x32_bf16 v[36:39], v[172:175], v[132:135], v[36:39]
    ds_read_b64_tr_b16 v[122:123], v218 offset:1024
    v_mfma_f32_16x16x32_bf16 v[4:7], v[168:171], v[136:139], v[4:7]
    ds_read_b64_tr_b16 v[124:125], v219 offset:0
    v_mfma_f32_16x16x32_bf16 v[40:43], v[172:175], v[136:139], v[40:43]
    ds_read_b64_tr_b16 v[126:127], v219 offset:1024
    v_mfma_f32_16x16x32_bf16 v[8:11], v[168:171], v[140:143], v[8:11]
    ds_read_b128 v[84:87], v217 offset:0
    v_mfma_f32_16x16x32_bf16 v[44:47], v[172:175], v[140:143], v[44:47]
    ds_read_b128 v[88:91], v217 offset:1024
    v_mfma_f32_16x16x32_bf16 v[12:15], v[168:171], v[144:147], v[12:15]
    ds_read_b128 v[92:95], v217 offset:2048
    v_mfma_f32_16x16x32_bf16 v[48:51], v[172:175], v[144:147], v[48:51]
    ds_read_b128 v[96:99], v217 offset:3072
    v_mfma_f32_16x16x32_bf16 v[16:19], v[168:171], v[148:151], v[16:19]
    ds_read_b128 v[100:103], v217 offset:4096
    v_mfma_f32_16x16x32_bf16 v[52:55], v[172:175], v[148:151], v[52:55]
    ds_read_b128 v[104:107], v217 offset:5120
    v_mfma_f32_16x16x32_bf16 v[20:23], v[168:171], v[152:155], v[20:23]
    ds_read_b128 v[108:111], v217 offset:6144
    v_mfma_f32_16x16x32_bf16 v[56:59], v[172:175], v[152:155], v[56:59]
    ds_read_b128 v[112:115], v217 offset:7168
    v_mfma_f32_16x16x32_bf16 v[24:27], v[168:171], v[156:159], v[24:27]
    ds_read_b128 v[116:119], v217 offset:8192
    v_mfma_f32_16x16x32_bf16 v[60:63], v[172:175], v[156:159], v[60:63]
    v_mfma_f32_16x16x32_bf16 v[28:31], v[168:171], v[160:163], v[28:31]
    v_mfma_f32_16x16x32_bf16 v[64:67], v[172:175], v[160:163], v[64:67]
    v_mfma_f32_16x16x32_bf16 v[32:35], v[168:171], v[164:167], v[32:35]
    v_mfma_f32_16x16x32_bf16 v[68:71], v[172:175], v[164:167], v[68:71]
    s_cmp_ge_u32 s3, 4
    s_cbranch_scc1 L_ao_18
    s_add_u32 m0, s63, 137536
    s_nop 0
    buffer_load_dwordx4 v223, s[8:11], 0 offen offset:704 lds
    s_add_u32 m0, s63, 141632
    s_nop 0
    buffer_load_dwordx4 v80, s[8:11], 0 offen offset:704 lds
    s_add_u32 m0, s63, 147456
    s_nop 0
    buffer_load_dwordx4 v225, s[12:15], s54 offen lds
    s_add_u32 m0, s63, 151552
    s_nop 0
    buffer_load_dwordx4 v81, s[12:15], s54 offen lds
    s_add_u32 m0, s63, 155392
    s_nop 0
    buffer_load_dwordx4 v225, s[12:15], s54 offen offset:256 lds
    s_add_u32 m0, s63, 159488
    s_nop 0
    buffer_load_dwordx4 v81, s[12:15], s54 offen offset:256 lds
    s_add_u32 s54, s54, 262144
    s_mov_b32 m0, 145728
    s_cmp_eq_u32 s46, 3
    s_cselect_b64 exec, -1, 0
    buffer_load_dwordx4 v224, s[8:11], 0 offen offset:704 lds
    s_mov_b64 exec, -1
    s_waitcnt vmcnt(12)
L_ao_18:
    s_waitcnt lgkmcnt(0)
    s_barrier
    v_mfma_f32_16x16x32_bf16 v[0:3], v[120:123], v[84:87], v[0:3]
    ds_read_b64_tr_b16 v[168:169], v218 offset:25600
    v_mfma_f32_16x16x32_bf16 v[36:39], v[124:127], v[84:87], v[36:39]
    ds_read_b64_tr_b16 v[170:171], v218 offset:26624
    v_mfma_f32_16x16x32_bf16 v[4:7], v[120:123], v[88:91], v[4:7]
    ds_read_b64_tr_b16 v[172:173], v219 offset:25600
    v_mfma_f32_16x16x32_bf16 v[40:43], v[124:127], v[88:91], v[40:43]
    ds_read_b64_tr_b16 v[174:175], v219 offset:26624
    v_mfma_f32_16x16x32_bf16 v[8:11], v[120:123], v[92:95], v[8:11]
    ds_read_b128 v[132:135], v217 offset:25600
    v_mfma_f32_16x16x32_bf16 v[44:47], v[124:127], v[92:95], v[44:47]
    ds_read_b128 v[136:139], v217 offset:26624
    v_mfma_f32_16x16x32_bf16 v[12:15], v[120:123], v[96:99], v[12:15]
    ds_read_b128 v[140:143], v217 offset:27648
    v_mfma_f32_16x16x32_bf16 v[48:51], v[124:127], v[96:99], v[48:51]
    ds_read_b128 v[144:147], v217 offset:28672
    v_mfma_f32_16x16x32_bf16 v[16:19], v[120:123], v[100:103], v[16:19]
    ds_read_b128 v[148:151], v217 offset:29696
    v_mfma_f32_16x16x32_bf16 v[52:55], v[124:127], v[100:103], v[52:55]
    ds_read_b128 v[152:155], v217 offset:30720
    v_mfma_f32_16x16x32_bf16 v[20:23], v[120:123], v[104:107], v[20:23]
    ds_read_b128 v[156:159], v217 offset:31744
    v_mfma_f32_16x16x32_bf16 v[56:59], v[124:127], v[104:107], v[56:59]
    ds_read_b128 v[160:163], v217 offset:32768
    v_mfma_f32_16x16x32_bf16 v[24:27], v[120:123], v[108:111], v[24:27]
    ds_read_b128 v[164:167], v217 offset:33792
    v_mfma_f32_16x16x32_bf16 v[60:63], v[124:127], v[108:111], v[60:63]
    v_mfma_f32_16x16x32_bf16 v[28:31], v[120:123], v[112:115], v[28:31]
    v_mfma_f32_16x16x32_bf16 v[64:67], v[124:127], v[112:115], v[64:67]
    v_mfma_f32_16x16x32_bf16 v[32:35], v[120:123], v[116:119], v[32:35]
    v_mfma_f32_16x16x32_bf16 v[68:71], v[124:127], v[116:119], v[68:71]
    s_cmp_ge_u32 s3, 4
    s_cbranch_scc1 L_ao_19
    s_add_u32 m0, s63, 60672
    s_nop 0
    buffer_load_dwordx4 v223, s[8:11], 0 offen offset:768 lds
    s_add_u32 m0, s63, 64768
    s_nop 0
    buffer_load_dwordx4 v80, s[8:11], 0 offen offset:768 lds
    s_add_u32 m0, s63, 70656
    s_nop 0
    buffer_load_dwordx4 v225, s[12:15], s54 offen lds
    s_add_u32 m0, s63, 74752
    s_nop 0
    buffer_load_dwordx4 v81, s[12:15], s54 offen lds
    s_add_u32 m0, s63, 78592
    s_nop 0
    buffer_load_dwordx4 v225, s[12:15], s54 offen offset:256 lds
    s_add_u32 m0, s63, 82688
    s_nop 0
    buffer_load_dwordx4 v81, s[12:15], s54 offen offset:256 lds
    s_add_u32 s54, s54, 262144
    s_mov_b32 m0, 68864
    s_cmp_eq_u32 s46, 0
    s_cselect_b64 exec, -1, 0
    buffer_load_dwordx4 v224, s[8:11], 0 offen offset:768 lds
    s_mov_b64 exec, -1
    s_waitcnt vmcnt(12)
L_ao_19:
    s_waitcnt lgkmcnt(0)
    s_barrier
    v_mfma_f32_16x16x32_bf16 v[0:3], v[168:171], v[132:135], v[0:3]
    ds_read_b64_tr_b16 v[120:121], v221 offset:0
    v_mfma_f32_16x16x32_bf16 v[36:39], v[172:175], v[132:135], v[36:39]
    ds_read_b64_tr_b16 v[122:123], v221 offset:1024
    v_mfma_f32_16x16x32_bf16 v[4:7], v[168:171], v[136:139], v[4:7]
    ds_read_b64_tr_b16 v[124:125], v222 offset:0
    v_mfma_f32_16x16x32_bf16 v[40:43], v[172:175], v[136:139], v[40:43]
    ds_read_b64_tr_b16 v[126:127], v222 offset:1024
    v_mfma_f32_16x16x32_bf16 v[8:11], v[168:171], v[140:143], v[8:11]
    ds_read_b128 v[84:87], v220 offset:0
    v_mfma_f32_16x16x32_bf16 v[44:47], v[172:175], v[140:143], v[44:47]
    ds_read_b128 v[88:91], v220 offset:1024
    v_mfma_f32_16x16x32_bf16 v[12:15], v[168:171], v[144:147], v[12:15]
    ds_read_b128 v[92:95], v220 offset:2048
    v_mfma_f32_16x16x32_bf16 v[48:51], v[172:175], v[144:147], v[48:51]
    ds_read_b128 v[96:99], v220 offset:3072
    v_mfma_f32_16x16x32_bf16 v[16:19], v[168:171], v[148:151], v[16:19]
    ds_read_b128 v[100:103], v220 offset:4096
    v_mfma_f32_16x16x32_bf16 v[52:55], v[172:175], v[148:151], v[52:55]
    ds_read_b128 v[104:107], v220 offset:5120
    v_mfma_f32_16x16x32_bf16 v[20:23], v[168:171], v[152:155], v[20:23]
    ds_read_b128 v[108:111], v220 offset:6144
    v_mfma_f32_16x16x32_bf16 v[56:59], v[172:175], v[152:155], v[56:59]
    ds_read_b128 v[112:115], v220 offset:7168
    v_mfma_f32_16x16x32_bf16 v[24:27], v[168:171], v[156:159], v[24:27]
    ds_read_b128 v[116:119], v220 offset:8192
    v_mfma_f32_16x16x32_bf16 v[60:63], v[172:175], v[156:159], v[60:63]
    v_mfma_f32_16x16x32_bf16 v[28:31], v[168:171], v[160:163], v[28:31]
    v_mfma_f32_16x16x32_bf16 v[64:67], v[172:175], v[160:163], v[64:67]
    v_mfma_f32_16x16x32_bf16 v[32:35], v[168:171], v[164:167], v[32:35]
    v_mfma_f32_16x16x32_bf16 v[68:71], v[172:175], v[164:167], v[68:71]
    s_cmp_ge_u32 s3, 4
    s_cbranch_scc1 L_ao_20
    s_add_u32 m0, s63, 86208
    s_nop 0
    buffer_load_dwordx4 v223, s[8:11], 0 offen offset:832 lds
    s_add_u32 m0, s63, 90304
    s_nop 0
    buffer_load_dwordx4 v80, s[8:11], 0 offen offset:832 lds
    s_add_u32 m0, s63, 96256
    s_nop 0
    buffer_load_dwordx4 v225, s[12:15], s54 offen lds
    s_add_u32 m0, s63, 100352
    s_nop 0
    buffer_load_dwordx4 v81, s[12:15], s54 offen lds
    s_add_u32 m0, s63, 104192
    s_nop 0
    buffer_load_dwordx4 v225, s[12:15], s54 offen offset:256 lds
    s_add_u32 m0, s63, 108288
    s_nop 0
    buffer_load_dwordx4 v81, s[12:15], s54 offen offset:256 lds
    s_add_u32 s54, s54, 262144
    s_mov_b32 m0, 94400
    s_cmp_eq_u32 s46, 1
    s_cselect_b64 exec, -1, 0
    buffer_load_dwordx4 v224, s[8:11], 0 offen offset:832 lds
    s_mov_b64 exec, -1
    s_waitcnt vmcnt(12)
L_ao_20:
    s_waitcnt lgkmcnt(0)
    s_barrier
    v_mfma_f32_16x16x32_bf16 v[0:3], v[120:123], v[84:87], v[0:3]
    ds_read_b64_tr_b16 v[168:169], v221 offset:25600
    v_mfma_f32_16x16x32_bf16 v[36:39], v[124:127], v[84:87], v[36:39]
    ds_read_b64_tr_b16 v[170:171], v221 offset:26624
    v_mfma_f32_16x16x32_bf16 v[4:7], v[120:123], v[88:91], v[4:7]
    ds_read_b64_tr_b16 v[172:173], v222 offset:25600
    v_mfma_f32_16x16x32_bf16 v[40:43], v[124:127], v[88:91], v[40:43]
    ds_read_b64_tr_b16 v[174:175], v222 offset:26624
    v_mfma_f32_16x16x32_bf16 v[8:11], v[120:123], v[92:95], v[8:11]
    ds_read_b128 v[132:135], v220 offset:25600
    v_mfma_f32_16x16x32_bf16 v[44:47], v[124:127], v[92:95], v[44:47]
    ds_read_b128 v[136:139], v220 offset:26624
    v_mfma_f32_16x16x32_bf16 v[12:15], v[120:123], v[96:99], v[12:15]
    ds_read_b128 v[140:143], v220 offset:27648
    v_mfma_f32_16x16x32_bf16 v[48:51], v[124:127], v[96:99], v[48:51]
    ds_read_b128 v[144:147], v220 offset:28672
    v_mfma_f32_16x16x32_bf16 v[16:19], v[120:123], v[100:103], v[16:19]
    ds_read_b128 v[148:151], v220 offset:29696
    v_mfma_f32_16x16x32_bf16 v[52:55], v[124:127], v[100:103], v[52:55]
    ds_read_b128 v[152:155], v220 offset:30720
    v_mfma_f32_16x16x32_bf16 v[20:23], v[120:123], v[104:107], v[20:23]
    ds_read_b128 v[156:159], v220 offset:31744
    v_mfma_f32_16x16x32_bf16 v[56:59], v[124:127], v[104:107], v[56:59]
    ds_read_b128 v[160:163], v220 offset:32768
    v_mfma_f32_16x16x32_bf16 v[24:27], v[120:123], v[108:111], v[24:27]
    ds_read_b128 v[164:167], v220 offset:33792
    v_mfma_f32_16x16x32_bf16 v[60:63], v[124:127], v[108:111], v[60:63]
    v_mfma_f32_16x16x32_bf16 v[28:31], v[120:123], v[112:115], v[28:31]
    v_mfma_f32_16x16x32_bf16 v[64:67], v[124:127], v[112:115], v[64:67]
    v_mfma_f32_16x16x32_bf16 v[32:35], v[120:123], v[116:119], v[32:35]
    v_mfma_f32_16x16x32_bf16 v[68:71], v[124:127], v[116:119], v[68:71]
    s_cmp_ge_u32 s3, 4
    s_cbranch_scc1 L_ao_21
    s_add_u32 m0, s63, 111744
    s_nop 0
    buffer_load_dwordx4 v223, s[8:11], 0 offen offset:896 lds
    s_add_u32 m0, s63, 115840
    s_nop 0
    buffer_load_dwordx4 v80, s[8:11], 0 offen offset:896 lds
    s_add_u32 m0, s63, 121856
    s_nop 0
    buffer_load_dwordx4 v225, s[12:15], s54 offen lds
    s_add_u32 m0, s63, 125952
    s_nop 0
    buffer_load_dwordx4 v81, s[12:15], s54 offen lds
    s_add_u32 m0, s63, 129792
    s_nop 0
    buffer_load_dwordx4 v225, s[12:15], s54 offen offset:256 lds
    s_add_u32 m0, s63, 133888
    s_nop 0
    buffer_load_dwordx4 v81, s[12:15], s54 offen offset:256 lds
    s_add_u32 s54, s54, 262144
    s_mov_b32 m0, 119936
    s_cmp_eq_u32 s46, 2
    s_cselect_b64 exec, -1, 0
    buffer_load_dwordx4 v224, s[8:11], 0 offen offset:896 lds
    s_mov_b64 exec, -1
    s_waitcnt vmcnt(12)
L_ao_21:
    s_waitcnt lgkmcnt(0)
    s_barrier
    v_mfma_f32_16x16x32_bf16 v[0:3], v[168:171], v[132:135], v[0:3]
    ds_read_b64_tr_b16 v[120:121], v218 offset:0
    v_mfma_f32_16x16x32_bf16 v[36:39], v[172:175], v[132:135], v[36:39]
    ds_read_b64_tr_b16 v[122:123], v218 offset:1024
    v_mfma_f32_16x16x32_bf16 v[4:7], v[168:171], v[136:139], v[4:7]
    ds_read_b64_tr_b16 v[124:125], v219 offset:0
    v_mfma_f32_16x16x32_bf16 v[40:43], v[172:175], v[136:139], v[40:43]
    ds_read_b64_tr_b16 v[126:127], v219 offset:1024
    v_mfma_f32_16x16x32_bf16 v[8:11], v[168:171], v[140:143], v[8:11]
    ds_read_b128 v[84:87], v217 offset:0
    v_mfma_f32_16x16x32_bf16 v[44:47], v[172:175], v[140:143], v[44:47]
    ds_read_b128 v[88:91], v217 offset:1024
    v_mfma_f32_16x16x32_bf16 v[12:15], v[168:171], v[144:147], v[12:15]
    ds_read_b128 v[92:95], v217 offset:2048
    v_mfma_f32_16x16x32_bf16 v[48:51], v[172:175], v[144:147], v[48:51]
    ds_read_b128 v[96:99], v217 offset:3072
    v_mfma_f32_16x16x32_bf16 v[16:19], v[168:171], v[148:151], v[16:19]
    ds_read_b128 v[100:103], v217 offset:4096
    v_mfma_f32_16x16x32_bf16 v[52:55], v[172:175], v[148:151], v[52:55]
    ds_read_b128 v[104:107], v217 offset:5120
    v_mfma_f32_16x16x32_bf16 v[20:23], v[168:171], v[152:155], v[20:23]
    ds_read_b128 v[108:111], v217 offset:6144
    v_mfma_f32_16x16x32_bf16 v[56:59], v[172:175], v[152:155], v[56:59]
    ds_read_b128 v[112:115], v217 offset:7168
    v_mfma_f32_16x16x32_bf16 v[24:27], v[168:171], v[156:159], v[24:27]
    ds_read_b128 v[116:119], v217 offset:8192
    v_mfma_f32_16x16x32_bf16 v[60:63], v[172:175], v[156:159], v[60:63]
    v_mfma_f32_16x16x32_bf16 v[28:31], v[168:171], v[160:163], v[28:31]
    v_mfma_f32_16x16x32_bf16 v[64:67], v[172:175], v[160:163], v[64:67]
    v_mfma_f32_16x16x32_bf16 v[32:35], v[168:171], v[164:167], v[32:35]
    v_mfma_f32_16x16x32_bf16 v[68:71], v[172:175], v[164:167], v[68:71]
    s_cmp_ge_u32 s3, 4
    s_cbranch_scc1 L_ao_22
    s_add_u32 m0, s63, 137280
    s_nop 0
    buffer_load_dwordx4 v223, s[8:11], 0 offen offset:960 lds
    s_add_u32 m0, s63, 141376
    s_nop 0
    buffer_load_dwordx4 v80, s[8:11], 0 offen offset:960 lds
    s_add_u32 m0, s63, 147456
    s_nop 0
    buffer_load_dwordx4 v225, s[12:15], s54 offen lds
    s_add_u32 m0, s63, 151552
    s_nop 0
    buffer_load_dwordx4 v81, s[12:15], s54 offen lds
    s_add_u32 m0, s63, 155392
    s_nop 0
    buffer_load_dwordx4 v225, s[12:15], s54 offen offset:256 lds
    s_add_u32 m0, s63, 159488
    s_nop 0
    buffer_load_dwordx4 v81, s[12:15], s54 offen offset:256 lds
    s_add_u32 s54, s54, 262144
    s_mov_b32 m0, 145472
    s_cmp_eq_u32 s46, 3
    s_cselect_b64 exec, -1, 0
    buffer_load_dwordx4 v224, s[8:11], 0 offen offset:960 lds
    s_mov_b64 exec, -1
    s_waitcnt vmcnt(12)
L_ao_22:
    s_waitcnt lgkmcnt(0)
    s_barrier
    v_mfma_f32_16x16x32_bf16 v[0:3], v[120:123], v[84:87], v[0:3]
    ds_read_b64_tr_b16 v[168:169], v218 offset:25600
    v_mfma_f32_16x16x32_bf16 v[36:39], v[124:127], v[84:87], v[36:39]
    ds_read_b64_tr_b16 v[170:171], v218 offset:26624
    v_mfma_f32_16x16x32_bf16 v[4:7], v[120:123], v[88:91], v[4:7]
    ds_read_b64_tr_b16 v[172:173], v219 offset:25600
    v_mfma_f32_16x16x32_bf16 v[40:43], v[124:127], v[88:91], v[40:43]
    ds_read_b64_tr_b16 v[174:175], v219 offset:26624
    v_mfma_f32_16x16x32_bf16 v[8:11], v[120:123], v[92:95], v[8:11]
    ds_read_b128 v[132:135], v217 offset:25600
    v_mfma_f32_16x16x32_bf16 v[44:47], v[124:127], v[92:95], v[44:47]
    ds_read_b128 v[136:139], v217 offset:26624
    v_mfma_f32_16x16x32_bf16 v[12:15], v[120:123], v[96:99], v[12:15]
    ds_read_b128 v[140:143], v217 offset:27648
    v_mfma_f32_16x16x32_bf16 v[48:51], v[124:127], v[96:99], v[48:51]
    ds_read_b128 v[144:147], v217 offset:28672
    v_mfma_f32_16x16x32_bf16 v[16:19], v[120:123], v[100:103], v[16:19]
    ds_read_b128 v[148:151], v217 offset:29696
    v_mfma_f32_16x16x32_bf16 v[52:55], v[124:127], v[100:103], v[52:55]
    ds_read_b128 v[152:155], v217 offset:30720
    v_mfma_f32_16x16x32_bf16 v[20:23], v[120:123], v[104:107], v[20:23]
    ds_read_b128 v[156:159], v217 offset:31744
    v_mfma_f32_16x16x32_bf16 v[56:59], v[124:127], v[104:107], v[56:59]
    ds_read_b128 v[160:163], v217 offset:32768
    v_mfma_f32_16x16x32_bf16 v[24:27], v[120:123], v[108:111], v[24:27]
    ds_read_b128 v[164:167], v217 offset:33792
    v_mfma_f32_16x16x32_bf16 v[60:63], v[124:127], v[108:111], v[60:63]
    v_mfma_f32_16x16x32_bf16 v[28:31], v[120:123], v[112:115], v[28:31]
    v_mfma_f32_16x16x32_bf16 v[64:67], v[124:127], v[112:115], v[64:67]
    v_mfma_f32_16x16x32_bf16 v[32:35], v[120:123], v[116:119], v[32:35]
    v_mfma_f32_16x16x32_bf16 v[68:71], v[124:127], v[116:119], v[68:71]
    s_cmp_ge_u32 s3, 4
    s_cbranch_scc1 L_ao_23
    s_add_u32 m0, s63, 60416
    s_nop 0
    buffer_load_dwordx4 v223, s[8:11], 0 offen offset:1024 lds
    s_add_u32 m0, s63, 64512
    s_nop 0
    buffer_load_dwordx4 v80, s[8:11], 0 offen offset:1024 lds
    s_add_u32 m0, s63, 70656
    s_nop 0
    buffer_load_dwordx4 v225, s[12:15], s54 offen lds
    s_add_u32 m0, s63, 74752
    s_nop 0
    buffer_load_dwordx4 v81, s[12:15], s54 offen lds
    s_add_u32 m0, s63, 78592
    s_nop 0
    buffer_load_dwordx4 v225, s[12:15], s54 offen offset:256 lds
    s_add_u32 m0, s63, 82688
    s_nop 0
    buffer_load_dwordx4 v81, s[12:15], s54 offen offset:256 lds
    s_add_u32 s54, s54, 262144
    s_mov_b32 m0, 68608
    s_cmp_eq_u32 s46, 0
    s_cselect_b64 exec, -1, 0
    buffer_load_dwordx4 v224, s[8:11], 0 offen offset:1024 lds
    s_mov_b64 exec, -1
    s_waitcnt vmcnt(12)
L_ao_23:
    s_waitcnt lgkmcnt(0)
    s_barrier
    v_mfma_f32_16x16x32_bf16 v[0:3], v[168:171], v[132:135], v[0:3]
    ds_read_b64_tr_b16 v[120:121], v221 offset:0
    v_mfma_f32_16x16x32_bf16 v[36:39], v[172:175], v[132:135], v[36:39]
    ds_read_b64_tr_b16 v[122:123], v221 offset:1024
    v_mfma_f32_16x16x32_bf16 v[4:7], v[168:171], v[136:139], v[4:7]
    ds_read_b64_tr_b16 v[124:125], v222 offset:0
    v_mfma_f32_16x16x32_bf16 v[40:43], v[172:175], v[136:139], v[40:43]
    ds_read_b64_tr_b16 v[126:127], v222 offset:1024
    v_mfma_f32_16x16x32_bf16 v[8:11], v[168:171], v[140:143], v[8:11]
    ds_read_b128 v[84:87], v220 offset:0
    v_mfma_f32_16x16x32_bf16 v[44:47], v[172:175], v[140:143], v[44:47]
    ds_read_b128 v[88:91], v220 offset:1024
    v_mfma_f32_16x16x32_bf16 v[12:15], v[168:171], v[144:147], v[12:15]
    ds_read_b128 v[92:95], v220 offset:2048
    v_mfma_f32_16x16x32_bf16 v[48:51], v[172:175], v[144:147], v[48:51]
    ds_read_b128 v[96:99], v220 offset:3072
    v_mfma_f32_16x16x32_bf16 v[16:19], v[168:171], v[148:151], v[16:19]
    ds_read_b128 v[100:103], v220 offset:4096
    v_mfma_f32_16x16x32_bf16 v[52:55], v[172:175], v[148:151], v[52:55]
    ds_read_b128 v[104:107], v220 offset:5120
    v_mfma_f32_16x16x32_bf16 v[20:23], v[168:171], v[152:155], v[20:23]
    ds_read_b128 v[108:111], v220 offset:6144
    v_mfma_f32_16x16x32_bf16 v[56:59], v[172:175], v[152:155], v[56:59]
    ds_read_b128 v[112:115], v220 offset:7168
    v_mfma_f32_16x16x32_bf16 v[24:27], v[168:171], v[156:159], v[24:27]
    ds_read_b128 v[116:119], v220 offset:8192
    v_mfma_f32_16x16x32_bf16 v[60:63], v[172:175], v[156:159], v[60:63]
    v_mfma_f32_16x16x32_bf16 v[28:31], v[168:171], v[160:163], v[28:31]
    v_mfma_f32_16x16x32_bf16 v[64:67], v[172:175], v[160:163], v[64:67]
    v_mfma_f32_16x16x32_bf16 v[32:35], v[168:171], v[164:167], v[32:35]
    v_mfma_f32_16x16x32_bf16 v[68:71], v[172:175], v[164:167], v[68:71]
    s_cmp_ge_u32 s3, 4
    s_cbranch_scc1 L_ao_24
    s_add_u32 m0, s63, 85952
    s_nop 0
    buffer_load_dwordx4 v223, s[8:11], 0 offen offset:1088 lds
    s_add_u32 m0, s63, 90048
    s_nop 0
    buffer_load_dwordx4 v80, s[8:11], 0 offen offset:1088 lds
    s_add_u32 m0, s63, 96256
    s_nop 0
    buffer_load_dwordx4 v225, s[12:15], s54 offen lds
    s_add_u32 m0, s63, 100352
    s_nop 0
    buffer_load_dwordx4 v81, s[12:15], s54 offen lds
    s_add_u32 m0, s63, 104192
    s_nop 0
    buffer_load_dwordx4 v225, s[12:15], s54 offen offset:256 lds
    s_add_u32 m0, s63, 108288
    s_nop 0
    buffer_load_dwordx4 v81, s[12:15], s54 offen offset:256 lds
    s_add_u32 s54, s54, 262144
    s_mov_b32 m0, 94144
    s_cmp_eq_u32 s46, 1
    s_cselect_b64 exec, -1, 0
    buffer_load_dwordx4 v224, s[8:11], 0 offen offset:1088 lds
    s_mov_b64 exec, -1
    s_waitcnt vmcnt(12)
L_ao_24:
    s_waitcnt lgkmcnt(0)
    s_barrier
    v_mfma_f32_16x16x32_bf16 v[0:3], v[120:123], v[84:87], v[0:3]
    ds_read_b64_tr_b16 v[168:169], v221 offset:25600
    v_mfma_f32_16x16x32_bf16 v[36:39], v[124:127], v[84:87], v[36:39]
    ds_read_b64_tr_b16 v[170:171], v221 offset:26624
    v_mfma_f32_16x16x32_bf16 v[4:7], v[120:123], v[88:91], v[4:7]
    ds_read_b64_tr_b16 v[172:173], v222 offset:25600
    v_mfma_f32_16x16x32_bf16 v[40:43], v[124:127], v[88:91], v[40:43]
    ds_read_b64_tr_b16 v[174:175], v222 offset:26624
    v_mfma_f32_16x16x32_bf16 v[8:11], v[120:123], v[92:95], v[8:11]
    ds_read_b128 v[132:135], v220 offset:25600
    v_mfma_f32_16x16x32_bf16 v[44:47], v[124:127], v[92:95], v[44:47]
    ds_read_b128 v[136:139], v220 offset:26624
    v_mfma_f32_16x16x32_bf16 v[12:15], v[120:123], v[96:99], v[12:15]
    ds_read_b128 v[140:143], v220 offset:27648
    v_mfma_f32_16x16x32_bf16 v[48:51], v[124:127], v[96:99], v[48:51]
    ds_read_b128 v[144:147], v220 offset:28672
    v_mfma_f32_16x16x32_bf16 v[16:19], v[120:123], v[100:103], v[16:19]
    ds_read_b128 v[148:151], v220 offset:29696
    v_mfma_f32_16x16x32_bf16 v[52:55], v[124:127], v[100:103], v[52:55]
    ds_read_b128 v[152:155], v220 offset:30720
    v_mfma_f32_16x16x32_bf16 v[20:23], v[120:123], v[104:107], v[20:23]
    ds_read_b128 v[156:159], v220 offset:31744
    v_mfma_f32_16x16x32_bf16 v[56:59], v[124:127], v[104:107], v[56:59]
    ds_read_b128 v[160:163], v220 offset:32768
    v_mfma_f32_16x16x32_bf16 v[24:27], v[120:123], v[108:111], v[24:27]
    ds_read_b128 v[164:167], v220 offset:33792
    v_mfma_f32_16x16x32_bf16 v[60:63], v[124:127], v[108:111], v[60:63]
    v_mfma_f32_16x16x32_bf16 v[28:31], v[120:123], v[112:115], v[28:31]
    v_mfma_f32_16x16x32_bf16 v[64:67], v[124:127], v[112:115], v[64:67]
    v_mfma_f32_16x16x32_bf16 v[32:35], v[120:123], v[116:119], v[32:35]
    v_mfma_f32_16x16x32_bf16 v[68:71], v[124:127], v[116:119], v[68:71]
    s_cmp_ge_u32 s3, 4
    s_cbranch_scc1 L_ao_25

    s_add_u32 m0, s96, 52224
    s_nop 0
    buffer_load_dwordx4 v254, s[16:19], 0 offen nt lds
    s_add_u32 m0, s96, 52288
    s_nop 0
    buffer_load_dwordx4 v254, s[16:19], 0 offen offset:1024 nt lds

    s_add_u32 m0, s96, 0
    s_nop 0
    buffer_load_dwordx4 v236, s[16:19], s89 offen nt lds
    s_add_u32 m0, s96, 64
    s_nop 0
    buffer_load_dwordx4 v236, s[16:19], s89 offen offset:1024 nt lds
    s_add_u32 m0, s97, 0
    s_nop 0
    buffer_load_dwordx4 v237, s[20:23], s89 offen nt lds
    s_add_u32 m0, s97, 832
    s_nop 0
    buffer_load_dwordx4 v237, s[20:23], s89 offen offset:256 nt lds
    s_add_u32 s89, s89, 8192
    s_waitcnt vmcnt(12)
L_ao_25:
    s_waitcnt lgkmcnt(0)
    s_barrier
    v_mfma_f32_16x16x32_bf16 v[0:3], v[168:171], v[132:135], v[0:3]
    ds_read_b64_tr_b16 v[120:121], v218 offset:0
    v_mfma_f32_16x16x32_bf16 v[36:39], v[172:175], v[132:135], v[36:39]
    ds_read_b64_tr_b16 v[122:123], v218 offset:1024
    v_mfma_f32_16x16x32_bf16 v[4:7], v[168:171], v[136:139], v[4:7]
    ds_read_b64_tr_b16 v[124:125], v219 offset:0
    v_mfma_f32_16x16x32_bf16 v[40:43], v[172:175], v[136:139], v[40:43]
    ds_read_b64_tr_b16 v[126:127], v219 offset:1024
    v_mfma_f32_16x16x32_bf16 v[8:11], v[168:171], v[140:143], v[8:11]
    ds_read_b128 v[84:87], v217 offset:0
    v_mfma_f32_16x16x32_bf16 v[44:47], v[172:175], v[140:143], v[44:47]
    ds_read_b128 v[88:91], v217 offset:1024
    v_mfma_f32_16x16x32_bf16 v[12:15], v[168:171], v[144:147], v[12:15]
    ds_read_b128 v[92:95], v217 offset:2048
    v_mfma_f32_16x16x32_bf16 v[48:51], v[172:175], v[144:147], v[48:51]
    ds_read_b128 v[96:99], v217 offset:3072
    v_mfma_f32_16x16x32_bf16 v[16:19], v[168:171], v[148:151], v[16:19]
    ds_read_b128 v[100:103], v217 offset:4096
    v_mfma_f32_16x16x32_bf16 v[52:55], v[172:175], v[148:151], v[52:55]
    ds_read_b128 v[104:107], v217 offset:5120
    v_mfma_f32_16x16x32_bf16 v[20:23], v[168:171], v[152:155], v[20:23]
    ds_read_b128 v[108:111], v217 offset:6144
    v_mfma_f32_16x16x32_bf16 v[56:59], v[172:175], v[152:155], v[56:59]
    ds_read_b128 v[112:115], v217 offset:7168
    v_mfma_f32_16x16x32_bf16 v[24:27], v[168:171], v[156:159], v[24:27]
    ds_read_b128 v[116:119], v217 offset:8192
    v_mfma_f32_16x16x32_bf16 v[60:63], v[172:175], v[156:159], v[60:63]
    v_mfma_f32_16x16x32_bf16 v[28:31], v[168:171], v[160:163], v[28:31]
    v_mfma_f32_16x16x32_bf16 v[64:67], v[172:175], v[160:163], v[64:67]
    v_mfma_f32_16x16x32_bf16 v[32:35], v[168:171], v[164:167], v[32:35]
    v_mfma_f32_16x16x32_bf16 v[68:71], v[172:175], v[164:167], v[68:71]
    s_cmp_ge_u32 s3, 4
    s_cbranch_scc1 L_ao_26
    s_add_u32 m0, s96, 17408
    s_nop 0
    buffer_load_dwordx4 v236, s[16:19], s89 offen nt lds
    s_add_u32 m0, s96, 17472
    s_nop 0
    buffer_load_dwordx4 v236, s[16:19], s89 offen offset:1024 nt lds
    s_add_u32 m0, s97, 17408
    s_nop 0
    buffer_load_dwordx4 v237, s[20:23], s89 offen nt lds
    s_add_u32 m0, s97, 18240
    s_nop 0
    buffer_load_dwordx4 v237, s[20:23], s89 offen offset:256 nt lds
    s_add_u32 s89, s89, 8192
    s_waitcnt vmcnt(10)
L_ao_26:
    s_waitcnt lgkmcnt(0)
    s_barrier
    v_mfma_f32_16x16x32_bf16 v[0:3], v[120:123], v[84:87], v[0:3]
    ds_read_b64_tr_b16 v[168:169], v218 offset:25600
    v_mfma_f32_16x16x32_bf16 v[36:39], v[124:127], v[84:87], v[36:39]
    ds_read_b64_tr_b16 v[170:171], v218 offset:26624
    v_mfma_f32_16x16x32_bf16 v[4:7], v[120:123], v[88:91], v[4:7]
    ds_read_b64_tr_b16 v[172:173], v219 offset:25600
    v_mfma_f32_16x16x32_bf16 v[40:43], v[124:127], v[88:91], v[40:43]
    ds_read_b64_tr_b16 v[174:175], v219 offset:26624
    v_mfma_f32_16x16x32_bf16 v[8:11], v[120:123], v[92:95], v[8:11]
    ds_read_b128 v[132:135], v217 offset:25600
    v_mfma_f32_16x16x32_bf16 v[44:47], v[124:127], v[92:95], v[44:47]
    ds_read_b128 v[136:139], v217 offset:26624
    v_mfma_f32_16x16x32_bf16 v[12:15], v[120:123], v[96:99], v[12:15]
    ds_read_b128 v[140:143], v217 offset:27648
    v_mfma_f32_16x16x32_bf16 v[48:51], v[124:127], v[96:99], v[48:51]
    ds_read_b128 v[144:147], v217 offset:28672
    v_mfma_f32_16x16x32_bf16 v[16:19], v[120:123], v[100:103], v[16:19]
    ds_read_b128 v[148:151], v217 offset:29696
    v_mfma_f32_16x16x32_bf16 v[52:55], v[124:127], v[100:103], v[52:55]
    ds_read_b128 v[152:155], v217 offset:30720
    v_mfma_f32_16x16x32_bf16 v[20:23], v[120:123], v[104:107], v[20:23]
    ds_read_b128 v[156:159], v217 offset:31744
    v_mfma_f32_16x16x32_bf16 v[56:59], v[124:127], v[104:107], v[56:59]
    ds_read_b128 v[160:163], v217 offset:32768
    v_mfma_f32_16x16x32_bf16 v[24:27], v[120:123], v[108:111], v[24:27]
    ds_read_b128 v[164:167], v217 offset:33792
    v_mfma_f32_16x16x32_bf16 v[60:63], v[124:127], v[108:111], v[60:63]
    v_mfma_f32_16x16x32_bf16 v[28:31], v[120:123], v[112:115], v[28:31]
    v_mfma_f32_16x16x32_bf16 v[64:67], v[124:127], v[112:115], v[64:67]
    v_mfma_f32_16x16x32_bf16 v[32:35], v[120:123], v[116:119], v[32:35]
    v_mfma_f32_16x16x32_bf16 v[68:71], v[124:127], v[116:119], v[68:71]
    s_cmp_ge_u32 s3, 4
    s_cbranch_scc1 L_ao_27
    s_add_u32 m0, s96, 34816
    s_nop 0
    buffer_load_dwordx4 v236, s[16:19], s89 offen nt lds
    s_add_u32 m0, s96, 34880
    s_nop 0
    buffer_load_dwordx4 v236, s[16:19], s89 offen offset:1024 nt lds
    s_add_u32 m0, s97, 34816
    s_nop 0
    buffer_load_dwordx4 v237, s[20:23], s89 offen nt lds
    s_add_u32 m0, s97, 35648
    s_nop 0
    buffer_load_dwordx4 v237, s[20:23], s89 offen offset:256 nt lds
    s_add_u32 s89, s89, 8192
L_ao_27:
    s_waitcnt lgkmcnt(0)
    s_barrier
    v_mfma_f32_16x16x32_bf16 v[0:3], v[168:171], v[132:135], v[0:3]
    v_mfma_f32_16x16x32_bf16 v[36:39], v[172:175], v[132:135], v[36:39]
    v_mfma_f32_16x16x32_bf16 v[4:7], v[168:171], v[136:139], v[4:7]
    v_mfma_f32_16x16x32_bf16 v[40:43], v[172:175], v[136:139], v[40:43]
    v_mfma_f32_16x16x32_bf16 v[8:11], v[168:171], v[140:143], v[8:11]
    v_mfma_f32_16x16x32_bf16 v[44:47], v[172:175], v[140:143], v[44:47]
    v_mfma_f32_16x16x32_bf16 v[12:15], v[168:171], v[144:147], v[12:15]
    v_mfma_f32_16x16x32_bf16 v[48:51], v[172:175], v[144:147], v[48:51]
    v_mfma_f32_16x16x32_bf16 v[16:19], v[168:171], v[148:151], v[16:19]
    v_mfma_f32_16x16x32_bf16 v[52:55], v[172:175], v[148:151], v[52:55]
    v_mfma_f32_16x16x32_bf16 v[20:23], v[168:171], v[152:155], v[20:23]
    v_mfma_f32_16x16x32_bf16 v[56:59], v[172:175], v[152:155], v[56:59]
    v_mfma_f32_16x16x32_bf16 v[24:27], v[168:171], v[156:159], v[24:27]
    v_mfma_f32_16x16x32_bf16 v[60:63], v[172:175], v[156:159], v[60:63]
    v_mfma_f32_16x16x32_bf16 v[28:31], v[168:171], v[160:163], v[28:31]
    v_mfma_f32_16x16x32_bf16 v[64:67], v[172:175], v[160:163], v[64:67]
    v_mfma_f32_16x16x32_bf16 v[32:35], v[168:171], v[164:167], v[32:35]
    v_mfma_f32_16x16x32_bf16 v[68:71], v[172:175], v[164:167], v[68:71]
    s_waitcnt lgkmcnt(0)
L_head_e:
    s_cmp_ge_u32 s3, 4
    s_cbranch_scc1 L_pteam
    s_nop 7
    s_mov_b32 s70, 1040356334
    s_mov_b32 s71, 1040356334

    v_and_b32 v72, 15, v216
    v_lshrrev_b32 v73, 5, v216
    s_lshl_b32 s47, s46, 2
    v_add_u32 v73, s47, v73
    v_xor_b32 v73, v73, v72
    v_lshlrev_b32 v72, 8, v72
    v_lshl_add_u32 v72, v73, 4, v72
    v_bfe_u32 v73, v216, 4, 1
    v_lshl_add_u32 v72, v73, 3, v72
    v_add_u32 v226, 69632, v72
    v_xor_b32 v72, 32, v72
    v_add_u32 v227, 69632, v72

    v_pk_mul_f32 v[0:1], v[0:1], s[70:71]
    v_pk_mul_f32 v[2:3], v[2:3], s[70:71]
    v_cvt_pk_bf16_f32 v180, v0, v1
    v_cvt_pk_bf16_f32 v181, v2, v3
    ds_write_b64 v226, v[180:181] offset:0
    v_pk_mul_f32 v[4:5], v[4:5], s[70:71]
    v_pk_mul_f32 v[6:7], v[6:7], s[70:71]
    v_cvt_pk_bf16_f32 v182, v4, v5
    v_cvt_pk_bf16_f32 v183, v6, v7
    ds_write_b64 v226, v[182:183] offset:4096
    v_pk_mul_f32 v[8:9], v[8:9], s[70:71]
    v_pk_mul_f32 v[10:11], v[10:11], s[70:71]
    v_cvt_pk_bf16_f32 v184, v8, v9
    v_cvt_pk_bf16_f32 v185, v10, v11
    ds_write_b64 v226, v[184:185] offset:8192
    v_pk_mul_f32 v[12:13], v[12:13], s[70:71]
    v_pk_mul_f32 v[14:15], v[14:15], s[70:71]
    v_cvt_pk_bf16_f32 v186, v12, v13
    v_cvt_pk_bf16_f32 v187, v14, v15
    ds_write_b64 v226, v[186:187] offset:12288
    v_pk_mul_f32 v[16:17], v[16:17], s[70:71]
    v_pk_mul_f32 v[18:19], v[18:19], s[70:71]
    v_cvt_pk_bf16_f32 v188, v16, v17
    v_cvt_pk_bf16_f32 v189, v18, v19
    ds_write_b64 v226, v[188:189] offset:16384
    v_pk_mul_f32 v[20:21], v[20:21], s[70:71]
    v_pk_mul_f32 v[22:23], v[22:23], s[70:71]
    v_cvt_pk_bf16_f32 v190, v20, v21
    v_cvt_pk_bf16_f32 v191, v22, v23
    ds_write_b64 v226, v[190:191] offset:20480
    v_pk_mul_f32 v[24:25], v[24:25], s[70:71]
    v_pk_mul_f32 v[26:27], v[26:27], s[70:71]
    v_cvt_pk_bf16_f32 v192, v24, v25
    v_cvt_pk_bf16_f32 v193, v26, v27
    ds_write_b64 v226, v[192:193] offset:24576
    v_pk_mul_f32 v[28:29], v[28:29], s[70:71]
    v_pk_mul_f32 v[30:31], v[30:31], s[70:71]
    v_cvt_pk_bf16_f32 v194, v28, v29
    v_cvt_pk_bf16_f32 v195, v30, v31
    ds_write_b64 v226, v[194:195] offset:28672
    v_pk_mul_f32 v[32:33], v[32:33], s[70:71]
    v_pk_mul_f32 v[34:35], v[34:35], s[70:71]
    v_cvt_pk_bf16_f32 v196, v32, v33
    v_cvt_pk_bf16_f32 v197, v34, v35
    ds_write_b64 v226, v[196:197] offset:32768
    v_pk_mul_f32 v[36:37], v[36:37], s[70:71]
    v_pk_mul_f32 v[38:39], v[38:39], s[70:71]
    v_cvt_pk_bf16_f32 v198, v36, v37
    v_cvt_pk_bf16_f32 v199, v38, v39
    ds_write_b64 v227, v[198:199] offset:0
    v_pk_mul_f32 v[40:41], v[40:41], s[70:71]
    v_pk_mul_f32 v[42:43], v[42:43], s[70:71]
    v_cvt_pk_bf16_f32 v200, v40, v41
    v_cvt_pk_bf16_f32 v201, v42, v43
    ds_write_b64 v227, v[200:201] offset:4096
    v_pk_mul_f32 v[44:45], v[44:45], s[70:71]
    v_pk_mul_f32 v[46:47], v[46:47], s[70:71]
    v_cvt_pk_bf16_f32 v202, v44, v45
    v_cvt_pk_bf16_f32 v203, v46, v47
    ds_write_b64 v227, v[202:203] offset:8192
    v_pk_mul_f32 v[48:49], v[48:49], s[70:71]
    v_pk_mul_f32 v[50:51], v[50:51], s[70:71]
    v_cvt_pk_bf16_f32 v204, v48, v49
    v_cvt_pk_bf16_f32 v205, v50, v51
    ds_write_b64 v227, v[204:205] offset:12288
    v_pk_mul_f32 v[52:53], v[52:53], s[70:71]
    v_pk_mul_f32 v[54:55], v[54:55], s[70:71]
    v_cvt_pk_bf16_f32 v206, v52, v53
    v_cvt_pk_bf16_f32 v207, v54, v55
    ds_write_b64 v227, v[206:207] offset:16384
    v_pk_mul_f32 v[56:57], v[56:57], s[70:71]
    v_pk_mul_f32 v[58:59], v[58:59], s[70:71]
    v_cvt_pk_bf16_f32 v208, v56, v57
    v_cvt_pk_bf16_f32 v209, v58, v59
    ds_write_b64 v227, v[208:209] offset:20480
    v_pk_mul_f32 v[60:61], v[60:61], s[70:71]
    v_pk_mul_f32 v[62:63], v[62:63], s[70:71]
    v_cvt_pk_bf16_f32 v210, v60, v61
    v_cvt_pk_bf16_f32 v211, v62, v63
    ds_write_b64 v227, v[210:211] offset:24576
    v_pk_mul_f32 v[64:65], v[64:65], s[70:71]
    v_pk_mul_f32 v[66:67], v[66:67], s[70:71]
    v_cvt_pk_bf16_f32 v212, v64, v65
    v_cvt_pk_bf16_f32 v213, v66, v67
    ds_write_b64 v227, v[212:213] offset:28672
    v_pk_mul_f32 v[68:69], v[68:69], s[70:71]
    v_pk_mul_f32 v[70:71], v[70:71], s[70:71]
    v_cvt_pk_bf16_f32 v214, v68, v69
    v_cvt_pk_bf16_f32 v215, v70, v71
    ds_write_b64 v227, v[214:215] offset:32768
    s_waitcnt vmcnt(0) lgkmcnt(0)
    s_barrier
    s_mov_b32 s92, 0
    v_mov_b64 v[0:1], 0
    v_mov_b64 v[2:3], 0
    v_mov_b64 v[4:5], 0
    v_mov_b64 v[6:7], 0
    v_mov_b64 v[8:9], 0
    v_mov_b64 v[10:11], 0
    v_mov_b64 v[12:13], 0
    v_mov_b64 v[14:15], 0
    v_mov_b64 v[16:17], 0
    v_mov_b64 v[18:19], 0
    v_mov_b64 v[20:21], 0
    v_mov_b64 v[22:23], 0
    v_mov_b64 v[24:25], 0
    v_mov_b64 v[26:27], 0
    v_mov_b64 v[28:29], 0
    v_mov_b64 v[30:31], 0
    v_mov_b64 v[32:33], 0
    v_mov_b64 v[34:35], 0
    v_mov_b64 v[36:37], 0
    v_mov_b64 v[38:39], 0
    v_mov_b64 v[40:41], 0
    v_mov_b64 v[42:43], 0
    v_mov_b64 v[44:45], 0
    v_mov_b64 v[46:47], 0
    v_mov_b64 v[48:49], 0
    v_mov_b64 v[50:51], 0
    v_mov_b64 v[52:53], 0
    v_mov_b64 v[54:55], 0
    v_mov_b64 v[56:57], 0
    v_mov_b64 v[58:59], 0
    v_mov_b64 v[60:61], 0
    v_mov_b64 v[62:63], 0
    v_mov_b64 v[64:65], 0
    v_mov_b64 v[66:67], 0
    v_mov_b64 v[68:69], 0
    v_mov_b64 v[70:71], 0
    v_mov_b32 v228, 0
    v_mov_b32 v229, 0
L_a_head:

    s_cmp_eq_u32 s92, 0
    s_mov_b32 s50, 124928
    s_cselect_b32 s50, 69632, s50
    s_lshl_b32 s47, s46, 13
    s_add_u32 s47, s47, s50
    v_and_b32 v243, 31, v238
    v_lshlrev_b32 v243, 8, v243
    v_add_u32 v243, s47, v243
    v_lshrrev_b32 v244, 5, v238
    v_and_b32 v245, 15, v238
    v_xor_b32 v244, v244, v245
    v_lshl_add_u32 v243, v244, 4, v243

    v_xor_b32 v244, 0, v243
    ds_read_b128 v[72:75], v244
    v_xor_b32 v244, 32, v243
    ds_read_b128 v[76:79], v244
    v_xor_b32 v244, 64, v243
    ds_read_b128 v[80:83], v244
    v_xor_b32 v244, 96, v243
    ds_read_b128 v[84:87], v244
    v_xor_b32 v244, 128, v243
    ds_read_b128 v[88:91], v244
    v_xor_b32 v244, 160, v243
    ds_read_b128 v[92:95], v244
    v_xor_b32 v244, 192, v243
    ds_read_b128 v[96:99], v244
    v_xor_b32 v244, 224, v243
    ds_read_b128 v[100:103], v244

    v_lshlrev_b32 v243, 8, v245
    s_add_u32 s50, s50, 32768
    v_add_u32 v243, s50, v243
    v_lshrrev_b32 v244, 4, v238
    v_xor_b32 v244, v244, v245
    v_lshl_add_u32 v243, v244, 4, v243

    v_xor_b32 v244, 0, v243
    ds_read_b128 v[104:107], v244
    v_xor_b32 v244, 64, v243
    ds_read_b128 v[108:111], v244
    v_xor_b32 v244, 128, v243
    ds_read_b128 v[112:115], v244
    v_xor_b32 v244, 192, v243
    ds_read_b128 v[116:119], v244

    s_waitcnt lgkmcnt(0)
    s_cmp_lt_u32 s46, 2
    s_cbranch_scc1 L_a_pre_l

    ds_read_b128 v[172:175], v230 offset:52224
    ds_read_b128 v[176:179], v231 offset:52224
    ds_read_b128 v[180:183], v230 offset:52288
    ds_read_b128 v[184:187], v231 offset:52288
    ds_read_b128 v[188:191], v230 offset:52352
    ds_read_b128 v[192:195], v231 offset:52352
    ds_read_b128 v[196:199], v230 offset:52416
    ds_read_b128 v[200:203], v231 offset:52416
    s_waitcnt lgkmcnt(7)
    v_mfma_f32_32x32x16_bf16 v[120:135], v[172:175], v[72:75], 0
    s_waitcnt lgkmcnt(6)
    v_mfma_f32_32x32x16_bf16 v[120:135], v[176:179], v[76:79], v[120:135]
    s_waitcnt lgkmcnt(5)
    v_mfma_f32_32x32x16_bf16 v[120:135], v[180:183], v[80:83], v[120:135]
    s_waitcnt lgkmcnt(4)
    v_mfma_f32_32x32x16_bf16 v[120:135], v[184:187], v[84:87], v[120:135]
    s_waitcnt lgkmcnt(3)
    v_mfma_f32_32x32x16_bf16 v[120:135], v[188:191], v[88:91], v[120:135]
    s_waitcnt lgkmcnt(2)
    v_mfma_f32_32x32x16_bf16 v[120:135], v[192:195], v[92:95], v[120:135]
    s_waitcnt lgkmcnt(1)
    v_mfma_f32_32x32x16_bf16 v[120:135], v[196:199], v[96:99], v[120:135]
    s_waitcnt lgkmcnt(0)
    v_mfma_f32_32x32x16_bf16 v[120:135], v[200:203], v[100:103], v[120:135]
    v_mov_b64 v[188:189], 0
    v_mov_b64 v[190:191], 0
    v_mov_b64 v[192:193], 0
    v_mov_b64 v[194:195], 0
    v_mov_b64 v[196:197], 0
    v_mov_b64 v[198:199], 0
    v_mov_b64 v[200:201], 0
    v_mov_b64 v[202:203], 0
    v_mov_b64 v[220:221], 0
    v_mov_b64 v[222:223], 0
    v_mov_b64 v[224:225], 0
    v_mov_b64 v[226:227], 0
    v_mov_b64 v[160:161], 0
    v_mov_b64 v[162:163], 0
    v_mov_b64 v[164:165], 0
    v_mov_b64 v[166:167], 0
    s_branch L_a_pre_e
L_a_pre_l:
    ds_read_b128 v[172:175], v230 offset:52224
    ds_read_b128 v[176:179], v231 offset:52224
    ds_read_b128 v[180:183], v230 offset:52288
    ds_read_b128 v[184:187], v231 offset:52288
    ds_read_b128 v[188:191], v230 offset:52352
    ds_read_b128 v[192:195], v231 offset:52352
    ds_read_b128 v[196:199], v230 offset:52416
    ds_read_b128 v[200:203], v231 offset:52416
    ds_read_b128 v[204:207], v232 offset:52224
    ds_read_b128 v[208:211], v232 offset:52288
    ds_read_b128 v[212:215], v232 offset:52352
    ds_read_b128 v[216:219], v232 offset:52416
    s_waitcnt lgkmcnt(0)
    v_mfma_f32_16x16x32_bf16 v[152:155], v[204:207], v[104:107], 0
    v_mfma_f32_16x16x32_bf16 v[152:155], v[208:211], v[108:111], v[152:155]
    v_mfma_f32_16x16x32_bf16 v[152:155], v[212:215], v[112:115], v[152:155]
    v_mfma_f32_16x16x32_bf16 v[152:155], v[216:219], v[116:119], v[152:155]
    s_waitcnt lgkmcnt(11)
    v_mfma_f32_32x32x16_bf16 v[120:135], v[172:175], v[72:75], 0
    s_waitcnt lgkmcnt(10)
    v_mfma_f32_32x32x16_bf16 v[120:135], v[176:179], v[76:79], v[120:135]
    s_waitcnt lgkmcnt(9)
    v_mfma_f32_32x32x16_bf16 v[120:135], v[180:183], v[80:83], v[120:135]
    s_waitcnt lgkmcnt(8)
    v_mfma_f32_32x32x16_bf16 v[120:135], v[184:187], v[84:87], v[120:135]
    s_waitcnt lgkmcnt(7)
    v_mfma_f32_32x32x16_bf16 v[120:135], v[188:191], v[88:91], v[120:135]
    s_waitcnt lgkmcnt(6)
    v_mfma_f32_32x32x16_bf16 v[120:135], v[192:195], v[92:95], v[120:135]
    s_waitcnt lgkmcnt(5)
    v_mfma_f32_32x32x16_bf16 v[120:135], v[196:199], v[96:99], v[120:135]
    s_waitcnt lgkmcnt(4)
    v_mfma_f32_32x32x16_bf16 v[120:135], v[200:203], v[100:103], v[120:135]
    v_exp_f32 v152, v152
    v_exp_f32 v153, v153
    v_exp_f32 v154, v154
    v_exp_f32 v155, v155
    v_cvt_pk_bf16_f32 v168, v152, v153
    v_cvt_pk_bf16_f32 v169, v154, v155
    ds_write_b64 v242, v[168:169] offset:0
    v_add_f32 v229, v229, v152
    v_add_f32 v229, v229, v153
    v_add_f32 v229, v229, v154
    v_add_f32 v229, v229, v155
    v_mov_b64 v[188:189], 0
    v_mov_b64 v[190:191], 0
    v_mov_b64 v[192:193], 0
    v_mov_b64 v[194:195], 0
    v_mov_b64 v[196:197], 0
    v_mov_b64 v[198:199], 0
    v_mov_b64 v[200:201], 0
    v_mov_b64 v[202:203], 0
    v_mov_b64 v[220:221], 0
    v_mov_b64 v[222:223], 0
    v_mov_b64 v[224:225], 0
    v_mov_b64 v[226:227], 0
    v_mov_b64 v[160:161], 0
    v_mov_b64 v[162:163], 0
    v_mov_b64 v[164:165], 0
    v_mov_b64 v[166:167], 0
L_a_pre_e:
    s_mov_b32 s91, 0
    s_waitcnt lgkmcnt(0)
L_a_tick:
    s_barrier
    s_cmp_ge_u32 s46, 2
    s_cbranch_scc1 L_a_tl_0
    ds_read_b128 v[172:175], v230 offset:0
    ds_read_b128 v[176:179], v231 offset:0
    ds_read_b128 v[180:183], v230 offset:64
    ds_read_b128 v[184:187], v231 offset:64
    v_mfma_f32_32x32x16_bf16 v[0:15], v[188:191], v[160:163], v[0:15]
    ds_read_b128 v[188:191], v230 offset:128
    v_exp_f32 v120, v120
    v_exp_f32 v121, v121
    v_mfma_f32_32x32x16_bf16 v[16:31], v[192:195], v[160:163], v[16:31]
    ds_read_b128 v[192:195], v231 offset:128
    v_exp_f32 v122, v122
    v_exp_f32 v123, v123
    v_mfma_f32_32x32x16_bf16 v[32:47], v[196:199], v[160:163], v[32:47]
    ds_read_b128 v[196:199], v230 offset:192
    v_exp_f32 v124, v124
    v_exp_f32 v125, v125
    v_mfma_f32_32x32x16_bf16 v[48:63], v[200:203], v[160:163], v[48:63]
    ds_read_b128 v[200:203], v231 offset:192
    v_exp_f32 v126, v126
    v_exp_f32 v127, v127
    v_mfma_f32_16x16x32_bf16 v[64:67], v[220:223], v[164:167], v[64:67]
    v_mfma_f32_16x16x32_bf16 v[68:71], v[224:227], v[164:167], v[68:71]
    ds_read_b128 v[164:167], v241 offset:0
    ds_read_b64_tr_b16 v[220:221], v234 offset:0
    ds_read_b64_tr_b16 v[222:223], v234 offset:4352
    ds_read_b64_tr_b16 v[224:225], v235 offset:0
    ds_read_b64_tr_b16 v[226:227], v235 offset:4352
    s_waitcnt lgkmcnt(9)
    v_mfma_f32_32x32x16_bf16 v[136:151], v[172:175], v[72:75], 0
    ds_read_b64_tr_b16 v[172:173], v233 offset:0
    ds_read_b64_tr_b16 v[174:175], v233 offset:512
    v_exp_f32 v128, v128
    v_cvt_pk_bf16_f32 v156, v120, v121
    v_mfma_f32_32x32x16_bf16 v[136:151], v[176:179], v[76:79], v[136:151]
    ds_read_b64_tr_b16 v[176:177], v233 offset:64
    ds_read_b64_tr_b16 v[178:179], v233 offset:576
    v_exp_f32 v129, v129
    v_cvt_pk_bf16_f32 v157, v122, v123
    v_mfma_f32_32x32x16_bf16 v[136:151], v[180:183], v[80:83], v[136:151]
    ds_read_b64_tr_b16 v[180:181], v233 offset:128
    ds_read_b64_tr_b16 v[182:183], v233 offset:640
    v_exp_f32 v130, v130
    v_cvt_pk_bf16_f32 v158, v124, v125
    v_mfma_f32_32x32x16_bf16 v[136:151], v[184:187], v[84:87], v[136:151]
    ds_read_b64_tr_b16 v[184:185], v233 offset:192
    ds_read_b64_tr_b16 v[186:187], v233 offset:704
    v_exp_f32 v131, v131
    v_cvt_pk_bf16_f32 v159, v126, v127
    s_waitcnt lgkmcnt(13)
    v_mfma_f32_32x32x16_bf16 v[136:151], v[188:191], v[88:91], v[136:151]
    ds_read_b64_tr_b16 v[188:189], v233 offset:4352
    ds_read_b64_tr_b16 v[190:191], v233 offset:4864
    v_exp_f32 v132, v132
    v_exp_f32 v133, v133
    v_mfma_f32_32x32x16_bf16 v[136:151], v[192:195], v[92:95], v[136:151]
    ds_read_b64_tr_b16 v[192:193], v233 offset:4416
    ds_read_b64_tr_b16 v[194:195], v233 offset:4928
    v_exp_f32 v134, v134
    v_exp_f32 v135, v135
    v_mfma_f32_32x32x16_bf16 v[136:151], v[196:199], v[96:99], v[136:151]
    ds_read_b64_tr_b16 v[196:197], v233 offset:4480
    ds_read_b64_tr_b16 v[198:199], v233 offset:4992
    v_cvt_pk_bf16_f32 v160, v128, v129
    v_cvt_pk_bf16_f32 v161, v130, v131
    v_mfma_f32_32x32x16_bf16 v[136:151], v[200:203], v[100:103], v[136:151]
    ds_read_b64_tr_b16 v[200:201], v233 offset:4544
    ds_read_b64_tr_b16 v[202:203], v233 offset:5056
    v_cvt_pk_bf16_f32 v162, v132, v133
    v_cvt_pk_bf16_f32 v163, v134, v135
    s_waitcnt lgkmcnt(8)
    v_mfma_f32_32x32x16_bf16 v[0:15], v[172:175], v[156:159], v[0:15]
    v_add_f32 v228, v228, v120
    v_add_f32 v228, v228, v121
    v_add_f32 v228, v228, v122
    v_add_f32 v228, v228, v123
    v_mfma_f32_32x32x16_bf16 v[16:31], v[176:179], v[156:159], v[16:31]
    v_add_f32 v228, v228, v124
    v_add_f32 v228, v228, v125
    v_add_f32 v228, v228, v126
    v_add_f32 v228, v228, v127
    v_mfma_f32_32x32x16_bf16 v[32:47], v[180:183], v[156:159], v[32:47]
    v_add_f32 v228, v228, v128
    v_add_f32 v228, v228, v129
    v_add_f32 v228, v228, v130
    v_add_f32 v228, v228, v131
    v_mfma_f32_32x32x16_bf16 v[48:63], v[184:187], v[156:159], v[48:63]
    v_add_f32 v228, v228, v132
    v_add_f32 v228, v228, v133
    v_add_f32 v228, v228, v134
    v_add_f32 v228, v228, v135
    s_branch L_a_te_0
L_a_tl_0:
    ds_read_b128 v[172:175], v230 offset:0
    ds_read_b128 v[176:179], v231 offset:0
    ds_read_b128 v[180:183], v230 offset:64
    ds_read_b128 v[184:187], v231 offset:64
    ds_read_b128 v[204:207], v232 offset:0
    ds_read_b128 v[208:211], v232 offset:64
    ds_read_b128 v[212:215], v232 offset:128
    ds_read_b128 v[216:219], v232 offset:192
    v_mfma_f32_32x32x16_bf16 v[0:15], v[188:191], v[160:163], v[0:15]
    ds_read_b128 v[188:191], v230 offset:128
    v_exp_f32 v120, v120
    v_exp_f32 v121, v121
    v_mfma_f32_32x32x16_bf16 v[16:31], v[192:195], v[160:163], v[16:31]
    ds_read_b128 v[192:195], v231 offset:128
    v_exp_f32 v122, v122
    v_exp_f32 v123, v123
    v_mfma_f32_32x32x16_bf16 v[32:47], v[196:199], v[160:163], v[32:47]
    ds_read_b128 v[196:199], v230 offset:192
    v_exp_f32 v124, v124
    v_exp_f32 v125, v125
    v_mfma_f32_32x32x16_bf16 v[48:63], v[200:203], v[160:163], v[48:63]
    ds_read_b128 v[200:203], v231 offset:192
    v_exp_f32 v126, v126
    v_exp_f32 v127, v127
    v_mfma_f32_16x16x32_bf16 v[64:67], v[220:223], v[164:167], v[64:67]
    v_mfma_f32_16x16x32_bf16 v[68:71], v[224:227], v[164:167], v[68:71]
    s_waitcnt lgkmcnt(4)
    v_mfma_f32_16x16x32_bf16 v[152:155], v[204:207], v[104:107], 0
    v_mfma_f32_16x16x32_bf16 v[152:155], v[208:211], v[108:111], v[152:155]
    ds_read_b128 v[164:167], v241 offset:0
    v_mfma_f32_16x16x32_bf16 v[152:155], v[212:215], v[112:115], v[152:155]
    ds_read_b64_tr_b16 v[220:221], v234 offset:0
    ds_read_b64_tr_b16 v[222:223], v234 offset:4352
    v_mfma_f32_16x16x32_bf16 v[152:155], v[216:219], v[116:119], v[152:155]
    ds_read_b64_tr_b16 v[224:225], v235 offset:0
    ds_read_b64_tr_b16 v[226:227], v235 offset:4352
    s_waitcnt lgkmcnt(13)
    v_mfma_f32_32x32x16_bf16 v[136:151], v[172:175], v[72:75], 0
    ds_read_b64_tr_b16 v[172:173], v233 offset:0
    ds_read_b64_tr_b16 v[174:175], v233 offset:512
    v_exp_f32 v128, v128
    v_cvt_pk_bf16_f32 v156, v120, v121
    v_mfma_f32_32x32x16_bf16 v[136:151], v[176:179], v[76:79], v[136:151]
    ds_read_b64_tr_b16 v[176:177], v233 offset:64
    ds_read_b64_tr_b16 v[178:179], v233 offset:576
    v_exp_f32 v129, v129
    v_cvt_pk_bf16_f32 v157, v122, v123
    v_mfma_f32_32x32x16_bf16 v[136:151], v[180:183], v[80:83], v[136:151]
    ds_read_b64_tr_b16 v[180:181], v233 offset:128
    ds_read_b64_tr_b16 v[182:183], v233 offset:640
    v_exp_f32 v130, v130
    v_cvt_pk_bf16_f32 v158, v124, v125
    v_mfma_f32_32x32x16_bf16 v[136:151], v[184:187], v[84:87], v[136:151]
    ds_read_b64_tr_b16 v[184:185], v233 offset:192
    ds_read_b64_tr_b16 v[186:187], v233 offset:704
    v_exp_f32 v131, v131
    v_cvt_pk_bf16_f32 v159, v126, v127
    s_waitcnt lgkmcnt(13)
    v_mfma_f32_32x32x16_bf16 v[136:151], v[188:191], v[88:91], v[136:151]
    ds_read_b64_tr_b16 v[188:189], v233 offset:4352
    ds_read_b64_tr_b16 v[190:191], v233 offset:4864
    v_exp_f32 v132, v132
    v_exp_f32 v133, v133
    v_mfma_f32_32x32x16_bf16 v[136:151], v[192:195], v[92:95], v[136:151]
    ds_read_b64_tr_b16 v[192:193], v233 offset:4416
    ds_read_b64_tr_b16 v[194:195], v233 offset:4928
    v_exp_f32 v134, v134
    v_exp_f32 v135, v135
    v_mfma_f32_32x32x16_bf16 v[136:151], v[196:199], v[96:99], v[136:151]
    ds_read_b64_tr_b16 v[196:197], v233 offset:4480
    ds_read_b64_tr_b16 v[198:199], v233 offset:4992
    v_cvt_pk_bf16_f32 v160, v128, v129
    v_cvt_pk_bf16_f32 v161, v130, v131
    v_mfma_f32_32x32x16_bf16 v[136:151], v[200:203], v[100:103], v[136:151]
    ds_read_b64_tr_b16 v[200:201], v233 offset:4544
    ds_read_b64_tr_b16 v[202:203], v233 offset:5056
    v_cvt_pk_bf16_f32 v162, v132, v133
    v_cvt_pk_bf16_f32 v163, v134, v135
    s_waitcnt lgkmcnt(8)
    v_mfma_f32_32x32x16_bf16 v[0:15], v[172:175], v[156:159], v[0:15]
    v_add_f32 v228, v228, v120
    v_add_f32 v228, v228, v121
    v_add_f32 v228, v228, v122
    v_add_f32 v228, v228, v123
    v_exp_f32 v152, v152
    v_exp_f32 v153, v153
    v_exp_f32 v154, v154
    v_mfma_f32_32x32x16_bf16 v[16:31], v[176:179], v[156:159], v[16:31]
    v_add_f32 v228, v228, v124
    v_add_f32 v228, v228, v125
    v_add_f32 v228, v228, v126
    v_add_f32 v228, v228, v127
    v_exp_f32 v155, v155
    v_cvt_pk_bf16_f32 v168, v152, v153
    v_cvt_pk_bf16_f32 v169, v154, v155
    v_mfma_f32_32x32x16_bf16 v[32:47], v[180:183], v[156:159], v[32:47]
    v_add_f32 v228, v228, v128
    v_add_f32 v228, v228, v129
    v_add_f32 v228, v228, v130
    v_add_f32 v228, v228, v131
    ds_write_b64 v242, v[168:169] offset:1024
    v_add_f32 v229, v229, v152
    v_add_f32 v229, v229, v153
    v_mfma_f32_32x32x16_bf16 v[48:63], v[184:187], v[156:159], v[48:63]
    v_add_f32 v228, v228, v132
    v_add_f32 v228, v228, v133
    v_add_f32 v228, v228, v134
    v_add_f32 v228, v228, v135
    v_add_f32 v229, v229, v154
    v_add_f32 v229, v229, v155
L_a_te_0:
    s_waitcnt lgkmcnt(0)
    s_barrier
    s_cmp_lt_u32 s46, 2
    s_cbranch_scc1 L_a_tl_1
    ds_read_b128 v[172:175], v230 offset:17408
    ds_read_b128 v[176:179], v231 offset:17408
    ds_read_b128 v[180:183], v230 offset:17472
    ds_read_b128 v[184:187], v231 offset:17472
    v_mfma_f32_32x32x16_bf16 v[0:15], v[188:191], v[160:163], v[0:15]
    ds_read_b128 v[188:191], v230 offset:17536
    v_exp_f32 v136, v136
    v_exp_f32 v137, v137
    v_mfma_f32_32x32x16_bf16 v[16:31], v[192:195], v[160:163], v[16:31]
    ds_read_b128 v[192:195], v231 offset:17536
    v_exp_f32 v138, v138
    v_exp_f32 v139, v139
    v_mfma_f32_32x32x16_bf16 v[32:47], v[196:199], v[160:163], v[32:47]
    ds_read_b128 v[196:199], v230 offset:17600
    v_exp_f32 v140, v140
    v_exp_f32 v141, v141
    v_mfma_f32_32x32x16_bf16 v[48:63], v[200:203], v[160:163], v[48:63]
    ds_read_b128 v[200:203], v231 offset:17600
    v_exp_f32 v142, v142
    v_exp_f32 v143, v143
    v_mfma_f32_16x16x32_bf16 v[64:67], v[220:223], v[164:167], v[64:67]
    v_mfma_f32_16x16x32_bf16 v[68:71], v[224:227], v[164:167], v[68:71]
    ds_read_b128 v[164:167], v241 offset:1024
    ds_read_b64_tr_b16 v[220:221], v234 offset:17408
    ds_read_b64_tr_b16 v[222:223], v234 offset:21760
    ds_read_b64_tr_b16 v[224:225], v235 offset:17408
    ds_read_b64_tr_b16 v[226:227], v235 offset:21760
    s_waitcnt lgkmcnt(9)
    v_mfma_f32_32x32x16_bf16 v[120:135], v[172:175], v[72:75], 0
    ds_read_b64_tr_b16 v[172:173], v233 offset:17408
    ds_read_b64_tr_b16 v[174:175], v233 offset:17920
    v_exp_f32 v144, v144
    v_cvt_pk_bf16_f32 v156, v136, v137
    v_mfma_f32_32x32x16_bf16 v[120:135], v[176:179], v[76:79], v[120:135]
    ds_read_b64_tr_b16 v[176:177], v233 offset:17472
    ds_read_b64_tr_b16 v[178:179], v233 offset:17984
    v_exp_f32 v145, v145
    v_cvt_pk_bf16_f32 v157, v138, v139
    v_mfma_f32_32x32x16_bf16 v[120:135], v[180:183], v[80:83], v[120:135]
    ds_read_b64_tr_b16 v[180:181], v233 offset:17536
    ds_read_b64_tr_b16 v[182:183], v233 offset:18048
    v_exp_f32 v146, v146
    v_cvt_pk_bf16_f32 v158, v140, v141
    v_mfma_f32_32x32x16_bf16 v[120:135], v[184:187], v[84:87], v[120:135]
    ds_read_b64_tr_b16 v[184:185], v233 offset:17600
    ds_read_b64_tr_b16 v[186:187], v233 offset:18112
    v_exp_f32 v147, v147
    v_cvt_pk_bf16_f32 v159, v142, v143
    s_waitcnt lgkmcnt(13)
    v_mfma_f32_32x32x16_bf16 v[120:135], v[188:191], v[88:91], v[120:135]
    ds_read_b64_tr_b16 v[188:189], v233 offset:21760
    ds_read_b64_tr_b16 v[190:191], v233 offset:22272
    v_exp_f32 v148, v148
    v_exp_f32 v149, v149
    v_mfma_f32_32x32x16_bf16 v[120:135], v[192:195], v[92:95], v[120:135]
    ds_read_b64_tr_b16 v[192:193], v233 offset:21824
    ds_read_b64_tr_b16 v[194:195], v233 offset:22336
    v_exp_f32 v150, v150
    v_exp_f32 v151, v151
    v_mfma_f32_32x32x16_bf16 v[120:135], v[196:199], v[96:99], v[120:135]
    ds_read_b64_tr_b16 v[196:197], v233 offset:21888
    ds_read_b64_tr_b16 v[198:199], v233 offset:22400
    v_cvt_pk_bf16_f32 v160, v144, v145
    v_cvt_pk_bf16_f32 v161, v146, v147
    v_mfma_f32_32x32x16_bf16 v[120:135], v[200:203], v[100:103], v[120:135]
    ds_read_b64_tr_b16 v[200:201], v233 offset:21952
    ds_read_b64_tr_b16 v[202:203], v233 offset:22464
    v_cvt_pk_bf16_f32 v162, v148, v149
    v_cvt_pk_bf16_f32 v163, v150, v151
    s_waitcnt lgkmcnt(8)
    v_mfma_f32_32x32x16_bf16 v[0:15], v[172:175], v[156:159], v[0:15]
    v_add_f32 v228, v228, v136
    v_add_f32 v228, v228, v137
    v_add_f32 v228, v228, v138
    v_add_f32 v228, v228, v139
    v_mfma_f32_32x32x16_bf16 v[16:31], v[176:179], v[156:159], v[16:31]
    v_add_f32 v228, v228, v140
    v_add_f32 v228, v228, v141
    v_add_f32 v228, v228, v142
    v_add_f32 v228, v228, v143
    v_mfma_f32_32x32x16_bf16 v[32:47], v[180:183], v[156:159], v[32:47]
    v_add_f32 v228, v228, v144
    v_add_f32 v228, v228, v145
    v_add_f32 v228, v228, v146
    v_add_f32 v228, v228, v147
    v_mfma_f32_32x32x16_bf16 v[48:63], v[184:187], v[156:159], v[48:63]
    v_add_f32 v228, v228, v148
    v_add_f32 v228, v228, v149
    v_add_f32 v228, v228, v150
    v_add_f32 v228, v228, v151
    s_branch L_a_te_1
L_a_tl_1:
    ds_read_b128 v[172:175], v230 offset:17408
    ds_read_b128 v[176:179], v231 offset:17408
    ds_read_b128 v[180:183], v230 offset:17472
    ds_read_b128 v[184:187], v231 offset:17472
    ds_read_b128 v[204:207], v232 offset:17408
    ds_read_b128 v[208:211], v232 offset:17472
    ds_read_b128 v[212:215], v232 offset:17536
    ds_read_b128 v[216:219], v232 offset:17600
    v_mfma_f32_32x32x16_bf16 v[0:15], v[188:191], v[160:163], v[0:15]
    ds_read_b128 v[188:191], v230 offset:17536
    v_exp_f32 v136, v136
    v_exp_f32 v137, v137
    v_mfma_f32_32x32x16_bf16 v[16:31], v[192:195], v[160:163], v[16:31]
    ds_read_b128 v[192:195], v231 offset:17536
    v_exp_f32 v138, v138
    v_exp_f32 v139, v139
    v_mfma_f32_32x32x16_bf16 v[32:47], v[196:199], v[160:163], v[32:47]
    ds_read_b128 v[196:199], v230 offset:17600
    v_exp_f32 v140, v140
    v_exp_f32 v141, v141
    v_mfma_f32_32x32x16_bf16 v[48:63], v[200:203], v[160:163], v[48:63]
    ds_read_b128 v[200:203], v231 offset:17600
    v_exp_f32 v142, v142
    v_exp_f32 v143, v143
    v_mfma_f32_16x16x32_bf16 v[64:67], v[220:223], v[164:167], v[64:67]
    v_mfma_f32_16x16x32_bf16 v[68:71], v[224:227], v[164:167], v[68:71]
    s_waitcnt lgkmcnt(4)
    v_mfma_f32_16x16x32_bf16 v[152:155], v[204:207], v[104:107], 0
    v_mfma_f32_16x16x32_bf16 v[152:155], v[208:211], v[108:111], v[152:155]
    ds_read_b128 v[164:167], v241 offset:1024
    v_mfma_f32_16x16x32_bf16 v[152:155], v[212:215], v[112:115], v[152:155]
    ds_read_b64_tr_b16 v[220:221], v234 offset:17408
    ds_read_b64_tr_b16 v[222:223], v234 offset:21760
    v_mfma_f32_16x16x32_bf16 v[152:155], v[216:219], v[116:119], v[152:155]
    ds_read_b64_tr_b16 v[224:225], v235 offset:17408
    ds_read_b64_tr_b16 v[226:227], v235 offset:21760
    s_waitcnt lgkmcnt(13)
    v_mfma_f32_32x32x16_bf16 v[120:135], v[172:175], v[72:75], 0
    ds_read_b64_tr_b16 v[172:173], v233 offset:17408
    ds_read_b64_tr_b16 v[174:175], v233 offset:17920
    v_exp_f32 v144, v144
    v_cvt_pk_bf16_f32 v156, v136, v137
    v_mfma_f32_32x32x16_bf16 v[120:135], v[176:179], v[76:79], v[120:135]
    ds_read_b64_tr_b16 v[176:177], v233 offset:17472
    ds_read_b64_tr_b16 v[178:179], v233 offset:17984
    v_exp_f32 v145, v145
    v_cvt_pk_bf16_f32 v157, v138, v139
    v_mfma_f32_32x32x16_bf16 v[120:135], v[180:183], v[80:83], v[120:135]
    ds_read_b64_tr_b16 v[180:181], v233 offset:17536
    ds_read_b64_tr_b16 v[182:183], v233 offset:18048
    v_exp_f32 v146, v146
    v_cvt_pk_bf16_f32 v158, v140, v141
    v_mfma_f32_32x32x16_bf16 v[120:135], v[184:187], v[84:87], v[120:135]
    ds_read_b64_tr_b16 v[184:185], v233 offset:17600
    ds_read_b64_tr_b16 v[186:187], v233 offset:18112
    v_exp_f32 v147, v147
    v_cvt_pk_bf16_f32 v159, v142, v143
    s_waitcnt lgkmcnt(13)
    v_mfma_f32_32x32x16_bf16 v[120:135], v[188:191], v[88:91], v[120:135]
    ds_read_b64_tr_b16 v[188:189], v233 offset:21760
    ds_read_b64_tr_b16 v[190:191], v233 offset:22272
    v_exp_f32 v148, v148
    v_exp_f32 v149, v149
    v_mfma_f32_32x32x16_bf16 v[120:135], v[192:195], v[92:95], v[120:135]
    ds_read_b64_tr_b16 v[192:193], v233 offset:21824
    ds_read_b64_tr_b16 v[194:195], v233 offset:22336
    v_exp_f32 v150, v150
    v_exp_f32 v151, v151
    v_mfma_f32_32x32x16_bf16 v[120:135], v[196:199], v[96:99], v[120:135]
    ds_read_b64_tr_b16 v[196:197], v233 offset:21888
    ds_read_b64_tr_b16 v[198:199], v233 offset:22400
    v_cvt_pk_bf16_f32 v160, v144, v145
    v_cvt_pk_bf16_f32 v161, v146, v147
    v_mfma_f32_32x32x16_bf16 v[120:135], v[200:203], v[100:103], v[120:135]
    ds_read_b64_tr_b16 v[200:201], v233 offset:21952
    ds_read_b64_tr_b16 v[202:203], v233 offset:22464
    v_cvt_pk_bf16_f32 v162, v148, v149
    v_cvt_pk_bf16_f32 v163, v150, v151
    s_waitcnt lgkmcnt(8)
    v_mfma_f32_32x32x16_bf16 v[0:15], v[172:175], v[156:159], v[0:15]
    v_add_f32 v228, v228, v136
    v_add_f32 v228, v228, v137
    v_add_f32 v228, v228, v138
    v_add_f32 v228, v228, v139
    v_exp_f32 v152, v152
    v_exp_f32 v153, v153
    v_exp_f32 v154, v154
    v_mfma_f32_32x32x16_bf16 v[16:31], v[176:179], v[156:159], v[16:31]
    v_add_f32 v228, v228, v140
    v_add_f32 v228, v228, v141
    v_add_f32 v228, v228, v142
    v_add_f32 v228, v228, v143
    v_exp_f32 v155, v155
    v_cvt_pk_bf16_f32 v168, v152, v153
    v_cvt_pk_bf16_f32 v169, v154, v155
    v_mfma_f32_32x32x16_bf16 v[32:47], v[180:183], v[156:159], v[32:47]
    v_add_f32 v228, v228, v144
    v_add_f32 v228, v228, v145
    v_add_f32 v228, v228, v146
    v_add_f32 v228, v228, v147
    ds_write_b64 v242, v[168:169] offset:0
    v_add_f32 v229, v229, v152
    v_add_f32 v229, v229, v153
    v_mfma_f32_32x32x16_bf16 v[48:63], v[184:187], v[156:159], v[48:63]
    v_add_f32 v228, v228, v148
    v_add_f32 v228, v228, v149
    v_add_f32 v228, v228, v150
    v_add_f32 v228, v228, v151
    v_add_f32 v229, v229, v154
    v_add_f32 v229, v229, v155
L_a_te_1:
    s_waitcnt vmcnt(0) lgkmcnt(0)
    s_barrier
    s_cmp_ge_u32 s46, 2
    s_cbranch_scc1 L_a_tl_2
    ds_read_b128 v[172:175], v230 offset:34816
    ds_read_b128 v[176:179], v231 offset:34816
    ds_read_b128 v[180:183], v230 offset:34880
    ds_read_b128 v[184:187], v231 offset:34880
    v_mfma_f32_32x32x16_bf16 v[0:15], v[188:191], v[160:163], v[0:15]
    ds_read_b128 v[188:191], v230 offset:34944
    v_exp_f32 v120, v120
    v_exp_f32 v121, v121
    v_mfma_f32_32x32x16_bf16 v[16:31], v[192:195], v[160:163], v[16:31]
    ds_read_b128 v[192:195], v231 offset:34944
    v_exp_f32 v122, v122
    v_exp_f32 v123, v123
    v_mfma_f32_32x32x16_bf16 v[32:47], v[196:199], v[160:163], v[32:47]
    ds_read_b128 v[196:199], v230 offset:35008
    v_exp_f32 v124, v124
    v_exp_f32 v125, v125
    v_mfma_f32_32x32x16_bf16 v[48:63], v[200:203], v[160:163], v[48:63]
    ds_read_b128 v[200:203], v231 offset:35008
    v_exp_f32 v126, v126
    v_exp_f32 v127, v127
    v_mfma_f32_16x16x32_bf16 v[64:67], v[220:223], v[164:167], v[64:67]
    v_mfma_f32_16x16x32_bf16 v[68:71], v[224:227], v[164:167], v[68:71]
    ds_read_b128 v[164:167], v241 offset:0
    ds_read_b64_tr_b16 v[220:221], v234 offset:34816
    ds_read_b64_tr_b16 v[222:223], v234 offset:39168
    ds_read_b64_tr_b16 v[224:225], v235 offset:34816
    ds_read_b64_tr_b16 v[226:227], v235 offset:39168
    s_waitcnt lgkmcnt(9)
    v_mfma_f32_32x32x16_bf16 v[136:151], v[172:175], v[72:75], 0
    ds_read_b64_tr_b16 v[172:173], v233 offset:34816
    ds_read_b64_tr_b16 v[174:175], v233 offset:35328
    v_exp_f32 v128, v128
    v_cvt_pk_bf16_f32 v156, v120, v121
    v_mfma_f32_32x32x16_bf16 v[136:151], v[176:179], v[76:79], v[136:151]
    ds_read_b64_tr_b16 v[176:177], v233 offset:34880
    ds_read_b64_tr_b16 v[178:179], v233 offset:35392
    v_exp_f32 v129, v129
    v_cvt_pk_bf16_f32 v157, v122, v123
    v_mfma_f32_32x32x16_bf16 v[136:151], v[180:183], v[80:83], v[136:151]
    ds_read_b64_tr_b16 v[180:181], v233 offset:34944
    ds_read_b64_tr_b16 v[182:183], v233 offset:35456
    v_exp_f32 v130, v130
    v_cvt_pk_bf16_f32 v158, v124, v125
    v_mfma_f32_32x32x16_bf16 v[136:151], v[184:187], v[84:87], v[136:151]
    ds_read_b64_tr_b16 v[184:185], v233 offset:35008
    ds_read_b64_tr_b16 v[186:187], v233 offset:35520
    v_exp_f32 v131, v131
    v_cvt_pk_bf16_f32 v159, v126, v127
    s_waitcnt lgkmcnt(13)
    v_mfma_f32_32x32x16_bf16 v[136:151], v[188:191], v[88:91], v[136:151]
    ds_read_b64_tr_b16 v[188:189], v233 offset:39168
    ds_read_b64_tr_b16 v[190:191], v233 offset:39680
    v_exp_f32 v132, v132
    v_exp_f32 v133, v133
    v_mfma_f32_32x32x16_bf16 v[136:151], v[192:195], v[92:95], v[136:151]
    ds_read_b64_tr_b16 v[192:193], v233 offset:39232
    ds_read_b64_tr_b16 v[194:195], v233 offset:39744
    v_exp_f32 v134, v134
    v_exp_f32 v135, v135
    v_mfma_f32_32x32x16_bf16 v[136:151], v[196:199], v[96:99], v[136:151]
    ds_read_b64_tr_b16 v[196:197], v233 offset:39296
    ds_read_b64_tr_b16 v[198:199], v233 offset:39808
    v_cvt_pk_bf16_f32 v160, v128, v129
    v_cvt_pk_bf16_f32 v161, v130, v131
    v_mfma_f32_32x32x16_bf16 v[136:151], v[200:203], v[100:103], v[136:151]
    ds_read_b64_tr_b16 v[200:201], v233 offset:39360
    ds_read_b64_tr_b16 v[202:203], v233 offset:39872
    v_cvt_pk_bf16_f32 v162, v132, v133
    v_cvt_pk_bf16_f32 v163, v134, v135
    s_waitcnt lgkmcnt(8)
    v_mfma_f32_32x32x16_bf16 v[0:15], v[172:175], v[156:159], v[0:15]
    v_add_f32 v228, v228, v120
    v_add_f32 v228, v228, v121
    v_add_f32 v228, v228, v122
    v_add_f32 v228, v228, v123
    v_mfma_f32_32x32x16_bf16 v[16:31], v[176:179], v[156:159], v[16:31]
    v_add_f32 v228, v228, v124
    v_add_f32 v228, v228, v125
    v_add_f32 v228, v228, v126
    v_add_f32 v228, v228, v127
    v_mfma_f32_32x32x16_bf16 v[32:47], v[180:183], v[156:159], v[32:47]
    v_add_f32 v228, v228, v128
    v_add_f32 v228, v228, v129
    v_add_f32 v228, v228, v130
    v_add_f32 v228, v228, v131
    v_mfma_f32_32x32x16_bf16 v[48:63], v[184:187], v[156:159], v[48:63]
    v_add_f32 v228, v228, v132
    v_add_f32 v228, v228, v133
    v_add_f32 v228, v228, v134
    v_add_f32 v228, v228, v135
    s_branch L_a_te_2
L_a_tl_2:
    ds_read_b128 v[172:175], v230 offset:34816
    ds_read_b128 v[176:179], v231 offset:34816
    ds_read_b128 v[180:183], v230 offset:34880
    ds_read_b128 v[184:187], v231 offset:34880
    ds_read_b128 v[204:207], v232 offset:34816
    ds_read_b128 v[208:211], v232 offset:34880
    ds_read_b128 v[212:215], v232 offset:34944
    ds_read_b128 v[216:219], v232 offset:35008
    v_mfma_f32_32x32x16_bf16 v[0:15], v[188:191], v[160:163], v[0:15]
    ds_read_b128 v[188:191], v230 offset:34944
    v_exp_f32 v120, v120
    v_exp_f32 v121, v121
    v_mfma_f32_32x32x16_bf16 v[16:31], v[192:195], v[160:163], v[16:31]
    ds_read_b128 v[192:195], v231 offset:34944
    v_exp_f32 v122, v122
    v_exp_f32 v123, v123
    v_mfma_f32_32x32x16_bf16 v[32:47], v[196:199], v[160:163], v[32:47]
    ds_read_b128 v[196:199], v230 offset:35008
    v_exp_f32 v124, v124
    v_exp_f32 v125, v125
    v_mfma_f32_32x32x16_bf16 v[48:63], v[200:203], v[160:163], v[48:63]
    ds_read_b128 v[200:203], v231 offset:35008
    v_exp_f32 v126, v126
    v_exp_f32 v127, v127
    v_mfma_f32_16x16x32_bf16 v[64:67], v[220:223], v[164:167], v[64:67]
    v_mfma_f32_16x16x32_bf16 v[68:71], v[224:227], v[164:167], v[68:71]
    s_waitcnt lgkmcnt(4)
    v_mfma_f32_16x16x32_bf16 v[152:155], v[204:207], v[104:107], 0
    v_mfma_f32_16x16x32_bf16 v[152:155], v[208:211], v[108:111], v[152:155]
    ds_read_b128 v[164:167], v241 offset:0
    v_mfma_f32_16x16x32_bf16 v[152:155], v[212:215], v[112:115], v[152:155]
    ds_read_b64_tr_b16 v[220:221], v234 offset:34816
    ds_read_b64_tr_b16 v[222:223], v234 offset:39168
    v_mfma_f32_16x16x32_bf16 v[152:155], v[216:219], v[116:119], v[152:155]
    ds_read_b64_tr_b16 v[224:225], v235 offset:34816
    ds_read_b64_tr_b16 v[226:227], v235 offset:39168
    s_waitcnt lgkmcnt(13)
    v_mfma_f32_32x32x16_bf16 v[136:151], v[172:175], v[72:75], 0
    ds_read_b64_tr_b16 v[172:173], v233 offset:34816
    ds_read_b64_tr_b16 v[174:175], v233 offset:35328
    v_exp_f32 v128, v128
    v_cvt_pk_bf16_f32 v156, v120, v121
    v_mfma_f32_32x32x16_bf16 v[136:151], v[176:179], v[76:79], v[136:151]
    ds_read_b64_tr_b16 v[176:177], v233 offset:34880
    ds_read_b64_tr_b16 v[178:179], v233 offset:35392
    v_exp_f32 v129, v129
    v_cvt_pk_bf16_f32 v157, v122, v123
    v_mfma_f32_32x32x16_bf16 v[136:151], v[180:183], v[80:83], v[136:151]
    ds_read_b64_tr_b16 v[180:181], v233 offset:34944
    ds_read_b64_tr_b16 v[182:183], v233 offset:35456
    v_exp_f32 v130, v130
    v_cvt_pk_bf16_f32 v158, v124, v125
    v_mfma_f32_32x32x16_bf16 v[136:151], v[184:187], v[84:87], v[136:151]
    ds_read_b64_tr_b16 v[184:185], v233 offset:35008
    ds_read_b64_tr_b16 v[186:187], v233 offset:35520
    v_exp_f32 v131, v131
    v_cvt_pk_bf16_f32 v159, v126, v127
    s_waitcnt lgkmcnt(13)
    v_mfma_f32_32x32x16_bf16 v[136:151], v[188:191], v[88:91], v[136:151]
    ds_read_b64_tr_b16 v[188:189], v233 offset:39168
    ds_read_b64_tr_b16 v[190:191], v233 offset:39680
    v_exp_f32 v132, v132
    v_exp_f32 v133, v133
    v_mfma_f32_32x32x16_bf16 v[136:151], v[192:195], v[92:95], v[136:151]
    ds_read_b64_tr_b16 v[192:193], v233 offset:39232
    ds_read_b64_tr_b16 v[194:195], v233 offset:39744
    v_exp_f32 v134, v134
    v_exp_f32 v135, v135
    v_mfma_f32_32x32x16_bf16 v[136:151], v[196:199], v[96:99], v[136:151]
    ds_read_b64_tr_b16 v[196:197], v233 offset:39296
    ds_read_b64_tr_b16 v[198:199], v233 offset:39808
    v_cvt_pk_bf16_f32 v160, v128, v129
    v_cvt_pk_bf16_f32 v161, v130, v131
    v_mfma_f32_32x32x16_bf16 v[136:151], v[200:203], v[100:103], v[136:151]
    ds_read_b64_tr_b16 v[200:201], v233 offset:39360
    ds_read_b64_tr_b16 v[202:203], v233 offset:39872
    v_cvt_pk_bf16_f32 v162, v132, v133
    v_cvt_pk_bf16_f32 v163, v134, v135
    s_waitcnt lgkmcnt(8)
    v_mfma_f32_32x32x16_bf16 v[0:15], v[172:175], v[156:159], v[0:15]
    v_add_f32 v228, v228, v120
    v_add_f32 v228, v228, v121
    v_add_f32 v228, v228, v122
    v_add_f32 v228, v228, v123
    v_exp_f32 v152, v152
    v_exp_f32 v153, v153
    v_exp_f32 v154, v154
    v_mfma_f32_32x32x16_bf16 v[16:31], v[176:179], v[156:159], v[16:31]
    v_add_f32 v228, v228, v124
    v_add_f32 v228, v228, v125
    v_add_f32 v228, v228, v126
    v_add_f32 v228, v228, v127
    v_exp_f32 v155, v155
    v_cvt_pk_bf16_f32 v168, v152, v153
    v_cvt_pk_bf16_f32 v169, v154, v155
    v_mfma_f32_32x32x16_bf16 v[32:47], v[180:183], v[156:159], v[32:47]
    v_add_f32 v228, v228, v128
    v_add_f32 v228, v228, v129
    v_add_f32 v228, v228, v130
    v_add_f32 v228, v228, v131
    ds_write_b64 v242, v[168:169] offset:1024
    v_add_f32 v229, v229, v152
    v_add_f32 v229, v229, v153
    v_mfma_f32_32x32x16_bf16 v[48:63], v[184:187], v[156:159], v[48:63]
    v_add_f32 v228, v228, v132
    v_add_f32 v228, v228, v133
    v_add_f32 v228, v228, v134
    v_add_f32 v228, v228, v135
    v_add_f32 v229, v229, v154
    v_add_f32 v229, v229, v155
L_a_te_2:
    s_cmp_eq_u32 s91, 3
    s_cselect_b32 s95, 0, 2
    s_waitcnt lgkmcnt(0)
    s_barrier
    s_cmp_lt_u32 s46, s95
    s_cbranch_scc1 L_a_tl_3
    ds_read_b128 v[172:175], v230 offset:52224
    ds_read_b128 v[176:179], v231 offset:52224
    ds_read_b128 v[180:183], v230 offset:52288
    ds_read_b128 v[184:187], v231 offset:52288
    v_mfma_f32_32x32x16_bf16 v[0:15], v[188:191], v[160:163], v[0:15]
    ds_read_b128 v[188:191], v230 offset:52352
    v_exp_f32 v136, v136
    v_exp_f32 v137, v137
    v_mfma_f32_32x32x16_bf16 v[16:31], v[192:195], v[160:163], v[16:31]
    ds_read_b128 v[192:195], v231 offset:52352
    v_exp_f32 v138, v138
    v_exp_f32 v139, v139
    v_mfma_f32_32x32x16_bf16 v[32:47], v[196:199], v[160:163], v[32:47]
    ds_read_b128 v[196:199], v230 offset:52416
    v_exp_f32 v140, v140
    v_exp_f32 v141, v141
    v_mfma_f32_32x32x16_bf16 v[48:63], v[200:203], v[160:163], v[48:63]
    ds_read_b128 v[200:203], v231 offset:52416
    v_exp_f32 v142, v142
    v_exp_f32 v143, v143
    v_mfma_f32_16x16x32_bf16 v[64:67], v[220:223], v[164:167], v[64:67]
    v_mfma_f32_16x16x32_bf16 v[68:71], v[224:227], v[164:167], v[68:71]
    ds_read_b128 v[164:167], v241 offset:1024
    ds_read_b64_tr_b16 v[220:221], v234 offset:52224
    ds_read_b64_tr_b16 v[222:223], v234 offset:56576
    ds_read_b64_tr_b16 v[224:225], v235 offset:52224
    ds_read_b64_tr_b16 v[226:227], v235 offset:56576
    s_waitcnt lgkmcnt(9)
    v_mfma_f32_32x32x16_bf16 v[120:135], v[172:175], v[72:75], 0
    ds_read_b64_tr_b16 v[172:173], v233 offset:52224
    ds_read_b64_tr_b16 v[174:175], v233 offset:52736
    v_exp_f32 v144, v144
    v_cvt_pk_bf16_f32 v156, v136, v137
    v_mfma_f32_32x32x16_bf16 v[120:135], v[176:179], v[76:79], v[120:135]
    ds_read_b64_tr_b16 v[176:177], v233 offset:52288
    ds_read_b64_tr_b16 v[178:179], v233 offset:52800
    v_exp_f32 v145, v145
    v_cvt_pk_bf16_f32 v157, v138, v139
    v_mfma_f32_32x32x16_bf16 v[120:135], v[180:183], v[80:83], v[120:135]
    ds_read_b64_tr_b16 v[180:181], v233 offset:52352
    ds_read_b64_tr_b16 v[182:183], v233 offset:52864
    v_exp_f32 v146, v146
    v_cvt_pk_bf16_f32 v158, v140, v141
    v_mfma_f32_32x32x16_bf16 v[120:135], v[184:187], v[84:87], v[120:135]
    ds_read_b64_tr_b16 v[184:185], v233 offset:52416
    ds_read_b64_tr_b16 v[186:187], v233 offset:52928
    v_exp_f32 v147, v147
    v_cvt_pk_bf16_f32 v159, v142, v143
    s_waitcnt lgkmcnt(13)
    v_mfma_f32_32x32x16_bf16 v[120:135], v[188:191], v[88:91], v[120:135]
    ds_read_b64_tr_b16 v[188:189], v233 offset:56576
    ds_read_b64_tr_b16 v[190:191], v233 offset:57088
    v_exp_f32 v148, v148
    v_exp_f32 v149, v149
    v_mfma_f32_32x32x16_bf16 v[120:135], v[192:195], v[92:95], v[120:135]
    ds_read_b64_tr_b16 v[192:193], v233 offset:56640
    ds_read_b64_tr_b16 v[194:195], v233 offset:57152
    v_exp_f32 v150, v150
    v_exp_f32 v151, v151
    v_mfma_f32_32x32x16_bf16 v[120:135], v[196:199], v[96:99], v[120:135]
    ds_read_b64_tr_b16 v[196:197], v233 offset:56704
    ds_read_b64_tr_b16 v[198:199], v233 offset:57216
    v_cvt_pk_bf16_f32 v160, v144, v145
    v_cvt_pk_bf16_f32 v161, v146, v147
    v_mfma_f32_32x32x16_bf16 v[120:135], v[200:203], v[100:103], v[120:135]
    ds_read_b64_tr_b16 v[200:201], v233 offset:56768
    ds_read_b64_tr_b16 v[202:203], v233 offset:57280
    v_cvt_pk_bf16_f32 v162, v148, v149
    v_cvt_pk_bf16_f32 v163, v150, v151
    s_waitcnt lgkmcnt(8)
    v_mfma_f32_32x32x16_bf16 v[0:15], v[172:175], v[156:159], v[0:15]
    v_add_f32 v228, v228, v136
    v_add_f32 v228, v228, v137
    v_add_f32 v228, v228, v138
    v_add_f32 v228, v228, v139
    v_mfma_f32_32x32x16_bf16 v[16:31], v[176:179], v[156:159], v[16:31]
    v_add_f32 v228, v228, v140
    v_add_f32 v228, v228, v141
    v_add_f32 v228, v228, v142
    v_add_f32 v228, v228, v143
    v_mfma_f32_32x32x16_bf16 v[32:47], v[180:183], v[156:159], v[32:47]
    v_add_f32 v228, v228, v144
    v_add_f32 v228, v228, v145
    v_add_f32 v228, v228, v146
    v_add_f32 v228, v228, v147
    v_mfma_f32_32x32x16_bf16 v[48:63], v[184:187], v[156:159], v[48:63]
    v_add_f32 v228, v228, v148
    v_add_f32 v228, v228, v149
    v_add_f32 v228, v228, v150
    v_add_f32 v228, v228, v151
    s_branch L_a_te_3
L_a_tl_3:
    ds_read_b128 v[172:175], v230 offset:52224
    ds_read_b128 v[176:179], v231 offset:52224
    ds_read_b128 v[180:183], v230 offset:52288
    ds_read_b128 v[184:187], v231 offset:52288
    ds_read_b128 v[204:207], v232 offset:52224
    ds_read_b128 v[208:211], v232 offset:52288
    ds_read_b128 v[212:215], v232 offset:52352
    ds_read_b128 v[216:219], v232 offset:52416
    v_mfma_f32_32x32x16_bf16 v[0:15], v[188:191], v[160:163], v[0:15]
    ds_read_b128 v[188:191], v230 offset:52352
    v_exp_f32 v136, v136
    v_exp_f32 v137, v137
    v_mfma_f32_32x32x16_bf16 v[16:31], v[192:195], v[160:163], v[16:31]
    ds_read_b128 v[192:195], v231 offset:52352
    v_exp_f32 v138, v138
    v_exp_f32 v139, v139
    v_mfma_f32_32x32x16_bf16 v[32:47], v[196:199], v[160:163], v[32:47]
    ds_read_b128 v[196:199], v230 offset:52416
    v_exp_f32 v140, v140
    v_exp_f32 v141, v141
    v_mfma_f32_32x32x16_bf16 v[48:63], v[200:203], v[160:163], v[48:63]
    ds_read_b128 v[200:203], v231 offset:52416
    v_exp_f32 v142, v142
    v_exp_f32 v143, v143
    v_mfma_f32_16x16x32_bf16 v[64:67], v[220:223], v[164:167], v[64:67]
    v_mfma_f32_16x16x32_bf16 v[68:71], v[224:227], v[164:167], v[68:71]
    s_waitcnt lgkmcnt(4)
    v_mfma_f32_16x16x32_bf16 v[152:155], v[204:207], v[104:107], 0
    v_mfma_f32_16x16x32_bf16 v[152:155], v[208:211], v[108:111], v[152:155]
    ds_read_b128 v[164:167], v241 offset:1024
    v_mfma_f32_16x16x32_bf16 v[152:155], v[212:215], v[112:115], v[152:155]
    ds_read_b64_tr_b16 v[220:221], v234 offset:52224
    ds_read_b64_tr_b16 v[222:223], v234 offset:56576
    v_mfma_f32_16x16x32_bf16 v[152:155], v[216:219], v[116:119], v[152:155]
    ds_read_b64_tr_b16 v[224:225], v235 offset:52224
    ds_read_b64_tr_b16 v[226:227], v235 offset:56576
    s_waitcnt lgkmcnt(13)
    v_mfma_f32_32x32x16_bf16 v[120:135], v[172:175], v[72:75], 0
    ds_read_b64_tr_b16 v[172:173], v233 offset:52224
    ds_read_b64_tr_b16 v[174:175], v233 offset:52736
    v_exp_f32 v144, v144
    v_cvt_pk_bf16_f32 v156, v136, v137
    v_mfma_f32_32x32x16_bf16 v[120:135], v[176:179], v[76:79], v[120:135]
    ds_read_b64_tr_b16 v[176:177], v233 offset:52288
    ds_read_b64_tr_b16 v[178:179], v233 offset:52800
    v_exp_f32 v145, v145
    v_cvt_pk_bf16_f32 v157, v138, v139
    v_mfma_f32_32x32x16_bf16 v[120:135], v[180:183], v[80:83], v[120:135]
    ds_read_b64_tr_b16 v[180:181], v233 offset:52352
    ds_read_b64_tr_b16 v[182:183], v233 offset:52864
    v_exp_f32 v146, v146
    v_cvt_pk_bf16_f32 v158, v140, v141
    v_mfma_f32_32x32x16_bf16 v[120:135], v[184:187], v[84:87], v[120:135]
    ds_read_b64_tr_b16 v[184:185], v233 offset:52416
    ds_read_b64_tr_b16 v[186:187], v233 offset:52928
    v_exp_f32 v147, v147
    v_cvt_pk_bf16_f32 v159, v142, v143
    s_waitcnt lgkmcnt(13)
    v_mfma_f32_32x32x16_bf16 v[120:135], v[188:191], v[88:91], v[120:135]
    ds_read_b64_tr_b16 v[188:189], v233 offset:56576
    ds_read_b64_tr_b16 v[190:191], v233 offset:57088
    v_exp_f32 v148, v148
    v_exp_f32 v149, v149
    v_mfma_f32_32x32x16_bf16 v[120:135], v[192:195], v[92:95], v[120:135]
    ds_read_b64_tr_b16 v[192:193], v233 offset:56640
    ds_read_b64_tr_b16 v[194:195], v233 offset:57152
    v_exp_f32 v150, v150
    v_exp_f32 v151, v151
    v_mfma_f32_32x32x16_bf16 v[120:135], v[196:199], v[96:99], v[120:135]
    ds_read_b64_tr_b16 v[196:197], v233 offset:56704
    ds_read_b64_tr_b16 v[198:199], v233 offset:57216
    v_cvt_pk_bf16_f32 v160, v144, v145
    v_cvt_pk_bf16_f32 v161, v146, v147
    v_mfma_f32_32x32x16_bf16 v[120:135], v[200:203], v[100:103], v[120:135]
    ds_read_b64_tr_b16 v[200:201], v233 offset:56768
    ds_read_b64_tr_b16 v[202:203], v233 offset:57280
    v_cvt_pk_bf16_f32 v162, v148, v149
    v_cvt_pk_bf16_f32 v163, v150, v151
    s_waitcnt lgkmcnt(8)
    v_mfma_f32_32x32x16_bf16 v[0:15], v[172:175], v[156:159], v[0:15]
    v_add_f32 v228, v228, v136
    v_add_f32 v228, v228, v137
    v_add_f32 v228, v228, v138
    v_add_f32 v228, v228, v139
    v_exp_f32 v152, v152
    v_exp_f32 v153, v153
    v_exp_f32 v154, v154
    v_mfma_f32_32x32x16_bf16 v[16:31], v[176:179], v[156:159], v[16:31]
    v_add_f32 v228, v228, v140
    v_add_f32 v228, v228, v141
    v_add_f32 v228, v228, v142
    v_add_f32 v228, v228, v143
    v_exp_f32 v155, v155
    v_cvt_pk_bf16_f32 v168, v152, v153
    v_cvt_pk_bf16_f32 v169, v154, v155
    v_mfma_f32_32x32x16_bf16 v[32:47], v[180:183], v[156:159], v[32:47]
    v_add_f32 v228, v228, v144
    v_add_f32 v228, v228, v145
    v_add_f32 v228, v228, v146
    v_add_f32 v228, v228, v147
    ds_write_b64 v242, v[168:169] offset:0
    v_add_f32 v229, v229, v152
    v_add_f32 v229, v229, v153
    v_mfma_f32_32x32x16_bf16 v[48:63], v[184:187], v[156:159], v[48:63]
    v_add_f32 v228, v228, v148
    v_add_f32 v228, v228, v149
    v_add_f32 v228, v228, v150
    v_add_f32 v228, v228, v151
    v_add_f32 v229, v229, v154
    v_add_f32 v229, v229, v155
L_a_te_3:
    s_waitcnt lgkmcnt(0)
    s_add_u32 s91, s91, 1
    s_cmp_lt_u32 s91, 4
    s_cbranch_scc1 L_a_tick
    v_mfma_f32_32x32x16_bf16 v[0:15], v[188:191], v[160:163], v[0:15]
    v_mfma_f32_32x32x16_bf16 v[16:31], v[192:195], v[160:163], v[16:31]
    v_mfma_f32_32x32x16_bf16 v[32:47], v[196:199], v[160:163], v[32:47]
    v_mfma_f32_32x32x16_bf16 v[48:63], v[200:203], v[160:163], v[48:63]
    v_mfma_f32_16x16x32_bf16 v[64:67], v[220:223], v[164:167], v[64:67]
    v_mfma_f32_16x16x32_bf16 v[68:71], v[224:227], v[164:167], v[68:71]
    s_nop 7
    s_nop 3
    v_mov_b32 v250, v228
    s_nop 1
    v_permlane32_swap_b32 v228, v250
    s_nop 1
    v_add_f32 v228, v228, v250
    v_mov_b32 v250, v229
    s_nop 1
    v_permlane32_swap_b32 v229, v250
    s_nop 1
    v_add_f32 v229, v229, v250
    v_mov_b32 v250, v229
    s_nop 1
    v_permlane16_swap_b32 v229, v250
    s_nop 1
    v_add_f32 v229, v229, v250

    s_mov_b32 s48, 796917760
    s_mov_b32 s49, 1199570944
    v_cmp_nle_f32 vcc, s48, v228
    v_cmp_nge_f32 s[68:69], s49, v228
    s_cmp_eq_u32 s92, 0
    s_mov_b32 s93, 161792
    s_cselect_b32 s93, 70656, s93
    s_lshl_b32 s47, s46, 6
    s_add_u32 s47, s47, s93
    s_add_u32 s47, s47, 64
    v_and_b32 v243, 15, v238
    v_lshlrev_b32 v243, 2, v243
    v_add_u32 v243, s47, v243
    ds_write_b32 v243, v229
    s_or_b64 vcc, vcc, s[68:69]
    s_cmp_lg_u64 vcc, 0
    s_cselect_b32 s48, 1, 0

    s_lshl_b32 s47, s46, 2
    s_add_u32 s47, s47, s93
    v_mov_b32 v245, s47
    v_mov_b32 v246, s48
    ds_write_b32 v245, v246

    s_cmp_eq_u32 s92, 0
    s_cbranch_scc1 L_es_28
    s_mov_b32 s62, 0
    s_lshl_b32 s63, s46, 10
    s_add_u32 s64, s63, 9216

    v_lshlrev_b32 v247, 4, v238
    s_lshl_b32 s47, s46, 12
    v_add_u32 v204, s47, v247
    v_add_u32 v205, 16384, v204
    v_add_u32 v206, 32768, v247
    v_lshrrev_b32 v247, 4, v238
    v_and_b32 v248, 15, v238
    v_lshlrev_b32 v249, 2, v247
    v_xor_b32 v248, v248, v249
    s_and_b32 s47, s46, 1
    s_lshl_b32 s47, s47, 1
    v_xor_b32 v248, s47, v248
    s_lshl_b32 s47, s46, 2
    v_add_u32 v247, s47, v247
    v_mul_u32_u24 v247, 1152, v247
    v_lshl_add_u32 v207, v248, 4, v247
    v_add_u32 v208, 18432, v207
    v_lshrrev_b32 v247, 1, v238
    v_mul_u32_u24 v247, 1152, v247
    v_and_b32 v248, 1, v238
    v_lshl_add_u32 v247, v248, 4, v247
    v_add_u32 v209, 256, v247
    s_mov_b32 s52, 69632
    s_mov_b32 s60, 0
    s_mov_b32 s61, 0

    s_lshr_b32 s47, s61, 2
    s_add_u32 s47, s47, s5
    s_and_b32 s47, s47, 3
    s_lshl_b32 s47, s47, 1
    s_add_u32 s47, s47, s62
    s_lshl_b32 s48, s6, 3
    s_add_u32 s47, s47, s48
    s_mul_i32 s54, s47, 147456
    s_mul_i32 s53, s5, 288
    s_add_u32 s54, s54, s53
    s_lshl_b32 s53, s4, 5
    s_add_u32 s53, s53, s47
    s_mul_i32 s53, s53, 36864

    s_add_u32 s47, s5, 0
    s_and_b32 s47, s47, 3
    s_lshl_b32 s47, s47, 1
    s_add_u32 s47, s47, s62
    s_lshl_b32 s48, s6, 3
    s_add_u32 s47, s47, s48
    s_mul_i32 s58, s47, 147456
    s_mul_i32 s48, s5, 288
    s_add_u32 s58, s58, s48
    s_lshl_b32 s48, s4, 5
    s_add_u32 s48, s48, s47
    s_mul_i32 s52, s48, 36864

    s_add_u32 s47, s5, 1
    s_and_b32 s47, s47, 3
    s_lshl_b32 s47, s47, 1
    s_add_u32 s47, s47, s62
    s_lshl_b32 s48, s6, 3
    s_add_u32 s47, s47, s48
    s_mul_i32 s59, s47, 147456
    s_mul_i32 s48, s5, 288
    s_add_u32 s59, s59, s48
    s_lshl_b32 s48, s4, 5
    s_add_u32 s48, s48, s47
    s_mul_i32 s53, s48, 36864

    s_add_u32 s47, s5, 2
    s_and_b32 s47, s47, 3
    s_lshl_b32 s47, s47, 1
    s_add_u32 s47, s47, s62
    s_lshl_b32 s48, s6, 3
    s_add_u32 s47, s47, s48
    s_mul_i32 s60, s47, 147456
    s_mul_i32 s48, s5, 288
    s_add_u32 s60, s60, s48
    s_lshl_b32 s48, s4, 5
    s_add_u32 s48, s48, s47
    s_mul_i32 s54, s48, 36864

    s_add_u32 s47, s5, 3
    s_and_b32 s47, s47, 3
    s_lshl_b32 s47, s47, 1
    s_add_u32 s47, s47, s62
    s_lshl_b32 s48, s6, 3
    s_add_u32 s47, s47, s48
    s_mul_i32 s61, s47, 147456
    s_mul_i32 s48, s5, 288
    s_add_u32 s61, s61, s48
    s_lshl_b32 s48, s4, 5
    s_add_u32 s48, s48, s47
    s_mul_i32 s55, s48, 36864

L_es_28:

    s_waitcnt lgkmcnt(0)
    s_barrier

    v_mov_b32 v180, s93
    ds_read_b128 v[172:175], v180
    v_and_b32 v180, 15, v238
    v_lshlrev_b32 v180, 2, v180
    v_add_u32 v180, s93, v180
    ds_read_b32 v176, v180 offset:64
    ds_read_b32 v177, v180 offset:128
    ds_read_b32 v178, v180 offset:192
    ds_read_b32 v179, v180 offset:256
    s_waitcnt lgkmcnt(0)
    v_or_b32 v172, v172, v173
    v_or_b32 v174, v174, v175
    v_add_f32 v176, v176, v177
    v_add_f32 v178, v178, v179
    v_or_b32 v172, v172, v174
    v_add_f32 v176, v176, v178
    s_mov_b32 s48, 796917760
    s_mov_b32 s49, 1199570944
    v_cmp_nle_f32 vcc, s48, v176
    v_cmp_nge_f32 s[68:69], s49, v176
    v_cmp_ne_u32 s[70:71], 0, v172

    v_mov_b32 v229, v176

    s_nop 0
    s_or_b64 vcc, vcc, s[68:69]
    s_or_b64 vcc, vcc, s[70:71]
    s_cmp_lg_u64 vcc, 0
    s_cbranch_scc1 L_a_safe

L_a_store:

    v_rcp_f32 v243, v228
    v_rcp_f32 v244, v229
    s_nop 0
    v_mov_b32 v248, v243
    v_mov_b32 v249, v243
    s_lshl_b32 s47, s4, 5
    s_add_u32 s47, s47, s7
    s_add_u32 s47, s47, s92
    s_mul_i32 s94, s47, 36864
    v_bfe_u32 v245, v238, 4, 1
    s_lshl_b32 s47, s46, 1
    v_add_u32 v245, s47, v245
    v_lshlrev_b32 v245, 12, v245
    v_and_b32 v246, 15, v238
    v_lshl_add_u32 v245, v246, 4, v245
    v_lshrrev_b32 v246, 5, v238
    v_lshl_add_u32 v245, v246, 9, v245

    v_pk_mul_f32 v[0:1], v[0:1], v[248:249]
    v_pk_mul_f32 v[2:3], v[2:3], v[248:249]
    v_pk_mul_f32 v[4:5], v[4:5], v[248:249]
    v_pk_mul_f32 v[6:7], v[6:7], v[248:249]
    v_pk_mul_f32 v[8:9], v[8:9], v[248:249]
    v_pk_mul_f32 v[10:11], v[10:11], v[248:249]
    v_pk_mul_f32 v[12:13], v[12:13], v[248:249]
    v_pk_mul_f32 v[14:15], v[14:15], v[248:249]
    v_cvt_pk_bf16_f32 v0, v0, v1
    v_cvt_pk_bf16_f32 v1, v2, v3
    v_cvt_pk_bf16_f32 v2, v4, v5
    v_cvt_pk_bf16_f32 v3, v6, v7
    v_cvt_pk_bf16_f32 v4, v8, v9
    v_cvt_pk_bf16_f32 v5, v10, v11
    v_cvt_pk_bf16_f32 v6, v12, v13
    v_cvt_pk_bf16_f32 v7, v14, v15
    buffer_store_dwordx4 v[0:3], v245, s[28:31], s94 offen offset:0 sc1
    buffer_store_dwordx4 v[4:7], v245, s[28:31], s94 offen offset:256 sc1
    v_pk_mul_f32 v[16:17], v[16:17], v[248:249]
    v_pk_mul_f32 v[18:19], v[18:19], v[248:249]
    v_pk_mul_f32 v[20:21], v[20:21], v[248:249]
    v_pk_mul_f32 v[22:23], v[22:23], v[248:249]
    v_pk_mul_f32 v[24:25], v[24:25], v[248:249]
    v_pk_mul_f32 v[26:27], v[26:27], v[248:249]
    v_pk_mul_f32 v[28:29], v[28:29], v[248:249]
    v_pk_mul_f32 v[30:31], v[30:31], v[248:249]
    v_cvt_pk_bf16_f32 v16, v16, v17
    v_cvt_pk_bf16_f32 v17, v18, v19
    v_cvt_pk_bf16_f32 v18, v20, v21
    v_cvt_pk_bf16_f32 v19, v22, v23
    v_cvt_pk_bf16_f32 v20, v24, v25
    v_cvt_pk_bf16_f32 v21, v26, v27
    v_cvt_pk_bf16_f32 v22, v28, v29
    v_cvt_pk_bf16_f32 v23, v30, v31
    buffer_store_dwordx4 v[16:19], v245, s[28:31], s94 offen offset:1024 sc1
    buffer_store_dwordx4 v[20:23], v245, s[28:31], s94 offen offset:1280 sc1
    v_pk_mul_f32 v[32:33], v[32:33], v[248:249]
    v_pk_mul_f32 v[34:35], v[34:35], v[248:249]
    v_pk_mul_f32 v[36:37], v[36:37], v[248:249]
    v_pk_mul_f32 v[38:39], v[38:39], v[248:249]
    v_pk_mul_f32 v[40:41], v[40:41], v[248:249]
    v_pk_mul_f32 v[42:43], v[42:43], v[248:249]
    v_pk_mul_f32 v[44:45], v[44:45], v[248:249]
    v_pk_mul_f32 v[46:47], v[46:47], v[248:249]
    v_cvt_pk_bf16_f32 v32, v32, v33
    v_cvt_pk_bf16_f32 v33, v34, v35
    v_cvt_pk_bf16_f32 v34, v36, v37
    v_cvt_pk_bf16_f32 v35, v38, v39
    v_cvt_pk_bf16_f32 v36, v40, v41
    v_cvt_pk_bf16_f32 v37, v42, v43
    v_cvt_pk_bf16_f32 v38, v44, v45
    v_cvt_pk_bf16_f32 v39, v46, v47
    buffer_store_dwordx4 v[32:35], v245, s[28:31], s94 offen offset:2048 sc1
    buffer_store_dwordx4 v[36:39], v245, s[28:31], s94 offen offset:2304 sc1
    v_pk_mul_f32 v[48:49], v[48:49], v[248:249]
    v_pk_mul_f32 v[50:51], v[50:51], v[248:249]
    v_pk_mul_f32 v[52:53], v[52:53], v[248:249]
    v_pk_mul_f32 v[54:55], v[54:55], v[248:249]
    v_pk_mul_f32 v[56:57], v[56:57], v[248:249]
    v_pk_mul_f32 v[58:59], v[58:59], v[248:249]
    v_pk_mul_f32 v[60:61], v[60:61], v[248:249]
    v_pk_mul_f32 v[62:63], v[62:63], v[248:249]
    v_cvt_pk_bf16_f32 v48, v48, v49
    v_cvt_pk_bf16_f32 v49, v50, v51
    v_cvt_pk_bf16_f32 v50, v52, v53
    v_cvt_pk_bf16_f32 v51, v54, v55
    v_cvt_pk_bf16_f32 v52, v56, v57
    v_cvt_pk_bf16_f32 v53, v58, v59
    v_cvt_pk_bf16_f32 v54, v60, v61
    v_cvt_pk_bf16_f32 v55, v62, v63
    buffer_store_dwordx4 v[48:51], v245, s[28:31], s94 offen offset:3072 sc1
    buffer_store_dwordx4 v[52:55], v245, s[28:31], s94 offen offset:3328 sc1
    v_mul_f32 v64, v64, v244
    v_mul_f32 v65, v65, v244
    v_mul_f32 v66, v66, v244
    v_mul_f32 v67, v67, v244
    v_mul_f32 v68, v68, v244
    v_mul_f32 v69, v69, v244
    v_mul_f32 v70, v70, v244
    v_mul_f32 v71, v71, v244
    v_cvt_pk_bf16_f32 v64, v64, v65
    v_cvt_pk_bf16_f32 v65, v66, v67
    v_cvt_pk_bf16_f32 v66, v68, v69
    v_cvt_pk_bf16_f32 v67, v70, v71

    s_lshl_b32 s47, s46, 10
    s_add_u32 s47, s47, 32768
    v_lshlrev_b32 v246, 4, v238
    v_add_u32 v246, s47, v246
    buffer_store_dwordx4 v[64:67], v246, s[28:31], s94 offen sc1

    s_cmp_eq_u32 s92, 1
    s_cbranch_scc1 L_a_last
    s_nop 1
    v_mov_b64 v[0:1], 0
    v_mov_b64 v[2:3], 0
    v_mov_b64 v[4:5], 0
    v_mov_b64 v[6:7], 0
    v_mov_b64 v[8:9], 0
    v_mov_b64 v[10:11], 0
    v_mov_b64 v[12:13], 0
    v_mov_b64 v[14:15], 0
    v_mov_b64 v[16:17], 0
    v_mov_b64 v[18:19], 0
    v_mov_b64 v[20:21], 0
    v_mov_b64 v[22:23], 0
    v_mov_b64 v[24:25], 0
    v_mov_b64 v[26:27], 0
    v_mov_b64 v[28:29], 0
    v_mov_b64 v[30:31], 0
    v_mov_b64 v[32:33], 0
    v_mov_b64 v[34:35], 0
    v_mov_b64 v[36:37], 0
    v_mov_b64 v[38:39], 0
    v_mov_b64 v[40:41], 0
    v_mov_b64 v[42:43], 0
    v_mov_b64 v[44:45], 0
    v_mov_b64 v[46:47], 0
    v_mov_b64 v[48:49], 0
    v_mov_b64 v[50:51], 0
    v_mov_b64 v[52:53], 0
    v_mov_b64 v[54:55], 0
    v_mov_b64 v[56:57], 0
    v_mov_b64 v[58:59], 0
    v_mov_b64 v[60:61], 0
    v_mov_b64 v[62:63], 0
    v_mov_b64 v[64:65], 0
    v_mov_b64 v[66:67], 0
    v_mov_b64 v[68:69], 0
    v_mov_b64 v[70:71], 0
    v_mov_b32 v228, 0
    v_mov_b32 v229, 0
    s_mov_b32 s92, 1
    s_branch L_a_head
L_a_last:
    v_mov_b32 v246, 155648
    ds_read_b64 v[244:245], v246
    s_waitcnt lgkmcnt(0)
    v_readfirstlane_b32 s44, v244
    v_readfirstlane_b32 s45, v245
    s_barrier
    s_add_u32 m0, s63, 69632
    s_add_u32 s50, s59, 0
    buffer_load_dwordx4 v204, s[28:31], s53 offen offset:0 sc1 lds
    s_add_u32 m0, s63, 73728
    s_nop 0
    buffer_load_dwordx4 v205, s[28:31], s53 offen offset:0 sc1 lds
    s_add_u32 m0, s64, 69632
    s_nop 0
    buffer_load_dwordx4 v207, s[24:27], s50 offen lds
    s_add_u32 m0, s64, 73728
    s_nop 0
    buffer_load_dwordx4 v208, s[24:27], s50 offen lds
    s_mov_b32 m0, 77824
    s_cmp_eq_u32 s46, 0
    s_cselect_b64 exec, -1, 0
    buffer_load_dwordx4 v206, s[28:31], s53 offen offset:0 sc1 lds
    s_mov_b64 exec, -1
    s_mov_b32 m0, 87040
    s_cmp_eq_u32 s46, 2
    s_cselect_b64 exec, -1, 0
    buffer_load_dwordx4 v209, s[24:27], s50 offen lds
    s_mov_b64 exec, -1
    s_add_u32 m0, s63, 87040
    s_add_u32 s50, s59, 36864
    buffer_load_dwordx4 v204, s[28:31], s53 offen offset:1024 sc1 lds
    s_add_u32 m0, s63, 91136
    s_nop 0
    buffer_load_dwordx4 v205, s[28:31], s53 offen offset:1024 sc1 lds
    s_add_u32 m0, s64, 88064
    s_nop 0
    buffer_load_dwordx4 v207, s[24:27], s50 offen lds
    s_add_u32 m0, s64, 92160
    s_nop 0
    buffer_load_dwordx4 v208, s[24:27], s50 offen lds
    s_mov_b32 m0, 95232
    s_cmp_eq_u32 s46, 1
    s_cselect_b64 exec, -1, 0
    buffer_load_dwordx4 v206, s[28:31], s53 offen offset:1024 sc1 lds
    s_mov_b64 exec, -1
    s_mov_b32 m0, 105472
    s_cmp_eq_u32 s46, 3
    s_cselect_b64 exec, -1, 0
    buffer_load_dwordx4 v209, s[24:27], s50 offen lds
    s_mov_b64 exec, -1
    s_add_u32 m0, s63, 104448
    s_add_u32 s50, s59, 73728
    buffer_load_dwordx4 v204, s[28:31], s53 offen offset:2048 sc1 lds
    s_add_u32 m0, s63, 108544
    s_nop 0
    buffer_load_dwordx4 v205, s[28:31], s53 offen offset:2048 sc1 lds
    s_add_u32 m0, s64, 106496
    s_nop 0
    buffer_load_dwordx4 v207, s[24:27], s50 offen lds
    s_add_u32 m0, s64, 110592
    s_nop 0
    buffer_load_dwordx4 v208, s[24:27], s50 offen lds
    s_mov_b32 m0, 112640
    s_cmp_eq_u32 s46, 2
    s_cselect_b64 exec, -1, 0
    buffer_load_dwordx4 v206, s[28:31], s53 offen offset:2048 sc1 lds
    s_mov_b64 exec, -1
    s_mov_b32 m0, 123904
    s_cmp_eq_u32 s46, 0
    s_cselect_b64 exec, -1, 0
    buffer_load_dwordx4 v209, s[24:27], s50 offen lds
    s_mov_b64 exec, -1
    s_waitcnt vmcnt(8)
    s_barrier
    s_waitcnt vmcnt(12)

    s_lshl_b32 s47, s2, 9
    s_lshl_b32 s48, s46, 3
    s_add_u32 s47, s47, s48
    s_add_u32 s47, s47, 50331776
    v_mov_b32 v246, s47
    v_mov_b32 v244, s44
    v_mov_b32 v245, s45
    s_mov_b64 exec, 1
    global_store_dwordx2 v246, v[244:245], s[40:41] sc1
    s_mov_b64 exec, -1

    s_add_u32 m0, s63, 121856
    s_add_u32 s50, s59, 110592
    buffer_load_dwordx4 v204, s[28:31], s53 offen offset:3072 sc1 lds
    s_add_u32 m0, s63, 125952
    s_nop 0
    buffer_load_dwordx4 v205, s[28:31], s53 offen offset:3072 sc1 lds
    s_add_u32 m0, s64, 124928
    s_nop 0
    buffer_load_dwordx4 v207, s[24:27], s50 offen lds
    s_add_u32 m0, s64, 129024
    s_nop 0
    buffer_load_dwordx4 v208, s[24:27], s50 offen lds
    s_mov_b32 m0, 130048
    s_cmp_eq_u32 s46, 3
    s_cselect_b64 exec, -1, 0
    buffer_load_dwordx4 v206, s[28:31], s53 offen offset:3072 sc1 lds
    s_mov_b64 exec, -1
    s_mov_b32 m0, 142336
    s_cmp_eq_u32 s46, 1
    s_cselect_b64 exec, -1, 0
    buffer_load_dwordx4 v209, s[24:27], s50 offen lds
    s_mov_b64 exec, -1
    s_waitcnt vmcnt(8)
    s_barrier
    s_add_u32 m0, s63, 69632
    s_add_u32 s50, s60, 0
    buffer_load_dwordx4 v204, s[28:31], s54 offen offset:0 sc1 lds
    s_add_u32 m0, s63, 73728
    s_nop 0
    buffer_load_dwordx4 v205, s[28:31], s54 offen offset:0 sc1 lds
    s_add_u32 m0, s64, 69632
    s_nop 0
    buffer_load_dwordx4 v207, s[24:27], s50 offen lds
    s_add_u32 m0, s64, 73728
    s_nop 0
    buffer_load_dwordx4 v208, s[24:27], s50 offen lds
    s_mov_b32 m0, 77824
    s_cmp_eq_u32 s46, 0
    s_cselect_b64 exec, -1, 0
    buffer_load_dwordx4 v206, s[28:31], s54 offen offset:0 sc1 lds
    s_mov_b64 exec, -1
    s_mov_b32 m0, 87040
    s_cmp_eq_u32 s46, 2
    s_cselect_b64 exec, -1, 0
    buffer_load_dwordx4 v209, s[24:27], s50 offen lds
    s_mov_b64 exec, -1
    s_waitcnt vmcnt(8)
    s_barrier
    s_add_u32 m0, s63, 87040
    s_add_u32 s50, s60, 36864
    buffer_load_dwordx4 v204, s[28:31], s54 offen offset:1024 sc1 lds
    s_add_u32 m0, s63, 91136
    s_nop 0
    buffer_load_dwordx4 v205, s[28:31], s54 offen offset:1024 sc1 lds
    s_add_u32 m0, s64, 88064
    s_nop 0
    buffer_load_dwordx4 v207, s[24:27], s50 offen lds
    s_add_u32 m0, s64, 92160
    s_nop 0
    buffer_load_dwordx4 v208, s[24:27], s50 offen lds
    s_mov_b32 m0, 95232
    s_cmp_eq_u32 s46, 1
    s_cselect_b64 exec, -1, 0
    buffer_load_dwordx4 v206, s[28:31], s54 offen offset:1024 sc1 lds
    s_mov_b64 exec, -1
    s_mov_b32 m0, 105472
    s_cmp_eq_u32 s46, 3
    s_cselect_b64 exec, -1, 0
    buffer_load_dwordx4 v209, s[24:27], s50 offen lds
    s_mov_b64 exec, -1
    s_waitcnt vmcnt(8)
    s_barrier
    s_add_u32 m0, s63, 104448
    s_add_u32 s50, s60, 73728
    buffer_load_dwordx4 v204, s[28:31], s54 offen offset:2048 sc1 lds
    s_add_u32 m0, s63, 108544
    s_nop 0
    buffer_load_dwordx4 v205, s[28:31], s54 offen offset:2048 sc1 lds
    s_add_u32 m0, s64, 106496
    s_nop 0
    buffer_load_dwordx4 v207, s[24:27], s50 offen lds
    s_add_u32 m0, s64, 110592
    s_nop 0
    buffer_load_dwordx4 v208, s[24:27], s50 offen lds
    s_mov_b32 m0, 112640
    s_cmp_eq_u32 s46, 2
    s_cselect_b64 exec, -1, 0
    buffer_load_dwordx4 v206, s[28:31], s54 offen offset:2048 sc1 lds
    s_mov_b64 exec, -1
    s_mov_b32 m0, 123904
    s_cmp_eq_u32 s46, 0
    s_cselect_b64 exec, -1, 0
    buffer_load_dwordx4 v209, s[24:27], s50 offen lds
    s_mov_b64 exec, -1
    s_waitcnt vmcnt(8)
    s_barrier
    s_add_u32 m0, s63, 121856
    s_add_u32 s50, s60, 110592
    buffer_load_dwordx4 v204, s[28:31], s54 offen offset:3072 sc1 lds
    s_add_u32 m0, s63, 125952
    s_nop 0
    buffer_load_dwordx4 v205, s[28:31], s54 offen offset:3072 sc1 lds
    s_add_u32 m0, s64, 124928
    s_nop 0
    buffer_load_dwordx4 v207, s[24:27], s50 offen lds
    s_add_u32 m0, s64, 129024
    s_nop 0
    buffer_load_dwordx4 v208, s[24:27], s50 offen lds
    s_mov_b32 m0, 130048
    s_cmp_eq_u32 s46, 3
    s_cselect_b64 exec, -1, 0
    buffer_load_dwordx4 v206, s[28:31], s54 offen offset:3072 sc1 lds
    s_mov_b64 exec, -1
    s_mov_b32 m0, 142336
    s_cmp_eq_u32 s46, 1
    s_cselect_b64 exec, -1, 0
    buffer_load_dwordx4 v209, s[24:27], s50 offen lds
    s_mov_b64 exec, -1
    s_waitcnt vmcnt(8)
    s_barrier
    s_add_u32 m0, s63, 69632
    s_add_u32 s50, s61, 0
    buffer_load_dwordx4 v204, s[28:31], s55 offen offset:0 sc1 lds
    s_add_u32 m0, s63, 73728
    s_nop 0
    buffer_load_dwordx4 v205, s[28:31], s55 offen offset:0 sc1 lds
    s_add_u32 m0, s64, 69632
    s_nop 0
    buffer_load_dwordx4 v207, s[24:27], s50 offen lds
    s_add_u32 m0, s64, 73728
    s_nop 0
    buffer_load_dwordx4 v208, s[24:27], s50 offen lds
    s_mov_b32 m0, 77824
    s_cmp_eq_u32 s46, 0
    s_cselect_b64 exec, -1, 0
    buffer_load_dwordx4 v206, s[28:31], s55 offen offset:0 sc1 lds
    s_mov_b64 exec, -1
    s_mov_b32 m0, 87040
    s_cmp_eq_u32 s46, 2
    s_cselect_b64 exec, -1, 0
    buffer_load_dwordx4 v209, s[24:27], s50 offen lds
    s_mov_b64 exec, -1
    s_waitcnt vmcnt(8)
    s_barrier
    s_add_u32 m0, s63, 87040
    s_add_u32 s50, s61, 36864
    buffer_load_dwordx4 v204, s[28:31], s55 offen offset:1024 sc1 lds
    s_add_u32 m0, s63, 91136
    s_nop 0
    buffer_load_dwordx4 v205, s[28:31], s55 offen offset:1024 sc1 lds
    s_add_u32 m0, s64, 88064
    s_nop 0
    buffer_load_dwordx4 v207, s[24:27], s50 offen lds
    s_add_u32 m0, s64, 92160
    s_nop 0
    buffer_load_dwordx4 v208, s[24:27], s50 offen lds
    s_mov_b32 m0, 95232
    s_cmp_eq_u32 s46, 1
    s_cselect_b64 exec, -1, 0
    buffer_load_dwordx4 v206, s[28:31], s55 offen offset:1024 sc1 lds
    s_mov_b64 exec, -1
    s_mov_b32 m0, 105472
    s_cmp_eq_u32 s46, 3
    s_cselect_b64 exec, -1, 0
    buffer_load_dwordx4 v209, s[24:27], s50 offen lds
    s_mov_b64 exec, -1
    s_waitcnt vmcnt(8)
    s_barrier
    s_add_u32 m0, s63, 104448
    s_add_u32 s50, s61, 73728
    buffer_load_dwordx4 v204, s[28:31], s55 offen offset:2048 sc1 lds
    s_add_u32 m0, s63, 108544
    s_nop 0
    buffer_load_dwordx4 v205, s[28:31], s55 offen offset:2048 sc1 lds
    s_add_u32 m0, s64, 106496
    s_nop 0
    buffer_load_dwordx4 v207, s[24:27], s50 offen lds
    s_add_u32 m0, s64, 110592
    s_nop 0
    buffer_load_dwordx4 v208, s[24:27], s50 offen lds
    s_mov_b32 m0, 112640
    s_cmp_eq_u32 s46, 2
    s_cselect_b64 exec, -1, 0
    buffer_load_dwordx4 v206, s[28:31], s55 offen offset:2048 sc1 lds
    s_mov_b64 exec, -1
    s_mov_b32 m0, 123904
    s_cmp_eq_u32 s46, 0
    s_cselect_b64 exec, -1, 0
    buffer_load_dwordx4 v209, s[24:27], s50 offen lds
    s_mov_b64 exec, -1
    s_waitcnt vmcnt(8)
    s_barrier
    s_add_u32 m0, s63, 121856
    s_add_u32 s50, s61, 110592
    buffer_load_dwordx4 v204, s[28:31], s55 offen offset:3072 sc1 lds
    s_add_u32 m0, s63, 125952
    s_nop 0
    buffer_load_dwordx4 v205, s[28:31], s55 offen offset:3072 sc1 lds
    s_add_u32 m0, s64, 124928
    s_nop 0
    buffer_load_dwordx4 v207, s[24:27], s50 offen lds
    s_add_u32 m0, s64, 129024
    s_nop 0
    buffer_load_dwordx4 v208, s[24:27], s50 offen lds
    s_mov_b32 m0, 130048
    s_cmp_eq_u32 s46, 3
    s_cselect_b64 exec, -1, 0
    buffer_load_dwordx4 v206, s[28:31], s55 offen offset:3072 sc1 lds
    s_mov_b64 exec, -1
    s_mov_b32 m0, 142336
    s_cmp_eq_u32 s46, 1
    s_cselect_b64 exec, -1, 0
    buffer_load_dwordx4 v209, s[24:27], s50 offen lds
    s_mov_b64 exec, -1
    s_mov_b32 s62, 1

    s_add_u32 s47, s5, 0
    s_and_b32 s47, s47, 3
    s_lshl_b32 s47, s47, 1
    s_add_u32 s47, s47, s62
    s_lshl_b32 s48, s6, 3
    s_add_u32 s47, s47, s48
    s_mul_i32 s58, s47, 147456
    s_mul_i32 s48, s5, 288
    s_add_u32 s58, s58, s48
    s_lshl_b32 s48, s4, 5
    s_add_u32 s48, s48, s47
    s_mul_i32 s52, s48, 36864

    s_add_u32 s47, s5, 1
    s_and_b32 s47, s47, 3
    s_lshl_b32 s47, s47, 1
    s_add_u32 s47, s47, s62
    s_lshl_b32 s48, s6, 3
    s_add_u32 s47, s47, s48
    s_mul_i32 s59, s47, 147456
    s_mul_i32 s48, s5, 288
    s_add_u32 s59, s59, s48
    s_lshl_b32 s48, s4, 5
    s_add_u32 s48, s48, s47
    s_mul_i32 s53, s48, 36864

    s_add_u32 s47, s5, 2
    s_and_b32 s47, s47, 3
    s_lshl_b32 s47, s47, 1
    s_add_u32 s47, s47, s62
    s_lshl_b32 s48, s6, 3
    s_add_u32 s47, s47, s48
    s_mul_i32 s60, s47, 147456
    s_mul_i32 s48, s5, 288
    s_add_u32 s60, s60, s48
    s_lshl_b32 s48, s4, 5
    s_add_u32 s48, s48, s47
    s_mul_i32 s54, s48, 36864

    s_add_u32 s47, s5, 3
    s_and_b32 s47, s47, 3
    s_lshl_b32 s47, s47, 1
    s_add_u32 s47, s47, s62
    s_lshl_b32 s48, s6, 3
    s_add_u32 s47, s47, s48
    s_mul_i32 s61, s47, 147456
    s_mul_i32 s48, s5, 288
    s_add_u32 s61, s61, s48
    s_lshl_b32 s48, s4, 5
    s_add_u32 s48, s48, s47
    s_mul_i32 s55, s48, 36864

    s_waitcnt vmcnt(8)
    s_barrier

    s_andn2_b32 s47, s2, 24
    v_bfe_u32 v246, v238, 2, 2
    v_lshlrev_b32 v246, 3, v246
    v_add_u32 v246, s47, v246
    v_lshlrev_b32 v246, 9, v246
    v_and_b32 v247, 3, v238
    v_lshl_add_u32 v246, v247, 3, v246
    v_add_u32 v246, 50331776, v246
    s_mov_b32 s57, 100000

L_p16_29:

    global_load_dwordx2 v[244:245], v246, s[40:41] sc1
    s_waitcnt vmcnt(0)
    v_cmp_ne_u32 vcc, s44, v244
    v_cmp_ne_u32 s[68:69], s45, v245
    s_sub_u32 s57, s57, 1
    s_cmp_eq_u32 s57, 0
    s_cbranch_scc1 L_p16d_30
    s_or_b64 vcc, vcc, s[68:69]
    s_cmp_lg_u64 vcc, 0
    s_cbranch_scc0 L_p16d_30
    s_sleep 1
    s_branch L_p16_29

L_p16d_30:
    s_add_u32 m0, s63, 69632
    s_add_u32 s50, s58, 0
    buffer_load_dwordx4 v204, s[28:31], s52 offen offset:0 sc1 lds
    s_add_u32 m0, s63, 73728
    s_nop 0
    buffer_load_dwordx4 v205, s[28:31], s52 offen offset:0 sc1 lds
    s_add_u32 m0, s64, 69632
    s_nop 0
    buffer_load_dwordx4 v207, s[24:27], s50 offen lds
    s_add_u32 m0, s64, 73728
    s_nop 0
    buffer_load_dwordx4 v208, s[24:27], s50 offen lds
    s_mov_b32 m0, 77824
    s_cmp_eq_u32 s46, 0
    s_cselect_b64 exec, -1, 0
    buffer_load_dwordx4 v206, s[28:31], s52 offen offset:0 sc1 lds
    s_mov_b64 exec, -1
    s_mov_b32 m0, 87040
    s_cmp_eq_u32 s46, 2
    s_cselect_b64 exec, -1, 0
    buffer_load_dwordx4 v209, s[24:27], s50 offen lds
    s_mov_b64 exec, -1
    s_waitcnt vmcnt(8)
    s_barrier
    s_add_u32 m0, s63, 87040
    s_add_u32 s50, s58, 36864
    buffer_load_dwordx4 v204, s[28:31], s52 offen offset:1024 sc1 lds
    s_add_u32 m0, s63, 91136
    s_nop 0
    buffer_load_dwordx4 v205, s[28:31], s52 offen offset:1024 sc1 lds
    s_add_u32 m0, s64, 88064
    s_nop 0
    buffer_load_dwordx4 v207, s[24:27], s50 offen lds
    s_add_u32 m0, s64, 92160
    s_nop 0
    buffer_load_dwordx4 v208, s[24:27], s50 offen lds
    s_mov_b32 m0, 95232
    s_cmp_eq_u32 s46, 1
    s_cselect_b64 exec, -1, 0
    buffer_load_dwordx4 v206, s[28:31], s52 offen offset:1024 sc1 lds
    s_mov_b64 exec, -1
    s_mov_b32 m0, 105472
    s_cmp_eq_u32 s46, 3
    s_cselect_b64 exec, -1, 0
    buffer_load_dwordx4 v209, s[24:27], s50 offen lds
    s_mov_b64 exec, -1
    s_waitcnt vmcnt(8)
    s_barrier
    s_add_u32 m0, s63, 104448
    s_add_u32 s50, s58, 73728
    buffer_load_dwordx4 v204, s[28:31], s52 offen offset:2048 sc1 lds
    s_add_u32 m0, s63, 108544
    s_nop 0
    buffer_load_dwordx4 v205, s[28:31], s52 offen offset:2048 sc1 lds
    s_add_u32 m0, s64, 106496
    s_nop 0
    buffer_load_dwordx4 v207, s[24:27], s50 offen lds
    s_add_u32 m0, s64, 110592
    s_nop 0
    buffer_load_dwordx4 v208, s[24:27], s50 offen lds
    s_mov_b32 m0, 112640
    s_cmp_eq_u32 s46, 2
    s_cselect_b64 exec, -1, 0
    buffer_load_dwordx4 v206, s[28:31], s52 offen offset:2048 sc1 lds
    s_mov_b64 exec, -1
    s_mov_b32 m0, 123904
    s_cmp_eq_u32 s46, 0
    s_cselect_b64 exec, -1, 0
    buffer_load_dwordx4 v209, s[24:27], s50 offen lds
    s_mov_b64 exec, -1
    s_waitcnt vmcnt(8)
    s_barrier
    s_add_u32 m0, s63, 121856
    s_add_u32 s50, s58, 110592
    buffer_load_dwordx4 v204, s[28:31], s52 offen offset:3072 sc1 lds
    s_add_u32 m0, s63, 125952
    s_nop 0
    buffer_load_dwordx4 v205, s[28:31], s52 offen offset:3072 sc1 lds
    s_add_u32 m0, s64, 124928
    s_nop 0
    buffer_load_dwordx4 v207, s[24:27], s50 offen lds
    s_add_u32 m0, s64, 129024
    s_nop 0
    buffer_load_dwordx4 v208, s[24:27], s50 offen lds
    s_mov_b32 m0, 130048
    s_cmp_eq_u32 s46, 3
    s_cselect_b64 exec, -1, 0
    buffer_load_dwordx4 v206, s[28:31], s52 offen offset:3072 sc1 lds
    s_mov_b64 exec, -1
    s_mov_b32 m0, 142336
    s_cmp_eq_u32 s46, 1
    s_cselect_b64 exec, -1, 0
    buffer_load_dwordx4 v209, s[24:27], s50 offen lds
    s_mov_b64 exec, -1
    s_waitcnt vmcnt(8)
    s_barrier
    s_add_u32 m0, s63, 69632
    s_add_u32 s50, s59, 0
    buffer_load_dwordx4 v204, s[28:31], s53 offen offset:0 sc1 lds
    s_add_u32 m0, s63, 73728
    s_nop 0
    buffer_load_dwordx4 v205, s[28:31], s53 offen offset:0 sc1 lds
    s_add_u32 m0, s64, 69632
    s_nop 0
    buffer_load_dwordx4 v207, s[24:27], s50 offen lds
    s_add_u32 m0, s64, 73728
    s_nop 0
    buffer_load_dwordx4 v208, s[24:27], s50 offen lds
    s_mov_b32 m0, 77824
    s_cmp_eq_u32 s46, 0
    s_cselect_b64 exec, -1, 0
    buffer_load_dwordx4 v206, s[28:31], s53 offen offset:0 sc1 lds
    s_mov_b64 exec, -1
    s_mov_b32 m0, 87040
    s_cmp_eq_u32 s46, 2
    s_cselect_b64 exec, -1, 0
    buffer_load_dwordx4 v209, s[24:27], s50 offen lds
    s_mov_b64 exec, -1
    s_waitcnt vmcnt(8)
    s_barrier
    s_add_u32 m0, s63, 87040
    s_add_u32 s50, s59, 36864
    buffer_load_dwordx4 v204, s[28:31], s53 offen offset:1024 sc1 lds
    s_add_u32 m0, s63, 91136
    s_nop 0
    buffer_load_dwordx4 v205, s[28:31], s53 offen offset:1024 sc1 lds
    s_add_u32 m0, s64, 88064
    s_nop 0
    buffer_load_dwordx4 v207, s[24:27], s50 offen lds
    s_add_u32 m0, s64, 92160
    s_nop 0
    buffer_load_dwordx4 v208, s[24:27], s50 offen lds
    s_mov_b32 m0, 95232
    s_cmp_eq_u32 s46, 1
    s_cselect_b64 exec, -1, 0
    buffer_load_dwordx4 v206, s[28:31], s53 offen offset:1024 sc1 lds
    s_mov_b64 exec, -1
    s_mov_b32 m0, 105472
    s_cmp_eq_u32 s46, 3
    s_cselect_b64 exec, -1, 0
    buffer_load_dwordx4 v209, s[24:27], s50 offen lds
    s_mov_b64 exec, -1
    s_waitcnt vmcnt(8)
    s_barrier
    s_add_u32 m0, s63, 104448
    s_add_u32 s50, s59, 73728
    buffer_load_dwordx4 v204, s[28:31], s53 offen offset:2048 sc1 lds
    s_add_u32 m0, s63, 108544
    s_nop 0
    buffer_load_dwordx4 v205, s[28:31], s53 offen offset:2048 sc1 lds
    s_add_u32 m0, s64, 106496
    s_nop 0
    buffer_load_dwordx4 v207, s[24:27], s50 offen lds
    s_add_u32 m0, s64, 110592
    s_nop 0
    buffer_load_dwordx4 v208, s[24:27], s50 offen lds
    s_mov_b32 m0, 112640
    s_cmp_eq_u32 s46, 2
    s_cselect_b64 exec, -1, 0
    buffer_load_dwordx4 v206, s[28:31], s53 offen offset:2048 sc1 lds
    s_mov_b64 exec, -1
    s_mov_b32 m0, 123904
    s_cmp_eq_u32 s46, 0
    s_cselect_b64 exec, -1, 0
    buffer_load_dwordx4 v209, s[24:27], s50 offen lds
    s_mov_b64 exec, -1
    s_waitcnt vmcnt(8)
    s_barrier
    s_add_u32 m0, s63, 121856
    s_add_u32 s50, s59, 110592
    buffer_load_dwordx4 v204, s[28:31], s53 offen offset:3072 sc1 lds
    s_add_u32 m0, s63, 125952
    s_nop 0
    buffer_load_dwordx4 v205, s[28:31], s53 offen offset:3072 sc1 lds
    s_add_u32 m0, s64, 124928
    s_nop 0
    buffer_load_dwordx4 v207, s[24:27], s50 offen lds
    s_add_u32 m0, s64, 129024
    s_nop 0
    buffer_load_dwordx4 v208, s[24:27], s50 offen lds
    s_mov_b32 m0, 130048
    s_cmp_eq_u32 s46, 3
    s_cselect_b64 exec, -1, 0
    buffer_load_dwordx4 v206, s[28:31], s53 offen offset:3072 sc1 lds
    s_mov_b64 exec, -1
    s_mov_b32 m0, 142336
    s_cmp_eq_u32 s46, 1
    s_cselect_b64 exec, -1, 0
    buffer_load_dwordx4 v209, s[24:27], s50 offen lds
    s_mov_b64 exec, -1
    s_waitcnt vmcnt(8)
    s_barrier
    s_add_u32 m0, s63, 69632
    s_add_u32 s50, s60, 0
    buffer_load_dwordx4 v204, s[28:31], s54 offen offset:0 sc1 lds
    s_add_u32 m0, s63, 73728
    s_nop 0
    buffer_load_dwordx4 v205, s[28:31], s54 offen offset:0 sc1 lds
    s_add_u32 m0, s64, 69632
    s_nop 0
    buffer_load_dwordx4 v207, s[24:27], s50 offen lds
    s_add_u32 m0, s64, 73728
    s_nop 0
    buffer_load_dwordx4 v208, s[24:27], s50 offen lds
    s_mov_b32 m0, 77824
    s_cmp_eq_u32 s46, 0
    s_cselect_b64 exec, -1, 0
    buffer_load_dwordx4 v206, s[28:31], s54 offen offset:0 sc1 lds
    s_mov_b64 exec, -1
    s_mov_b32 m0, 87040
    s_cmp_eq_u32 s46, 2
    s_cselect_b64 exec, -1, 0
    buffer_load_dwordx4 v209, s[24:27], s50 offen lds
    s_mov_b64 exec, -1
    s_waitcnt vmcnt(8)
    s_barrier
    s_add_u32 m0, s63, 87040
    s_add_u32 s50, s60, 36864
    buffer_load_dwordx4 v204, s[28:31], s54 offen offset:1024 sc1 lds
    s_add_u32 m0, s63, 91136
    s_nop 0
    buffer_load_dwordx4 v205, s[28:31], s54 offen offset:1024 sc1 lds
    s_add_u32 m0, s64, 88064
    s_nop 0
    buffer_load_dwordx4 v207, s[24:27], s50 offen lds
    s_add_u32 m0, s64, 92160
    s_nop 0
    buffer_load_dwordx4 v208, s[24:27], s50 offen lds
    s_mov_b32 m0, 95232
    s_cmp_eq_u32 s46, 1
    s_cselect_b64 exec, -1, 0
    buffer_load_dwordx4 v206, s[28:31], s54 offen offset:1024 sc1 lds
    s_mov_b64 exec, -1
    s_mov_b32 m0, 105472
    s_cmp_eq_u32 s46, 3
    s_cselect_b64 exec, -1, 0
    buffer_load_dwordx4 v209, s[24:27], s50 offen lds
    s_mov_b64 exec, -1
    s_waitcnt vmcnt(8)
    s_barrier
    s_add_u32 m0, s63, 104448
    s_add_u32 s50, s60, 73728
    buffer_load_dwordx4 v204, s[28:31], s54 offen offset:2048 sc1 lds
    s_add_u32 m0, s63, 108544
    s_nop 0
    buffer_load_dwordx4 v205, s[28:31], s54 offen offset:2048 sc1 lds
    s_add_u32 m0, s64, 106496
    s_nop 0
    buffer_load_dwordx4 v207, s[24:27], s50 offen lds
    s_add_u32 m0, s64, 110592
    s_nop 0
    buffer_load_dwordx4 v208, s[24:27], s50 offen lds
    s_mov_b32 m0, 112640
    s_cmp_eq_u32 s46, 2
    s_cselect_b64 exec, -1, 0
    buffer_load_dwordx4 v206, s[28:31], s54 offen offset:2048 sc1 lds
    s_mov_b64 exec, -1
    s_mov_b32 m0, 123904
    s_cmp_eq_u32 s46, 0
    s_cselect_b64 exec, -1, 0
    buffer_load_dwordx4 v209, s[24:27], s50 offen lds
    s_mov_b64 exec, -1
    s_waitcnt vmcnt(8)
    s_barrier
    s_add_u32 m0, s63, 121856
    s_add_u32 s50, s60, 110592
    buffer_load_dwordx4 v204, s[28:31], s54 offen offset:3072 sc1 lds
    s_add_u32 m0, s63, 125952
    s_nop 0
    buffer_load_dwordx4 v205, s[28:31], s54 offen offset:3072 sc1 lds
    s_add_u32 m0, s64, 124928
    s_nop 0
    buffer_load_dwordx4 v207, s[24:27], s50 offen lds
    s_add_u32 m0, s64, 129024
    s_nop 0
    buffer_load_dwordx4 v208, s[24:27], s50 offen lds
    s_mov_b32 m0, 130048
    s_cmp_eq_u32 s46, 3
    s_cselect_b64 exec, -1, 0
    buffer_load_dwordx4 v206, s[28:31], s54 offen offset:3072 sc1 lds
    s_mov_b64 exec, -1
    s_mov_b32 m0, 142336
    s_cmp_eq_u32 s46, 1
    s_cselect_b64 exec, -1, 0
    buffer_load_dwordx4 v209, s[24:27], s50 offen lds
    s_mov_b64 exec, -1
    s_waitcnt vmcnt(8)
    s_barrier
    s_add_u32 m0, s63, 69632
    s_add_u32 s50, s61, 0
    buffer_load_dwordx4 v204, s[28:31], s55 offen offset:0 sc1 lds
    s_add_u32 m0, s63, 73728
    s_nop 0
    buffer_load_dwordx4 v205, s[28:31], s55 offen offset:0 sc1 lds
    s_add_u32 m0, s64, 69632
    s_nop 0
    buffer_load_dwordx4 v207, s[24:27], s50 offen lds
    s_add_u32 m0, s64, 73728
    s_nop 0
    buffer_load_dwordx4 v208, s[24:27], s50 offen lds
    s_mov_b32 m0, 77824
    s_cmp_eq_u32 s46, 0
    s_cselect_b64 exec, -1, 0
    buffer_load_dwordx4 v206, s[28:31], s55 offen offset:0 sc1 lds
    s_mov_b64 exec, -1
    s_mov_b32 m0, 87040
    s_cmp_eq_u32 s46, 2
    s_cselect_b64 exec, -1, 0
    buffer_load_dwordx4 v209, s[24:27], s50 offen lds
    s_mov_b64 exec, -1
    s_waitcnt vmcnt(8)
    s_barrier
    s_add_u32 m0, s63, 87040
    s_add_u32 s50, s61, 36864
    buffer_load_dwordx4 v204, s[28:31], s55 offen offset:1024 sc1 lds
    s_add_u32 m0, s63, 91136
    s_nop 0
    buffer_load_dwordx4 v205, s[28:31], s55 offen offset:1024 sc1 lds
    s_add_u32 m0, s64, 88064
    s_nop 0
    buffer_load_dwordx4 v207, s[24:27], s50 offen lds
    s_add_u32 m0, s64, 92160
    s_nop 0
    buffer_load_dwordx4 v208, s[24:27], s50 offen lds
    s_mov_b32 m0, 95232
    s_cmp_eq_u32 s46, 1
    s_cselect_b64 exec, -1, 0
    buffer_load_dwordx4 v206, s[28:31], s55 offen offset:1024 sc1 lds
    s_mov_b64 exec, -1
    s_mov_b32 m0, 105472
    s_cmp_eq_u32 s46, 3
    s_cselect_b64 exec, -1, 0
    buffer_load_dwordx4 v209, s[24:27], s50 offen lds
    s_mov_b64 exec, -1
    s_waitcnt vmcnt(8)
    s_barrier
    s_add_u32 m0, s63, 104448
    s_add_u32 s50, s61, 73728
    buffer_load_dwordx4 v204, s[28:31], s55 offen offset:2048 sc1 lds
    s_add_u32 m0, s63, 108544
    s_nop 0
    buffer_load_dwordx4 v205, s[28:31], s55 offen offset:2048 sc1 lds
    s_add_u32 m0, s64, 106496
    s_nop 0
    buffer_load_dwordx4 v207, s[24:27], s50 offen lds
    s_add_u32 m0, s64, 110592
    s_nop 0
    buffer_load_dwordx4 v208, s[24:27], s50 offen lds
    s_mov_b32 m0, 112640
    s_cmp_eq_u32 s46, 2
    s_cselect_b64 exec, -1, 0
    buffer_load_dwordx4 v206, s[28:31], s55 offen offset:2048 sc1 lds
    s_mov_b64 exec, -1
    s_mov_b32 m0, 123904
    s_cmp_eq_u32 s46, 0
    s_cselect_b64 exec, -1, 0
    buffer_load_dwordx4 v209, s[24:27], s50 offen lds
    s_mov_b64 exec, -1
    s_waitcnt vmcnt(8)
    s_barrier
    s_add_u32 m0, s63, 121856
    s_add_u32 s50, s61, 110592
    buffer_load_dwordx4 v204, s[28:31], s55 offen offset:3072 sc1 lds
    s_add_u32 m0, s63, 125952
    s_nop 0
    buffer_load_dwordx4 v205, s[28:31], s55 offen offset:3072 sc1 lds
    s_add_u32 m0, s64, 124928
    s_nop 0
    buffer_load_dwordx4 v207, s[24:27], s50 offen lds
    s_add_u32 m0, s64, 129024
    s_nop 0
    buffer_load_dwordx4 v208, s[24:27], s50 offen lds
    s_mov_b32 m0, 130048
    s_cmp_eq_u32 s46, 3
    s_cselect_b64 exec, -1, 0
    buffer_load_dwordx4 v206, s[28:31], s55 offen offset:3072 sc1 lds
    s_mov_b64 exec, -1
    s_mov_b32 m0, 142336
    s_cmp_eq_u32 s46, 1
    s_cselect_b64 exec, -1, 0
    buffer_load_dwordx4 v209, s[24:27], s50 offen lds
    s_mov_b64 exec, -1
    s_waitcnt vmcnt(8)
    s_barrier
    s_waitcnt vmcnt(4)
    s_barrier
    s_waitcnt vmcnt(0)
    s_barrier
    s_barrier
    s_barrier

    s_andn2_b32 s47, s2, 6
    v_and_b32 v246, 3, v238
    v_lshlrev_b32 v246, 1, v246
    v_add_u32 v246, s47, v246
    v_lshlrev_b32 v246, 9, v246
    v_add_u32 v246, 50331904, v246
    s_mov_b32 s57, 100000

L_poll_31:

    global_load_dwordx2 v[244:245], v246, s[40:41] sc1
    s_waitcnt vmcnt(0)
    v_cmp_ne_u32 vcc, s44, v244
    v_cmp_ne_u32 s[68:69], s45, v245
    s_sub_u32 s57, s57, 1
    s_cmp_eq_u32 s57, 0
    s_cbranch_scc1 L_polld_32
    s_or_b64 vcc, vcc, s[68:69]
    s_cmp_lg_u64 vcc, 0
    s_cbranch_scc0 L_polld_32
    s_sleep 1
    s_branch L_poll_31

L_polld_32:

    s_lshl_b32 s47, s4, 2
    s_add_u32 s47, s47, s5
    s_mul_i32 s53, s47, 165888
    s_lshl_b32 s61, s6, 3
    s_add_u32 s61, s61, s3
    v_lshlrev_b32 v243, 4, v238
    v_lshlrev_b32 v244, 3, v238
    v_and_b32 v245, 15, v238
    v_mul_u32_u24 v245, 1152, v245
    v_lshrrev_b32 v246, 4, v238
    v_lshl_add_u32 v245, v246, 3, v245
    s_mul_i32 s54, s4, 165888
    s_mul_i32 s47, s5, 288
    s_add_u32 s54, s54, s47

    s_lshl_b32 s48, s61, 10
    s_add_u32 s48, s48, s53
    buffer_load_dwordx4 v[0:3], v243, s[32:35], s48 offen sc1
    s_add_u32 s48, s48, 41472
    buffer_load_dwordx4 v[4:7], v243, s[32:35], s48 offen sc1
    s_add_u32 s48, s48, 41472
    buffer_load_dwordx4 v[8:11], v243, s[32:35], s48 offen sc1
    s_add_u32 s48, s48, 41472
    buffer_load_dwordx4 v[12:15], v243, s[32:35], s48 offen sc1

    s_add_u32 s65, s61, 32
    s_cmp_ge_u32 s65, 45
    s_cbranch_scc1 L_fr_w_35
    s_cmp_ge_u32 s65, 36
    s_cbranch_scc1 L_fr_h_33
    s_lshl_b32 s48, s65, 10
    s_add_u32 s48, s48, s53

    buffer_load_dwordx4 v[16:19], v243, s[32:35], s48 offen sc1
    s_add_u32 s48, s48, 41472
    buffer_load_dwordx4 v[20:23], v243, s[32:35], s48 offen sc1
    s_add_u32 s48, s48, 41472
    buffer_load_dwordx4 v[24:27], v243, s[32:35], s48 offen sc1
    s_add_u32 s48, s48, 41472
    buffer_load_dwordx4 v[28:31], v243, s[32:35], s48 offen sc1
    s_branch L_fr_w_35
L_fr_h_33:

    s_sub_u32 s48, s65, 36
    s_lshl_b32 s48, s48, 9
    s_add_u32 s48, s48, 36864
    s_add_u32 s48, s48, s53

    buffer_load_dwordx2 v[16:17], v244, s[32:35], s48 offen sc1
    s_add_u32 s48, s48, 41472
    buffer_load_dwordx2 v[20:21], v244, s[32:35], s48 offen sc1
    s_add_u32 s48, s48, 41472
    buffer_load_dwordx2 v[24:25], v244, s[32:35], s48 offen sc1
    s_add_u32 s48, s48, 41472
    buffer_load_dwordx2 v[28:29], v244, s[32:35], s48 offen sc1
L_fr_w_35:
    s_waitcnt vmcnt(0)
    v_lshlrev_b32 v40, 16, v0
    v_and_b32 v44, 0xffff0000, v0
    v_lshlrev_b32 v41, 16, v4
    v_and_b32 v45, 0xffff0000, v4
    v_lshlrev_b32 v42, 16, v8
    v_and_b32 v46, 0xffff0000, v8
    v_lshlrev_b32 v43, 16, v12
    v_and_b32 v47, 0xffff0000, v12
    v_add_f32 v40, v40, v41
    v_add_f32 v42, v42, v43
    v_add_f32 v44, v44, v45
    v_add_f32 v46, v46, v47
    v_add_f32 v40, v40, v42
    v_add_f32 v44, v44, v46
    v_cvt_pk_bf16_f32 v48, v40, v44
    v_lshlrev_b32 v40, 16, v1
    v_and_b32 v44, 0xffff0000, v1
    v_lshlrev_b32 v41, 16, v5
    v_and_b32 v45, 0xffff0000, v5
    v_lshlrev_b32 v42, 16, v9
    v_and_b32 v46, 0xffff0000, v9
    v_lshlrev_b32 v43, 16, v13
    v_and_b32 v47, 0xffff0000, v13
    v_add_f32 v40, v40, v41
    v_add_f32 v42, v42, v43
    v_add_f32 v44, v44, v45
    v_add_f32 v46, v46, v47
    v_add_f32 v40, v40, v42
    v_add_f32 v44, v44, v46
    v_cvt_pk_bf16_f32 v49, v40, v44
    v_lshlrev_b32 v40, 16, v2
    v_and_b32 v44, 0xffff0000, v2
    v_lshlrev_b32 v41, 16, v6
    v_and_b32 v45, 0xffff0000, v6
    v_lshlrev_b32 v42, 16, v10
    v_and_b32 v46, 0xffff0000, v10
    v_lshlrev_b32 v43, 16, v14
    v_and_b32 v47, 0xffff0000, v14
    v_add_f32 v40, v40, v41
    v_add_f32 v42, v42, v43
    v_add_f32 v44, v44, v45
    v_add_f32 v46, v46, v47
    v_add_f32 v40, v40, v42
    v_add_f32 v44, v44, v46
    v_cvt_pk_bf16_f32 v50, v40, v44
    v_lshlrev_b32 v40, 16, v3
    v_and_b32 v44, 0xffff0000, v3
    v_lshlrev_b32 v41, 16, v7
    v_and_b32 v45, 0xffff0000, v7
    v_lshlrev_b32 v42, 16, v11
    v_and_b32 v46, 0xffff0000, v11
    v_lshlrev_b32 v43, 16, v15
    v_and_b32 v47, 0xffff0000, v15
    v_add_f32 v40, v40, v41
    v_add_f32 v42, v42, v43
    v_add_f32 v44, v44, v45
    v_add_f32 v46, v46, v47
    v_add_f32 v40, v40, v42
    v_add_f32 v44, v44, v46
    v_cvt_pk_bf16_f32 v51, v40, v44

    s_mul_i32 s48, s61, 57
    s_lshr_b32 s48, s48, 9
    s_mul_i32 s49, s48, 9
    s_sub_u32 s49, s61, s49
    s_mul_i32 s49, s49, 18432
    s_lshl_b32 s48, s48, 6
    s_add_u32 s49, s49, s48
    s_add_u32 s49, s49, s54

    buffer_store_dwordx2 v[48:49], v245, s[36:39], s49 offen
    buffer_store_dwordx2 v[50:51], v245, s[36:39], s49 offen offset:32

    s_cmp_ge_u32 s65, 45
    s_cbranch_scc1 L_fr_e_36
    s_cmp_ge_u32 s65, 36
    s_cbranch_scc1 L_fr_h2_37
    s_nop 1

    v_lshlrev_b32 v40, 16, v16
    v_and_b32 v44, 0xffff0000, v16
    v_lshlrev_b32 v41, 16, v20
    v_and_b32 v45, 0xffff0000, v20
    v_lshlrev_b32 v42, 16, v24
    v_and_b32 v46, 0xffff0000, v24
    v_lshlrev_b32 v43, 16, v28
    v_and_b32 v47, 0xffff0000, v28
    v_add_f32 v40, v40, v41
    v_add_f32 v42, v42, v43
    v_add_f32 v44, v44, v45
    v_add_f32 v46, v46, v47
    v_add_f32 v40, v40, v42
    v_add_f32 v44, v44, v46
    v_cvt_pk_bf16_f32 v48, v40, v44
    v_lshlrev_b32 v40, 16, v17
    v_and_b32 v44, 0xffff0000, v17
    v_lshlrev_b32 v41, 16, v21
    v_and_b32 v45, 0xffff0000, v21
    v_lshlrev_b32 v42, 16, v25
    v_and_b32 v46, 0xffff0000, v25
    v_lshlrev_b32 v43, 16, v29
    v_and_b32 v47, 0xffff0000, v29
    v_add_f32 v40, v40, v41
    v_add_f32 v42, v42, v43
    v_add_f32 v44, v44, v45
    v_add_f32 v46, v46, v47
    v_add_f32 v40, v40, v42
    v_add_f32 v44, v44, v46
    v_cvt_pk_bf16_f32 v49, v40, v44
    v_lshlrev_b32 v40, 16, v18
    v_and_b32 v44, 0xffff0000, v18
    v_lshlrev_b32 v41, 16, v22
    v_and_b32 v45, 0xffff0000, v22
    v_lshlrev_b32 v42, 16, v26
    v_and_b32 v46, 0xffff0000, v26
    v_lshlrev_b32 v43, 16, v30
    v_and_b32 v47, 0xffff0000, v30
    v_add_f32 v40, v40, v41
    v_add_f32 v42, v42, v43
    v_add_f32 v44, v44, v45
    v_add_f32 v46, v46, v47
    v_add_f32 v40, v40, v42
    v_add_f32 v44, v44, v46
    v_cvt_pk_bf16_f32 v50, v40, v44
    v_lshlrev_b32 v40, 16, v19
    v_and_b32 v44, 0xffff0000, v19
    v_lshlrev_b32 v41, 16, v23
    v_and_b32 v45, 0xffff0000, v23
    v_lshlrev_b32 v42, 16, v27
    v_and_b32 v46, 0xffff0000, v27
    v_lshlrev_b32 v43, 16, v31
    v_and_b32 v47, 0xffff0000, v31
    v_add_f32 v40, v40, v41
    v_add_f32 v42, v42, v43
    v_add_f32 v44, v44, v45
    v_add_f32 v46, v46, v47
    v_add_f32 v40, v40, v42
    v_add_f32 v44, v44, v46
    v_cvt_pk_bf16_f32 v51, v40, v44

    s_mul_i32 s48, s65, 57
    s_lshr_b32 s48, s48, 9
    s_mul_i32 s49, s48, 9
    s_sub_u32 s49, s65, s49
    s_mul_i32 s49, s49, 18432
    s_lshl_b32 s48, s48, 6
    s_add_u32 s49, s49, s48
    s_add_u32 s49, s49, s54

    buffer_store_dwordx2 v[48:49], v245, s[36:39], s49 offen
    buffer_store_dwordx2 v[50:51], v245, s[36:39], s49 offen offset:32
    s_branch L_fr_e_36
L_fr_h2_37:
    s_nop 1
    v_lshlrev_b32 v40, 16, v16
    v_and_b32 v44, 0xffff0000, v16
    v_lshlrev_b32 v41, 16, v20
    v_and_b32 v45, 0xffff0000, v20
    v_lshlrev_b32 v42, 16, v24
    v_and_b32 v46, 0xffff0000, v24
    v_lshlrev_b32 v43, 16, v28
    v_and_b32 v47, 0xffff0000, v28
    v_add_f32 v40, v40, v41
    v_add_f32 v42, v42, v43
    v_add_f32 v44, v44, v45
    v_add_f32 v46, v46, v47
    v_add_f32 v40, v40, v42
    v_add_f32 v44, v44, v46
    v_cvt_pk_bf16_f32 v48, v40, v44
    v_lshlrev_b32 v40, 16, v17
    v_and_b32 v44, 0xffff0000, v17
    v_lshlrev_b32 v41, 16, v21
    v_and_b32 v45, 0xffff0000, v21
    v_lshlrev_b32 v42, 16, v25
    v_and_b32 v46, 0xffff0000, v25
    v_lshlrev_b32 v43, 16, v29
    v_and_b32 v47, 0xffff0000, v29
    v_add_f32 v40, v40, v41
    v_add_f32 v42, v42, v43
    v_add_f32 v44, v44, v45
    v_add_f32 v46, v46, v47
    v_add_f32 v40, v40, v42
    v_add_f32 v44, v44, v46
    v_cvt_pk_bf16_f32 v49, v40, v44

    s_sub_u32 s49, s65, 36
    s_mul_i32 s49, s49, 18432
    s_add_u32 s49, s49, 256
    s_add_u32 s49, s49, s54
    buffer_store_dwordx2 v[48:49], v245, s[36:39], s49 offen

L_fr_e_36:
    s_waitcnt vmcnt(0)
    s_waitcnt vmcnt(0)
    s_endpgm
L_a_safe:

    s_barrier
    s_cmp_eq_u32 s92, 0
    s_mov_b32 s98, 0
    s_cselect_b32 s98, 106496, s98
    s_and_b32 s48, s46, 1
    s_mul_i32 s48, s48, 4352

    v_add_u32 v230, s98, v230
    v_add_u32 v231, s98, v231
    v_add_u32 v232, s98, v232
    v_add_u32 v233, s98, v233
    v_add_u32 v234, s98, v234
    v_add_u32 v235, s98, v235
    v_subrev_u32 v232, s48, v232
    v_mov_b64 v[0:1], 0
    v_mov_b64 v[2:3], 0
    v_mov_b64 v[4:5], 0
    v_mov_b64 v[6:7], 0
    v_mov_b64 v[8:9], 0
    v_mov_b64 v[10:11], 0
    v_mov_b64 v[12:13], 0
    v_mov_b64 v[14:15], 0
    v_mov_b64 v[16:17], 0
    v_mov_b64 v[18:19], 0
    v_mov_b64 v[20:21], 0
    v_mov_b64 v[22:23], 0
    v_mov_b64 v[24:25], 0
    v_mov_b64 v[26:27], 0
    v_mov_b64 v[28:29], 0
    v_mov_b64 v[30:31], 0
    v_mov_b64 v[32:33], 0
    v_mov_b64 v[34:35], 0
    v_mov_b64 v[36:37], 0
    v_mov_b64 v[38:39], 0
    v_mov_b64 v[40:41], 0
    v_mov_b64 v[42:43], 0
    v_mov_b64 v[44:45], 0
    v_mov_b64 v[46:47], 0
    v_mov_b64 v[48:49], 0
    v_mov_b64 v[50:51], 0
    v_mov_b64 v[52:53], 0
    v_mov_b64 v[54:55], 0
    v_mov_b64 v[56:57], 0
    v_mov_b64 v[58:59], 0
    v_mov_b64 v[60:61], 0
    v_mov_b64 v[62:63], 0
    v_mov_b64 v[64:65], 0
    v_mov_b64 v[66:67], 0
    v_mov_b64 v[68:69], 0
    v_mov_b64 v[70:71], 0
    v_mov_b32 v228, 0
    v_mov_b32 v229, 0

    v_mov_b32 v239, 0xff800000
    v_mov_b32 v240, 0xff800000
    s_lshl_b32 s89, s92, 17
    s_mov_b32 s91, 0

L_a_safe_loop:
    s_add_u32 s49, s96, s98
    s_add_u32 s50, s97, s98
    s_add_u32 m0, s49, 0
    s_nop 0
    buffer_load_dwordx4 v254, s[16:19], s89 offen lds
    s_add_u32 m0, s49, 64
    s_nop 0
    buffer_load_dwordx4 v254, s[16:19], s89 offen offset:1024 lds
    s_add_u32 m0, s50, 0
    s_nop 0
    buffer_load_dwordx4 v237, s[20:23], s89 offen lds
    s_add_u32 m0, s50, 832
    s_nop 0
    buffer_load_dwordx4 v237, s[20:23], s89 offen offset:256 lds
    s_add_u32 s89, s89, 8192
    s_waitcnt vmcnt(0)
    s_barrier
    ds_read_b128 v[172:175], v230 offset:0
    ds_read_b128 v[176:179], v231 offset:0
    ds_read_b128 v[180:183], v230 offset:64
    ds_read_b128 v[184:187], v231 offset:64
    ds_read_b128 v[188:191], v230 offset:128
    ds_read_b128 v[192:195], v231 offset:128
    ds_read_b128 v[196:199], v230 offset:192
    ds_read_b128 v[200:203], v231 offset:192
    ds_read_b128 v[204:207], v232 offset:0
    ds_read_b128 v[208:211], v232 offset:64
    ds_read_b128 v[212:215], v232 offset:128
    ds_read_b128 v[216:219], v232 offset:192
    ds_read_b128 v[136:139], v232 offset:4352
    ds_read_b128 v[140:143], v232 offset:4416
    ds_read_b128 v[144:147], v232 offset:4480
    ds_read_b128 v[148:151], v232 offset:4544
    s_waitcnt lgkmcnt(0)
    v_mfma_f32_32x32x16_bf16 v[120:135], v[172:175], v[72:75], 0
    v_mfma_f32_32x32x16_bf16 v[120:135], v[176:179], v[76:79], v[120:135]
    v_mfma_f32_32x32x16_bf16 v[120:135], v[180:183], v[80:83], v[120:135]
    v_mfma_f32_32x32x16_bf16 v[120:135], v[184:187], v[84:87], v[120:135]
    v_mfma_f32_32x32x16_bf16 v[120:135], v[188:191], v[88:91], v[120:135]
    v_mfma_f32_32x32x16_bf16 v[120:135], v[192:195], v[92:95], v[120:135]
    v_mfma_f32_32x32x16_bf16 v[120:135], v[196:199], v[96:99], v[120:135]
    v_mfma_f32_32x32x16_bf16 v[120:135], v[200:203], v[100:103], v[120:135]
    v_mfma_f32_16x16x32_bf16 v[152:155], v[204:207], v[104:107], 0
    v_mfma_f32_16x16x32_bf16 v[152:155], v[208:211], v[108:111], v[152:155]
    v_mfma_f32_16x16x32_bf16 v[152:155], v[212:215], v[112:115], v[152:155]
    v_mfma_f32_16x16x32_bf16 v[152:155], v[216:219], v[116:119], v[152:155]
    v_mfma_f32_16x16x32_bf16 v[164:167], v[136:139], v[104:107], 0
    v_mfma_f32_16x16x32_bf16 v[164:167], v[140:143], v[108:111], v[164:167]
    v_mfma_f32_16x16x32_bf16 v[164:167], v[144:147], v[112:115], v[164:167]
    v_mfma_f32_16x16x32_bf16 v[164:167], v[148:151], v[116:119], v[164:167]
    ds_read_b64_tr_b16 v[172:173], v233 offset:0
    ds_read_b64_tr_b16 v[174:175], v233 offset:512
    ds_read_b64_tr_b16 v[176:177], v233 offset:64
    ds_read_b64_tr_b16 v[178:179], v233 offset:576
    ds_read_b64_tr_b16 v[180:181], v233 offset:128
    ds_read_b64_tr_b16 v[182:183], v233 offset:640
    ds_read_b64_tr_b16 v[184:185], v233 offset:192
    ds_read_b64_tr_b16 v[186:187], v233 offset:704
    ds_read_b64_tr_b16 v[188:189], v233 offset:4352
    ds_read_b64_tr_b16 v[190:191], v233 offset:4864
    ds_read_b64_tr_b16 v[192:193], v233 offset:4416
    ds_read_b64_tr_b16 v[194:195], v233 offset:4928
    ds_read_b64_tr_b16 v[196:197], v233 offset:4480
    ds_read_b64_tr_b16 v[198:199], v233 offset:4992
    ds_read_b64_tr_b16 v[200:201], v233 offset:4544
    ds_read_b64_tr_b16 v[202:203], v233 offset:5056
    ds_read_b64_tr_b16 v[220:221], v234
    ds_read_b64_tr_b16 v[222:223], v234 offset:4352
    ds_read_b64_tr_b16 v[224:225], v235
    ds_read_b64_tr_b16 v[226:227], v235 offset:4352
    s_nop 7
    s_nop 3
    v_max3_f32 v243, v120, v121, v122
    v_max3_f32 v243, v243, v123, v124
    v_max3_f32 v243, v243, v125, v126
    v_max3_f32 v243, v243, v127, v128
    v_max3_f32 v243, v243, v129, v130
    v_max3_f32 v243, v243, v131, v132
    v_max3_f32 v243, v243, v133, v134
    v_max_f32 v243, v243, v135
    v_mov_b32 v244, v243
    s_nop 1
    v_permlane32_swap_b32 v243, v244
    s_nop 1
    v_max_f32 v243, v243, v244
    v_max_f32 v243, v243, v239
    v_sub_f32 v244, v239, v243
    v_exp_f32 v244, v244
    v_mov_b32 v239, v243
    v_sub_f32 v120, v120, v243
    v_sub_f32 v121, v121, v243
    v_sub_f32 v122, v122, v243
    v_sub_f32 v123, v123, v243
    v_sub_f32 v124, v124, v243
    v_sub_f32 v125, v125, v243
    v_sub_f32 v126, v126, v243
    v_sub_f32 v127, v127, v243
    v_sub_f32 v128, v128, v243
    v_sub_f32 v129, v129, v243
    v_sub_f32 v130, v130, v243
    v_sub_f32 v131, v131, v243
    v_sub_f32 v132, v132, v243
    v_sub_f32 v133, v133, v243
    v_sub_f32 v134, v134, v243
    v_sub_f32 v135, v135, v243
    v_mul_f32 v228, v228, v244
    v_mul_f32 v0, v0, v244
    v_mul_f32 v1, v1, v244
    v_mul_f32 v2, v2, v244
    v_mul_f32 v3, v3, v244
    v_mul_f32 v4, v4, v244
    v_mul_f32 v5, v5, v244
    v_mul_f32 v6, v6, v244
    v_mul_f32 v7, v7, v244
    v_mul_f32 v8, v8, v244
    v_mul_f32 v9, v9, v244
    v_mul_f32 v10, v10, v244
    v_mul_f32 v11, v11, v244
    v_mul_f32 v12, v12, v244
    v_mul_f32 v13, v13, v244
    v_mul_f32 v14, v14, v244
    v_mul_f32 v15, v15, v244
    v_mul_f32 v16, v16, v244
    v_mul_f32 v17, v17, v244
    v_mul_f32 v18, v18, v244
    v_mul_f32 v19, v19, v244
    v_mul_f32 v20, v20, v244
    v_mul_f32 v21, v21, v244
    v_mul_f32 v22, v22, v244
    v_mul_f32 v23, v23, v244
    v_mul_f32 v24, v24, v244
    v_mul_f32 v25, v25, v244
    v_mul_f32 v26, v26, v244
    v_mul_f32 v27, v27, v244
    v_mul_f32 v28, v28, v244
    v_mul_f32 v29, v29, v244
    v_mul_f32 v30, v30, v244
    v_mul_f32 v31, v31, v244
    v_mul_f32 v32, v32, v244
    v_mul_f32 v33, v33, v244
    v_mul_f32 v34, v34, v244
    v_mul_f32 v35, v35, v244
    v_mul_f32 v36, v36, v244
    v_mul_f32 v37, v37, v244
    v_mul_f32 v38, v38, v244
    v_mul_f32 v39, v39, v244
    v_mul_f32 v40, v40, v244
    v_mul_f32 v41, v41, v244
    v_mul_f32 v42, v42, v244
    v_mul_f32 v43, v43, v244
    v_mul_f32 v44, v44, v244
    v_mul_f32 v45, v45, v244
    v_mul_f32 v46, v46, v244
    v_mul_f32 v47, v47, v244
    v_mul_f32 v48, v48, v244
    v_mul_f32 v49, v49, v244
    v_mul_f32 v50, v50, v244
    v_mul_f32 v51, v51, v244
    v_mul_f32 v52, v52, v244
    v_mul_f32 v53, v53, v244
    v_mul_f32 v54, v54, v244
    v_mul_f32 v55, v55, v244
    v_mul_f32 v56, v56, v244
    v_mul_f32 v57, v57, v244
    v_mul_f32 v58, v58, v244
    v_mul_f32 v59, v59, v244
    v_mul_f32 v60, v60, v244
    v_mul_f32 v61, v61, v244
    v_mul_f32 v62, v62, v244
    v_mul_f32 v63, v63, v244
    v_max3_f32 v243, v152, v153, v154
    v_max3_f32 v243, v243, v155, v164
    v_max3_f32 v243, v243, v165, v166
    v_max_f32 v243, v243, v167
    v_mov_b32 v244, v243
    s_nop 1
    v_permlane32_swap_b32 v243, v244
    s_nop 1
    v_max_f32 v243, v243, v244
    v_mov_b32 v244, v243
    s_nop 1
    v_permlane16_swap_b32 v243, v244
    s_nop 1
    v_max_f32 v243, v243, v244
    v_max_f32 v243, v243, v240
    v_sub_f32 v244, v240, v243
    v_exp_f32 v244, v244
    v_mov_b32 v240, v243
    v_sub_f32 v152, v152, v243
    v_sub_f32 v153, v153, v243
    v_sub_f32 v154, v154, v243
    v_sub_f32 v155, v155, v243
    v_sub_f32 v164, v164, v243
    v_sub_f32 v165, v165, v243
    v_sub_f32 v166, v166, v243
    v_sub_f32 v167, v167, v243
    v_mul_f32 v229, v229, v244
    v_mul_f32 v64, v64, v244
    v_mul_f32 v65, v65, v244
    v_mul_f32 v66, v66, v244
    v_mul_f32 v67, v67, v244
    v_mul_f32 v68, v68, v244
    v_mul_f32 v69, v69, v244
    v_mul_f32 v70, v70, v244
    v_mul_f32 v71, v71, v244
    v_exp_f32 v120, v120
    v_exp_f32 v121, v121
    v_exp_f32 v122, v122
    v_exp_f32 v123, v123
    v_exp_f32 v124, v124
    v_exp_f32 v125, v125
    v_exp_f32 v126, v126
    v_exp_f32 v127, v127
    v_exp_f32 v128, v128
    v_exp_f32 v129, v129
    v_exp_f32 v130, v130
    v_exp_f32 v131, v131
    v_exp_f32 v132, v132
    v_exp_f32 v133, v133
    v_exp_f32 v134, v134
    v_exp_f32 v135, v135
    v_exp_f32 v152, v152
    v_exp_f32 v153, v153
    v_exp_f32 v154, v154
    v_exp_f32 v155, v155
    v_exp_f32 v164, v164
    v_exp_f32 v165, v165
    v_exp_f32 v166, v166
    v_exp_f32 v167, v167
    v_cvt_pk_bf16_f32 v156, v120, v121
    v_cvt_pk_bf16_f32 v157, v122, v123
    v_cvt_pk_bf16_f32 v158, v124, v125
    v_cvt_pk_bf16_f32 v159, v126, v127
    v_cvt_pk_bf16_f32 v160, v128, v129
    v_cvt_pk_bf16_f32 v161, v130, v131
    v_cvt_pk_bf16_f32 v162, v132, v133
    v_cvt_pk_bf16_f32 v163, v134, v135
    v_cvt_pk_bf16_f32 v168, v152, v153
    v_cvt_pk_bf16_f32 v169, v154, v155
    v_cvt_pk_bf16_f32 v170, v164, v165
    v_cvt_pk_bf16_f32 v171, v166, v167
    v_add_f32 v228, v228, v120
    v_add_f32 v228, v228, v121
    v_add_f32 v228, v228, v122
    v_add_f32 v228, v228, v123
    v_add_f32 v228, v228, v124
    v_add_f32 v228, v228, v125
    v_add_f32 v228, v228, v126
    v_add_f32 v228, v228, v127
    v_add_f32 v228, v228, v128
    v_add_f32 v228, v228, v129
    v_add_f32 v228, v228, v130
    v_add_f32 v228, v228, v131
    v_add_f32 v228, v228, v132
    v_add_f32 v228, v228, v133
    v_add_f32 v228, v228, v134
    v_add_f32 v228, v228, v135
    v_add_f32 v229, v229, v152
    v_add_f32 v229, v229, v153
    v_add_f32 v229, v229, v154
    v_add_f32 v229, v229, v155
    v_add_f32 v229, v229, v164
    v_add_f32 v229, v229, v165
    v_add_f32 v229, v229, v166
    v_add_f32 v229, v229, v167
    s_waitcnt lgkmcnt(0)
    v_mfma_f32_32x32x16_bf16 v[0:15], v[172:175], v[156:159], v[0:15]
    v_mfma_f32_32x32x16_bf16 v[16:31], v[176:179], v[156:159], v[16:31]
    v_mfma_f32_32x32x16_bf16 v[32:47], v[180:183], v[156:159], v[32:47]
    v_mfma_f32_32x32x16_bf16 v[48:63], v[184:187], v[156:159], v[48:63]
    v_mfma_f32_32x32x16_bf16 v[0:15], v[188:191], v[160:163], v[0:15]
    v_mfma_f32_32x32x16_bf16 v[16:31], v[192:195], v[160:163], v[16:31]
    v_mfma_f32_32x32x16_bf16 v[32:47], v[196:199], v[160:163], v[32:47]
    v_mfma_f32_32x32x16_bf16 v[48:63], v[200:203], v[160:163], v[48:63]
    v_mfma_f32_16x16x32_bf16 v[64:67], v[220:223], v[168:171], v[64:67]
    v_mfma_f32_16x16x32_bf16 v[68:71], v[224:227], v[168:171], v[68:71]

    s_barrier
    s_add_u32 s91, s91, 1
    s_cmp_lt_u32 s91, 16
    s_cbranch_scc1 L_a_safe_loop
    s_and_b32 s48, s46, 1
    s_mul_i32 s48, s48, 4352

    v_subrev_u32 v230, s98, v230
    v_subrev_u32 v231, s98, v231
    v_subrev_u32 v232, s98, v232
    v_subrev_u32 v233, s98, v233
    v_subrev_u32 v234, s98, v234
    v_subrev_u32 v235, s98, v235
    v_add_u32 v232, s48, v232
    s_nop 7
    v_mov_b32 v250, v228
    s_nop 1
    v_permlane32_swap_b32 v228, v250
    s_nop 1
    v_add_f32 v228, v228, v250
    v_mov_b32 v250, v229
    s_nop 1
    v_permlane32_swap_b32 v229, v250
    s_nop 1
    v_add_f32 v229, v229, v250
    v_mov_b32 v250, v229
    s_nop 1
    v_permlane16_swap_b32 v229, v250
    s_nop 1
    v_add_f32 v229, v229, v250
    s_cmp_eq_u32 s92, 0
    s_cbranch_scc1 L_es2_38

    v_lshlrev_b32 v247, 4, v238
    s_lshl_b32 s47, s46, 12
    v_add_u32 v204, s47, v247
    v_add_u32 v205, 16384, v204
    v_add_u32 v206, 32768, v247
    v_lshrrev_b32 v247, 4, v238
    v_and_b32 v248, 15, v238
    v_lshlrev_b32 v249, 2, v247
    v_xor_b32 v248, v248, v249
    s_and_b32 s47, s46, 1
    s_lshl_b32 s47, s47, 1
    v_xor_b32 v248, s47, v248
    s_lshl_b32 s47, s46, 2
    v_add_u32 v247, s47, v247
    v_mul_u32_u24 v247, 1152, v247
    v_lshl_add_u32 v207, v248, 4, v247
    v_add_u32 v208, 18432, v207
    v_lshrrev_b32 v247, 1, v238
    v_mul_u32_u24 v247, 1152, v247
    v_and_b32 v248, 1, v238
    v_lshl_add_u32 v247, v248, 4, v247
    v_add_u32 v209, 256, v247
    s_mov_b32 s52, 69632
    s_mov_b32 s60, 0
    s_mov_b32 s61, 0

    s_lshr_b32 s47, s61, 2
    s_add_u32 s47, s47, s5
    s_and_b32 s47, s47, 3
    s_lshl_b32 s47, s47, 1
    s_add_u32 s47, s47, s62
    s_lshl_b32 s48, s6, 3
    s_add_u32 s47, s47, s48
    s_mul_i32 s54, s47, 147456
    s_mul_i32 s53, s5, 288
    s_add_u32 s54, s54, s53
    s_lshl_b32 s53, s4, 5
    s_add_u32 s53, s53, s47
    s_mul_i32 s53, s53, 36864

    s_add_u32 s47, s5, 0
    s_and_b32 s47, s47, 3
    s_lshl_b32 s47, s47, 1
    s_add_u32 s47, s47, s62
    s_lshl_b32 s48, s6, 3
    s_add_u32 s47, s47, s48
    s_mul_i32 s58, s47, 147456
    s_mul_i32 s48, s5, 288
    s_add_u32 s58, s58, s48
    s_lshl_b32 s48, s4, 5
    s_add_u32 s48, s48, s47
    s_mul_i32 s52, s48, 36864

    s_add_u32 s47, s5, 1
    s_and_b32 s47, s47, 3
    s_lshl_b32 s47, s47, 1
    s_add_u32 s47, s47, s62
    s_lshl_b32 s48, s6, 3
    s_add_u32 s47, s47, s48
    s_mul_i32 s59, s47, 147456
    s_mul_i32 s48, s5, 288
    s_add_u32 s59, s59, s48
    s_lshl_b32 s48, s4, 5
    s_add_u32 s48, s48, s47
    s_mul_i32 s53, s48, 36864

    s_add_u32 s47, s5, 2
    s_and_b32 s47, s47, 3
    s_lshl_b32 s47, s47, 1
    s_add_u32 s47, s47, s62
    s_lshl_b32 s48, s6, 3
    s_add_u32 s47, s47, s48
    s_mul_i32 s60, s47, 147456
    s_mul_i32 s48, s5, 288
    s_add_u32 s60, s60, s48
    s_lshl_b32 s48, s4, 5
    s_add_u32 s48, s48, s47
    s_mul_i32 s54, s48, 36864

    s_add_u32 s47, s5, 3
    s_and_b32 s47, s47, 3
    s_lshl_b32 s47, s47, 1
    s_add_u32 s47, s47, s62
    s_lshl_b32 s48, s6, 3
    s_add_u32 s47, s47, s48
    s_mul_i32 s61, s47, 147456
    s_mul_i32 s48, s5, 288
    s_add_u32 s61, s61, s48
    s_lshl_b32 s48, s4, 5
    s_add_u32 s48, s48, s47
    s_mul_i32 s55, s48, 36864

L_es2_38:
    s_branch L_a_store
L_pteam:
    s_setprio 0

    v_lshrrev_b32 v72, 4, v216
    v_and_b32 v73, 15, v216
    v_xor_b32 v74, v73, v72
    v_lshlrev_b32 v74, 4, v74
    v_lshl_add_u32 v248, v72, 8, v74
    s_lshl_b32 s47, s46, 11
    v_add_u32 v248, s47, v248
    v_add_u32 v249, 8192, v248
    v_and_b32 v74, 1, v72
    v_lshlrev_b32 v74, 1, v74
    v_xor_b32 v74, v73, v74
    v_lshlrev_b32 v74, 4, v74
    v_lshl_add_u32 v250, v72, 10, v74
    s_lshr_b32 s47, s46, 1
    s_lshl_b32 s47, s47, 4
    s_and_b32 s48, s46, 1
    s_lshl_b32 s48, s48, 1
    s_add_u32 s47, s47, s48
    s_lshl_b32 s47, s47, 8
    v_add_u32 v250, s47, v250
    s_mul_i32 s96, s46, 2176
    s_lshr_b32 s47, s46, 1
    s_lshl_b32 s47, s47, 2
    s_add_u32 s47, s47, s48
    s_mul_i32 s97, s47, 1088
    s_add_u32 s97, s97, 8704

    s_mov_b32 s66, 24576
    s_barrier

    s_lshl_b32 s47, s46, 4
    s_lshl_b64 s[58:59], 0xffff, s47
    s_lshl_b32 s63, s46, 10
    s_add_u32 s64, s63, 9216

L_pmid0:
    s_barrier
    s_add_u32 m0, s96, 52224
    s_nop 0
    buffer_load_dwordx4 v249, s[16:19], s66 offen nt lds
    s_add_u32 m0, s96, 52288
    s_nop 0
    buffer_load_dwordx4 v249, s[16:19], s66 offen offset:1024 nt lds
    s_add_u32 m0, s97, 52224
    s_nop 0
    buffer_load_dwordx4 v250, s[20:23], s66 offen nt lds
    s_add_u32 m0, s97, 53056
    s_nop 0
    buffer_load_dwordx4 v250, s[20:23], s66 offen offset:256 nt lds
    s_add_u32 s66, s66, 8192
    s_waitcnt lgkmcnt(0)
    s_barrier
    s_mov_b32 s70, 1040356334
    s_mov_b32 s71, 1040356334

    v_and_b32 v72, 15, v216
    v_lshrrev_b32 v73, 5, v216
    s_lshl_b32 s47, s46, 2
    v_add_u32 v73, s47, v73
    v_xor_b32 v73, v73, v72
    v_lshlrev_b32 v72, 8, v72
    v_lshl_add_u32 v72, v73, 4, v72
    v_bfe_u32 v73, v216, 4, 1
    v_lshl_add_u32 v72, v73, 3, v72
    v_add_u32 v226, 124928, v72
    v_xor_b32 v72, 32, v72
    v_add_u32 v227, 124928, v72

    v_pk_mul_f32 v[0:1], v[0:1], s[70:71]
    v_pk_mul_f32 v[2:3], v[2:3], s[70:71]
    v_cvt_pk_bf16_f32 v180, v0, v1
    v_cvt_pk_bf16_f32 v181, v2, v3
    ds_write_b64 v226, v[180:181] offset:0
    v_pk_mul_f32 v[4:5], v[4:5], s[70:71]
    v_pk_mul_f32 v[6:7], v[6:7], s[70:71]
    v_cvt_pk_bf16_f32 v182, v4, v5
    v_cvt_pk_bf16_f32 v183, v6, v7
    ds_write_b64 v226, v[182:183] offset:4096
    v_pk_mul_f32 v[8:9], v[8:9], s[70:71]
    v_pk_mul_f32 v[10:11], v[10:11], s[70:71]
    v_cvt_pk_bf16_f32 v184, v8, v9
    v_cvt_pk_bf16_f32 v185, v10, v11
    ds_write_b64 v226, v[184:185] offset:8192
    v_pk_mul_f32 v[12:13], v[12:13], s[70:71]
    v_pk_mul_f32 v[14:15], v[14:15], s[70:71]
    v_cvt_pk_bf16_f32 v186, v12, v13
    v_cvt_pk_bf16_f32 v187, v14, v15
    ds_write_b64 v226, v[186:187] offset:12288
    v_pk_mul_f32 v[16:17], v[16:17], s[70:71]
    v_pk_mul_f32 v[18:19], v[18:19], s[70:71]
    v_cvt_pk_bf16_f32 v188, v16, v17
    v_cvt_pk_bf16_f32 v189, v18, v19
    ds_write_b64 v226, v[188:189] offset:16384
    v_pk_mul_f32 v[20:21], v[20:21], s[70:71]
    v_pk_mul_f32 v[22:23], v[22:23], s[70:71]
    v_cvt_pk_bf16_f32 v190, v20, v21
    v_cvt_pk_bf16_f32 v191, v22, v23
    ds_write_b64 v226, v[190:191] offset:20480
    v_pk_mul_f32 v[24:25], v[24:25], s[70:71]
    v_pk_mul_f32 v[26:27], v[26:27], s[70:71]
    v_cvt_pk_bf16_f32 v192, v24, v25
    v_cvt_pk_bf16_f32 v193, v26, v27
    ds_write_b64 v226, v[192:193] offset:24576
    v_pk_mul_f32 v[28:29], v[28:29], s[70:71]
    v_pk_mul_f32 v[30:31], v[30:31], s[70:71]
    v_cvt_pk_bf16_f32 v194, v28, v29
    v_cvt_pk_bf16_f32 v195, v30, v31
    ds_write_b64 v226, v[194:195] offset:28672
    v_pk_mul_f32 v[32:33], v[32:33], s[70:71]
    v_pk_mul_f32 v[34:35], v[34:35], s[70:71]
    v_cvt_pk_bf16_f32 v196, v32, v33
    v_cvt_pk_bf16_f32 v197, v34, v35
    ds_write_b64 v226, v[196:197] offset:32768
    v_pk_mul_f32 v[36:37], v[36:37], s[70:71]
    v_pk_mul_f32 v[38:39], v[38:39], s[70:71]
    v_cvt_pk_bf16_f32 v198, v36, v37
    v_cvt_pk_bf16_f32 v199, v38, v39
    ds_write_b64 v227, v[198:199] offset:0
    v_pk_mul_f32 v[40:41], v[40:41], s[70:71]
    v_pk_mul_f32 v[42:43], v[42:43], s[70:71]
    v_cvt_pk_bf16_f32 v200, v40, v41
    v_cvt_pk_bf16_f32 v201, v42, v43
    ds_write_b64 v227, v[200:201] offset:4096
    v_pk_mul_f32 v[44:45], v[44:45], s[70:71]
    v_pk_mul_f32 v[46:47], v[46:47], s[70:71]
    v_cvt_pk_bf16_f32 v202, v44, v45
    v_cvt_pk_bf16_f32 v203, v46, v47
    ds_write_b64 v227, v[202:203] offset:8192
    v_pk_mul_f32 v[48:49], v[48:49], s[70:71]
    v_pk_mul_f32 v[50:51], v[50:51], s[70:71]
    v_cvt_pk_bf16_f32 v204, v48, v49
    v_cvt_pk_bf16_f32 v205, v50, v51
    ds_write_b64 v227, v[204:205] offset:12288
    v_pk_mul_f32 v[52:53], v[52:53], s[70:71]
    v_pk_mul_f32 v[54:55], v[54:55], s[70:71]
    v_cvt_pk_bf16_f32 v206, v52, v53
    v_cvt_pk_bf16_f32 v207, v54, v55
    ds_write_b64 v227, v[206:207] offset:16384
    v_pk_mul_f32 v[56:57], v[56:57], s[70:71]
    v_pk_mul_f32 v[58:59], v[58:59], s[70:71]
    v_cvt_pk_bf16_f32 v208, v56, v57
    v_cvt_pk_bf16_f32 v209, v58, v59
    ds_write_b64 v227, v[208:209] offset:20480
    v_pk_mul_f32 v[60:61], v[60:61], s[70:71]
    v_pk_mul_f32 v[62:63], v[62:63], s[70:71]
    v_cvt_pk_bf16_f32 v210, v60, v61
    v_cvt_pk_bf16_f32 v211, v62, v63
    ds_write_b64 v227, v[210:211] offset:24576
    v_pk_mul_f32 v[64:65], v[64:65], s[70:71]
    v_pk_mul_f32 v[66:67], v[66:67], s[70:71]
    v_cvt_pk_bf16_f32 v212, v64, v65
    v_cvt_pk_bf16_f32 v213, v66, v67
    ds_write_b64 v227, v[212:213] offset:28672
    v_pk_mul_f32 v[68:69], v[68:69], s[70:71]
    v_pk_mul_f32 v[70:71], v[70:71], s[70:71]
    v_cvt_pk_bf16_f32 v214, v68, v69
    v_cvt_pk_bf16_f32 v215, v70, v71
    ds_write_b64 v227, v[214:215] offset:32768
    s_add_u32 m0, s96, 0
    s_nop 0
    buffer_load_dwordx4 v249, s[16:19], s66 offen nt lds
    s_add_u32 m0, s96, 64
    s_nop 0
    buffer_load_dwordx4 v249, s[16:19], s66 offen offset:1024 nt lds
    s_add_u32 m0, s97, 0
    s_nop 0
    buffer_load_dwordx4 v250, s[20:23], s66 offen nt lds
    s_add_u32 m0, s97, 832
    s_nop 0
    buffer_load_dwordx4 v250, s[20:23], s66 offen offset:256 nt lds
    s_add_u32 s66, s66, 8192
    s_waitcnt lgkmcnt(0)
    s_barrier
    s_add_u32 m0, s96, 17408
    s_nop 0
    buffer_load_dwordx4 v249, s[16:19], s66 offen nt lds
    s_add_u32 m0, s96, 17472
    s_nop 0
    buffer_load_dwordx4 v249, s[16:19], s66 offen offset:1024 nt lds
    s_add_u32 m0, s97, 17408
    s_nop 0
    buffer_load_dwordx4 v250, s[20:23], s66 offen nt lds
    s_add_u32 m0, s97, 18240
    s_nop 0
    buffer_load_dwordx4 v250, s[20:23], s66 offen offset:256 nt lds
    s_add_u32 s66, s66, 8192
    s_waitcnt vmcnt(8) lgkmcnt(0)
    s_barrier
    s_mov_b32 s57, 100000
L_p_nonce:

    v_mov_b32 v234, 0
    global_load_dwordx2 v[232:233], v234, s[42:43] sc1
    s_waitcnt vmcnt(0)
    v_readfirstlane_b32 s44, v232
    v_readfirstlane_b32 s45, v233
    s_sub_u32 s57, s57, 1
    s_cmp_eq_u32 s57, 0
    s_cbranch_scc1 L_p_nonce_d
    s_cmp_eq_u32 s44, 0
    s_cbranch_scc0 L_p_nonce_d
    s_sleep 2
    s_branch L_p_nonce

L_p_nonce_d:
    s_add_u32 m0, s96, 34816
    s_nop 0
    buffer_load_dwordx4 v249, s[16:19], s66 offen nt lds
    s_add_u32 m0, s96, 34880
    s_nop 0
    buffer_load_dwordx4 v249, s[16:19], s66 offen offset:1024 nt lds
    s_add_u32 m0, s97, 34816
    s_nop 0
    buffer_load_dwordx4 v250, s[20:23], s66 offen nt lds
    s_add_u32 m0, s97, 35648
    s_nop 0
    buffer_load_dwordx4 v250, s[20:23], s66 offen offset:256 nt lds
    s_add_u32 s66, s66, 8192
    s_waitcnt vmcnt(8) lgkmcnt(0)
    s_barrier
    s_add_u32 m0, s96, 52224
    s_nop 0
    buffer_load_dwordx4 v249, s[16:19], s66 offen nt lds
    s_add_u32 m0, s96, 52288
    s_nop 0
    buffer_load_dwordx4 v249, s[16:19], s66 offen offset:1024 nt lds
    s_add_u32 m0, s97, 52224
    s_nop 0
    buffer_load_dwordx4 v250, s[20:23], s66 offen nt lds
    s_add_u32 m0, s97, 53056
    s_nop 0
    buffer_load_dwordx4 v250, s[20:23], s66 offen offset:256 nt lds
    s_add_u32 s66, s66, 8192
    s_waitcnt vmcnt(8) lgkmcnt(0)
    s_barrier
    s_mov_b32 s62, 0

    v_lshlrev_b32 v232, 4, v216
    s_lshl_b32 s47, s46, 12
    v_add_u32 v224, s47, v232
    v_add_u32 v225, 16384, v224
    v_add_u32 v226, 32768, v232
    v_lshrrev_b32 v232, 4, v216
    v_and_b32 v233, 15, v216
    v_lshlrev_b32 v234, 2, v232
    v_xor_b32 v233, v233, v234
    s_and_b32 s47, s46, 1
    s_lshl_b32 s47, s47, 1
    v_xor_b32 v233, s47, v233
    s_lshl_b32 s47, s46, 2
    v_add_u32 v232, s47, v232
    v_mul_u32_u24 v232, 1152, v232
    v_lshl_add_u32 v227, v233, 4, v232
    v_add_u32 v228, 18432, v227
    v_lshrrev_b32 v232, 1, v216
    v_mul_u32_u24 v232, 1152, v232
    v_and_b32 v233, 1, v216
    v_lshl_add_u32 v232, v233, 4, v232
    v_add_u32 v229, 256, v232
    s_mov_b32 s52, 69632
    s_mov_b32 s60, 0
    s_mov_b32 s61, 0

    s_lshr_b32 s47, s61, 2
    s_add_u32 s47, s47, s5
    s_and_b32 s47, s47, 3
    s_lshl_b32 s47, s47, 1
    s_add_u32 s47, s47, s62
    s_lshl_b32 s48, s6, 3
    s_add_u32 s47, s47, s48
    s_mul_i32 s54, s47, 147456
    s_mul_i32 s53, s5, 288
    s_add_u32 s54, s54, s53
    s_lshl_b32 s53, s4, 5
    s_add_u32 s53, s53, s47
    s_mul_i32 s53, s53, 36864

    s_add_u32 s47, s5, 0
    s_and_b32 s47, s47, 3
    s_lshl_b32 s47, s47, 1
    s_add_u32 s47, s47, s62
    s_lshl_b32 s48, s6, 3
    s_add_u32 s47, s47, s48
    s_mul_i32 s92, s47, 147456
    s_mul_i32 s48, s5, 288
    s_add_u32 s92, s92, s48
    s_lshl_b32 s48, s4, 5
    s_add_u32 s48, s48, s47
    s_mul_i32 s88, s48, 36864

    s_add_u32 s47, s5, 1
    s_and_b32 s47, s47, 3
    s_lshl_b32 s47, s47, 1
    s_add_u32 s47, s47, s62
    s_lshl_b32 s48, s6, 3
    s_add_u32 s47, s47, s48
    s_mul_i32 s93, s47, 147456
    s_mul_i32 s48, s5, 288
    s_add_u32 s93, s93, s48
    s_lshl_b32 s48, s4, 5
    s_add_u32 s48, s48, s47
    s_mul_i32 s89, s48, 36864

    s_add_u32 s47, s5, 2
    s_and_b32 s47, s47, 3
    s_lshl_b32 s47, s47, 1
    s_add_u32 s47, s47, s62
    s_lshl_b32 s48, s6, 3
    s_add_u32 s47, s47, s48
    s_mul_i32 s94, s47, 147456
    s_mul_i32 s48, s5, 288
    s_add_u32 s94, s94, s48
    s_lshl_b32 s48, s4, 5
    s_add_u32 s48, s48, s47
    s_mul_i32 s90, s48, 36864

    s_add_u32 s47, s5, 3
    s_and_b32 s47, s47, 3
    s_lshl_b32 s47, s47, 1
    s_add_u32 s47, s47, s62
    s_lshl_b32 s48, s6, 3
    s_add_u32 s47, s47, s48
    s_mul_i32 s95, s47, 147456
    s_mul_i32 s48, s5, 288
    s_add_u32 s95, s95, s48
    s_lshl_b32 s48, s4, 5
    s_add_u32 s48, s48, s47
    s_mul_i32 s91, s48, 36864

    v_lshlrev_b32 v232, 4, v216
    v_add_u32 v232, 69632, v232
    s_cmp_eq_u32 s46, 3
    s_cselect_b32 s47, 0, s46

    s_mul_i32 s48, s47, 3072
    v_add_u32 v217, s48, v232
    s_add_u32 s47, s47, 1
    s_cmp_eq_u32 s47, 3
    s_cselect_b32 s47, 0, s47
    s_mul_i32 s48, s47, 3072
    v_add_u32 v218, s48, v232
    s_add_u32 s47, s47, 1
    s_cmp_eq_u32 s47, 3
    s_cselect_b32 s47, 0, s47
    s_mul_i32 s48, s47, 3072
    v_add_u32 v219, s48, v232

    v_lshrrev_b32 v232, 4, v216
    v_bfe_u32 v233, v216, 2, 2
    v_lshl_add_u32 v234, v232, 2, v233
    v_lshlrev_b32 v235, 5, v234
    v_lshlrev_b32 v234, 8, v234
    v_xor_b32 v233, s46, v233
    v_lshl_add_u32 v234, v233, 6, v234
    v_and_b32 v232, 1, v232
    v_lshl_add_u32 v234, v232, 5, v234
    v_bfe_u32 v233, v216, 1, 1
    v_lshl_add_u32 v234, v233, 4, v234
    v_and_b32 v233, 1, v216
    v_lshl_add_u32 v234, v233, 3, v234
    v_add_u32 v220, 78848, v234
    v_xor_b32 v234, 32, v234
    v_add_u32 v221, 78848, v234

    v_and_b32 v233, 3, v216
    v_lshl_add_u32 v235, v233, 3, v235
    v_add_u32 v223, 87040, v235

    s_mov_b32 s55, 0
    s_add_u32 m0, s96, 0
    s_nop 0
    buffer_load_dwordx4 v249, s[16:19], s66 offen nt lds
    s_add_u32 m0, s96, 64
    s_nop 0
    buffer_load_dwordx4 v249, s[16:19], s66 offen offset:1024 nt lds
    s_add_u32 m0, s97, 0
    s_nop 0
    buffer_load_dwordx4 v250, s[20:23], s66 offen nt lds
    s_add_u32 m0, s97, 832
    s_nop 0
    buffer_load_dwordx4 v250, s[20:23], s66 offen offset:256 nt lds
    s_add_u32 s66, s66, 8192
    s_waitcnt vmcnt(8) lgkmcnt(0)
    s_barrier
    s_add_u32 m0, s96, 17408
    s_nop 0
    buffer_load_dwordx4 v249, s[16:19], s66 offen nt lds
    s_add_u32 m0, s96, 17472
    s_nop 0
    buffer_load_dwordx4 v249, s[16:19], s66 offen offset:1024 nt lds
    s_add_u32 m0, s97, 17408
    s_nop 0
    buffer_load_dwordx4 v250, s[20:23], s66 offen nt lds
    s_add_u32 m0, s97, 18240
    s_nop 0
    buffer_load_dwordx4 v250, s[20:23], s66 offen offset:256 nt lds
    s_add_u32 s66, s66, 8192
    s_waitcnt vmcnt(8) lgkmcnt(0)
    s_barrier
    s_add_u32 m0, s96, 34816
    s_nop 0
    buffer_load_dwordx4 v249, s[16:19], s66 offen nt lds
    s_add_u32 m0, s96, 34880
    s_nop 0
    buffer_load_dwordx4 v249, s[16:19], s66 offen offset:1024 nt lds
    s_add_u32 m0, s97, 34816
    s_nop 0
    buffer_load_dwordx4 v250, s[20:23], s66 offen nt lds
    s_add_u32 m0, s97, 35648
    s_nop 0
    buffer_load_dwordx4 v250, s[20:23], s66 offen offset:256 nt lds
    s_add_u32 s66, s66, 8192
    s_waitcnt vmcnt(8) lgkmcnt(0)
    s_barrier
    s_add_u32 m0, s96, 52224
    s_nop 0
    buffer_load_dwordx4 v249, s[16:19], s66 offen nt lds
    s_add_u32 m0, s96, 52288
    s_nop 0
    buffer_load_dwordx4 v249, s[16:19], s66 offen offset:1024 nt lds
    s_add_u32 m0, s97, 52224
    s_nop 0
    buffer_load_dwordx4 v250, s[20:23], s66 offen nt lds
    s_add_u32 m0, s97, 53056
    s_nop 0
    buffer_load_dwordx4 v250, s[20:23], s66 offen offset:256 nt lds
    s_add_u32 s66, s66, 8192
    s_waitcnt vmcnt(8) lgkmcnt(0)
    s_barrier
    s_add_u32 m0, s96, 0
    s_nop 0
    buffer_load_dwordx4 v249, s[16:19], s66 offen nt lds
    s_add_u32 m0, s96, 64
    s_nop 0
    buffer_load_dwordx4 v249, s[16:19], s66 offen offset:1024 nt lds
    s_add_u32 m0, s97, 0
    s_nop 0
    buffer_load_dwordx4 v250, s[20:23], s66 offen nt lds
    s_add_u32 m0, s97, 832
    s_nop 0
    buffer_load_dwordx4 v250, s[20:23], s66 offen offset:256 nt lds
    s_add_u32 s66, s66, 8192
    s_waitcnt vmcnt(8) lgkmcnt(0)
    s_barrier
    s_add_u32 m0, s96, 17408
    s_nop 0
    buffer_load_dwordx4 v249, s[16:19], s66 offen nt lds
    s_add_u32 m0, s96, 17472
    s_nop 0
    buffer_load_dwordx4 v249, s[16:19], s66 offen offset:1024 nt lds
    s_add_u32 m0, s97, 17408
    s_nop 0
    buffer_load_dwordx4 v250, s[20:23], s66 offen nt lds
    s_add_u32 m0, s97, 18240
    s_nop 0
    buffer_load_dwordx4 v250, s[20:23], s66 offen offset:256 nt lds
    s_add_u32 s66, s66, 8192
    s_waitcnt vmcnt(8) lgkmcnt(0)
    s_barrier
    s_add_u32 m0, s96, 34816
    s_nop 0
    buffer_load_dwordx4 v249, s[16:19], s66 offen nt lds
    s_add_u32 m0, s96, 34880
    s_nop 0
    buffer_load_dwordx4 v249, s[16:19], s66 offen offset:1024 nt lds
    s_add_u32 m0, s97, 34816
    s_nop 0
    buffer_load_dwordx4 v250, s[20:23], s66 offen nt lds
    s_add_u32 m0, s97, 35648
    s_nop 0
    buffer_load_dwordx4 v250, s[20:23], s66 offen offset:256 nt lds
    s_add_u32 s66, s66, 8192
    s_waitcnt vmcnt(8) lgkmcnt(0)
    s_barrier
    s_add_u32 m0, s96, 52224
    s_nop 0
    buffer_load_dwordx4 v249, s[16:19], s66 offen nt lds
    s_add_u32 m0, s96, 52288
    s_nop 0
    buffer_load_dwordx4 v249, s[16:19], s66 offen offset:1024 nt lds
    s_add_u32 m0, s97, 52224
    s_nop 0
    buffer_load_dwordx4 v250, s[20:23], s66 offen nt lds
    s_add_u32 m0, s97, 53056
    s_nop 0
    buffer_load_dwordx4 v250, s[20:23], s66 offen offset:256 nt lds
    s_add_u32 s66, s66, 8192
    s_waitcnt vmcnt(8) lgkmcnt(0)
    s_barrier
    s_add_u32 m0, s96, 0
    s_nop 0
    buffer_load_dwordx4 v249, s[16:19], s66 offen nt lds
    s_add_u32 m0, s96, 64
    s_nop 0
    buffer_load_dwordx4 v249, s[16:19], s66 offen offset:1024 nt lds
    s_add_u32 m0, s97, 0
    s_nop 0
    buffer_load_dwordx4 v250, s[20:23], s66 offen nt lds
    s_add_u32 m0, s97, 832
    s_nop 0
    buffer_load_dwordx4 v250, s[20:23], s66 offen offset:256 nt lds
    s_add_u32 s66, s66, 8192
    s_waitcnt vmcnt(8) lgkmcnt(0)
    s_barrier
    s_add_u32 m0, s96, 17408
    s_nop 0
    buffer_load_dwordx4 v249, s[16:19], s66 offen nt lds
    s_add_u32 m0, s96, 17472
    s_nop 0
    buffer_load_dwordx4 v249, s[16:19], s66 offen offset:1024 nt lds
    s_add_u32 m0, s97, 17408
    s_nop 0
    buffer_load_dwordx4 v250, s[20:23], s66 offen nt lds
    s_add_u32 m0, s97, 18240
    s_nop 0
    buffer_load_dwordx4 v250, s[20:23], s66 offen offset:256 nt lds
    s_add_u32 s66, s66, 8192
    s_waitcnt vmcnt(8) lgkmcnt(0)
    s_barrier
    s_add_u32 m0, s96, 34816
    s_nop 0
    buffer_load_dwordx4 v249, s[16:19], s66 offen nt lds
    s_add_u32 m0, s96, 34880
    s_nop 0
    buffer_load_dwordx4 v249, s[16:19], s66 offen offset:1024 nt lds
    s_add_u32 m0, s97, 34816
    s_nop 0
    buffer_load_dwordx4 v250, s[20:23], s66 offen nt lds
    s_add_u32 m0, s97, 35648
    s_nop 0
    buffer_load_dwordx4 v250, s[20:23], s66 offen offset:256 nt lds
    s_add_u32 s66, s66, 8192
    s_waitcnt vmcnt(8) lgkmcnt(0)
L_pmid0e:
    s_barrier

    v_mov_b32 v240, 70656
    ds_read_b128 v[232:235], v240
    v_and_b32 v240, 15, v216
    v_lshlrev_b32 v240, 2, v240
    v_add_u32 v240, 70656, v240
    ds_read_b32 v236, v240 offset:64
    ds_read_b32 v237, v240 offset:128
    ds_read_b32 v238, v240 offset:192
    ds_read_b32 v239, v240 offset:256
    s_waitcnt lgkmcnt(0)
    v_or_b32 v232, v232, v233
    v_or_b32 v234, v234, v235
    v_add_f32 v236, v236, v237
    v_add_f32 v238, v238, v239
    v_or_b32 v232, v232, v234
    v_add_f32 v236, v236, v238
    s_mov_b32 s48, 796917760
    s_mov_b32 s49, 1199570944
    v_cmp_nle_f32 vcc, s48, v236
    v_cmp_nge_f32 s[68:69], s49, v236
    v_cmp_ne_u32 s[70:71], 0, v232

    s_nop 0

    s_nop 0
    s_or_b64 vcc, vcc, s[68:69]
    s_or_b64 vcc, vcc, s[70:71]
    s_cmp_lg_u64 vcc, 0
    s_cbranch_scc1 L_p_safe0

L_p_back0:
L_pmid1:
    s_barrier
    s_add_u32 m0, s96, 52224
    s_nop 0
    buffer_load_dwordx4 v249, s[16:19], s66 offen nt lds
    s_add_u32 m0, s96, 52288
    s_nop 0
    buffer_load_dwordx4 v249, s[16:19], s66 offen offset:1024 nt lds
    s_add_u32 m0, s97, 52224
    s_nop 0
    buffer_load_dwordx4 v250, s[20:23], s66 offen nt lds
    s_add_u32 m0, s97, 53056
    s_nop 0
    buffer_load_dwordx4 v250, s[20:23], s66 offen offset:256 nt lds
    s_add_u32 s66, s66, 8192
    s_waitcnt vmcnt(8) lgkmcnt(0)
    s_barrier
    v_mov_b32 v232, s44
    v_mov_b32 v233, s45
    v_mov_b32 v234, 155648
    ds_write_b64 v234, v[232:233]
    s_add_u32 m0, s96, 0
    s_nop 0
    buffer_load_dwordx4 v249, s[16:19], s66 offen nt lds
    s_add_u32 m0, s96, 64
    s_nop 0
    buffer_load_dwordx4 v249, s[16:19], s66 offen offset:1024 nt lds
    s_add_u32 m0, s97, 0
    s_nop 0
    buffer_load_dwordx4 v250, s[20:23], s66 offen nt lds
    s_add_u32 m0, s97, 832
    s_nop 0
    buffer_load_dwordx4 v250, s[20:23], s66 offen offset:256 nt lds
    s_add_u32 s66, s66, 8192
    s_waitcnt vmcnt(8) lgkmcnt(0)
    s_barrier

    s_cmp_lg_u32 s46, 0
    s_cbranch_scc1 L_fw_39
    s_lshl_b32 s47, s2, 9
    s_add_u32 s47, s47, 50331648
    v_mov_b32 v232, s44
    v_mov_b32 v233, s45
    v_mov_b32 v234, s47
    s_mov_b64 exec, 1
    global_store_dwordx2 v234, v[232:233], s[40:41] sc1
    s_mov_b64 exec, -1

L_fw_39:
    s_add_u32 m0, s96, 17408
    s_nop 0
    buffer_load_dwordx4 v249, s[16:19], s66 offen nt lds
    s_add_u32 m0, s96, 17472
    s_nop 0
    buffer_load_dwordx4 v249, s[16:19], s66 offen offset:1024 nt lds
    s_add_u32 m0, s97, 17408
    s_nop 0
    buffer_load_dwordx4 v250, s[20:23], s66 offen nt lds
    s_add_u32 m0, s97, 18240
    s_nop 0
    buffer_load_dwordx4 v250, s[20:23], s66 offen offset:256 nt lds
    s_add_u32 s66, s66, 8192
    s_waitcnt vmcnt(8) lgkmcnt(0)
    s_barrier
    s_add_u32 m0, s96, 34816
    s_nop 0
    buffer_load_dwordx4 v249, s[16:19], s66 offen nt lds
    s_add_u32 m0, s96, 34880
    s_nop 0
    buffer_load_dwordx4 v249, s[16:19], s66 offen offset:1024 nt lds
    s_add_u32 m0, s97, 34816
    s_nop 0
    buffer_load_dwordx4 v250, s[20:23], s66 offen nt lds
    s_add_u32 m0, s97, 35648
    s_nop 0
    buffer_load_dwordx4 v250, s[20:23], s66 offen offset:256 nt lds
    s_add_u32 s66, s66, 8192
    s_waitcnt vmcnt(8) lgkmcnt(0)
    s_barrier
    s_add_u32 m0, s96, 52224
    s_nop 0
    buffer_load_dwordx4 v249, s[16:19], s66 offen nt lds
    s_add_u32 m0, s96, 52288
    s_nop 0
    buffer_load_dwordx4 v249, s[16:19], s66 offen offset:1024 nt lds
    s_add_u32 m0, s97, 52224
    s_nop 0
    buffer_load_dwordx4 v250, s[20:23], s66 offen nt lds
    s_add_u32 m0, s97, 53056
    s_nop 0
    buffer_load_dwordx4 v250, s[20:23], s66 offen offset:256 nt lds
    s_add_u32 s66, s66, 8192
    s_waitcnt vmcnt(8) lgkmcnt(0)
    s_barrier
    s_add_u32 m0, s96, 0
    s_nop 0
    buffer_load_dwordx4 v249, s[16:19], s66 offen nt lds
    s_add_u32 m0, s96, 64
    s_nop 0
    buffer_load_dwordx4 v249, s[16:19], s66 offen offset:1024 nt lds
    s_add_u32 m0, s97, 0
    s_nop 0
    buffer_load_dwordx4 v250, s[20:23], s66 offen nt lds
    s_add_u32 m0, s97, 832
    s_nop 0
    buffer_load_dwordx4 v250, s[20:23], s66 offen offset:256 nt lds
    s_add_u32 s66, s66, 8192
    s_waitcnt vmcnt(8) lgkmcnt(0)
    s_barrier
    s_add_u32 m0, s96, 17408
    s_nop 0
    buffer_load_dwordx4 v249, s[16:19], s66 offen nt lds
    s_add_u32 m0, s96, 17472
    s_nop 0
    buffer_load_dwordx4 v249, s[16:19], s66 offen offset:1024 nt lds
    s_add_u32 m0, s97, 17408
    s_nop 0
    buffer_load_dwordx4 v250, s[20:23], s66 offen nt lds
    s_add_u32 m0, s97, 18240
    s_nop 0
    buffer_load_dwordx4 v250, s[20:23], s66 offen offset:256 nt lds
    s_add_u32 s66, s66, 8192
    s_waitcnt vmcnt(8) lgkmcnt(0)
    s_barrier
    s_add_u32 m0, s96, 34816
    s_nop 0
    buffer_load_dwordx4 v249, s[16:19], s66 offen nt lds
    s_add_u32 m0, s96, 34880
    s_nop 0
    buffer_load_dwordx4 v249, s[16:19], s66 offen offset:1024 nt lds
    s_add_u32 m0, s97, 34816
    s_nop 0
    buffer_load_dwordx4 v250, s[20:23], s66 offen nt lds
    s_add_u32 m0, s97, 35648
    s_nop 0
    buffer_load_dwordx4 v250, s[20:23], s66 offen offset:256 nt lds
    s_add_u32 s66, s66, 8192
    s_waitcnt vmcnt(8) lgkmcnt(0)
    s_barrier
    s_add_u32 m0, s96, 52224
    s_nop 0
    buffer_load_dwordx4 v249, s[16:19], s66 offen nt lds
    s_add_u32 m0, s96, 52288
    s_nop 0
    buffer_load_dwordx4 v249, s[16:19], s66 offen offset:1024 nt lds
    s_add_u32 m0, s97, 52224
    s_nop 0
    buffer_load_dwordx4 v250, s[20:23], s66 offen nt lds
    s_add_u32 m0, s97, 53056
    s_nop 0
    buffer_load_dwordx4 v250, s[20:23], s66 offen offset:256 nt lds
    s_add_u32 s66, s66, 8192

    s_lshr_b32 s47, s2, 3
    s_mul_i32 s47, s47, 144
    s_mul_i32 s48, s46, 36
    s_add_u32 s47, s47, s48
    v_add_u32 v232, s47, v216
    v_mul_u32_u24 v233, 3641, v232
    v_lshrrev_b32 v233, 22, v233
    v_mul_u32_u24 v234, 1152, v233
    v_sub_u32 v232, v232, v234
    v_lshlrev_b32 v232, 7, v232
    v_lshlrev_b32 v233, 1, v233
    v_add_u32 v233, 0, v233
    s_lshl_b32 s47, s6, 3
    v_add_u32 v233, s47, v233
    s_mov_b32 s48, 147456
    v_mul_lo_u32 v233, v233, s48
    v_add_u32 v232, v232, v233
    s_mov_b32 exec_hi, 0xf
    buffer_load_dword v255, v232, s[24:27], 0 offen
    s_mov_b64 exec, -1

    s_waitcnt vmcnt(9) lgkmcnt(0)
    s_barrier

    s_andn2_b32 s47, s2, 24
    v_and_b32 v254, 3, v216
    v_lshlrev_b32 v254, 3, v254
    v_add_u32 v254, s47, v254
    v_lshlrev_b32 v254, 9, v254
    v_add_u32 v254, 50331648, v254
    global_load_dwordx2 v[252:253], v254, s[40:41] sc1

    s_add_u32 m0, s96, 0
    s_nop 0
    buffer_load_dwordx4 v249, s[16:19], s66 offen nt lds
    s_add_u32 m0, s96, 64
    s_nop 0
    buffer_load_dwordx4 v249, s[16:19], s66 offen offset:1024 nt lds
    s_add_u32 m0, s97, 0
    s_nop 0
    buffer_load_dwordx4 v250, s[20:23], s66 offen nt lds
    s_add_u32 m0, s97, 832
    s_nop 0
    buffer_load_dwordx4 v250, s[20:23], s66 offen offset:256 nt lds
    s_add_u32 s66, s66, 8192
    s_waitcnt vmcnt(10) lgkmcnt(0)
    s_barrier
    s_add_u32 m0, s96, 17408
    s_nop 0
    buffer_load_dwordx4 v249, s[16:19], s66 offen nt lds
    s_add_u32 m0, s96, 17472
    s_nop 0
    buffer_load_dwordx4 v249, s[16:19], s66 offen offset:1024 nt lds
    s_add_u32 m0, s97, 17408
    s_nop 0
    buffer_load_dwordx4 v250, s[20:23], s66 offen nt lds
    s_add_u32 m0, s97, 18240
    s_nop 0
    buffer_load_dwordx4 v250, s[20:23], s66 offen offset:256 nt lds
    s_add_u32 s66, s66, 8192
    s_waitcnt vmcnt(8)

    v_cmp_ne_u32 vcc, s44, v252
    v_cmp_ne_u32 s[68:69], s45, v253
    s_nop 1
    s_or_b64 vcc, vcc, s[68:69]
    s_cmp_lg_u64 vcc, 0
    s_cbranch_scc0 L_pc_40

    s_andn2_b32 s47, s2, 24
    v_and_b32 v234, 3, v216
    v_lshlrev_b32 v234, 3, v234
    v_add_u32 v234, s47, v234
    v_lshlrev_b32 v234, 9, v234
    v_add_u32 v234, 50331648, v234
    s_mov_b32 s57, 100000

L_poll_41:

    global_load_dwordx2 v[232:233], v234, s[40:41] sc1
    s_waitcnt vmcnt(0)
    v_cmp_ne_u32 vcc, s44, v232
    v_cmp_ne_u32 s[68:69], s45, v233
    s_sub_u32 s57, s57, 1
    s_cmp_eq_u32 s57, 0
    s_cbranch_scc1 L_polld_42
    s_or_b64 vcc, vcc, s[68:69]
    s_cmp_lg_u64 vcc, 0
    s_cbranch_scc0 L_polld_42
    s_sleep 1
    s_branch L_poll_41

L_polld_42:
L_pc_40:
    s_waitcnt vmcnt(10) lgkmcnt(0)
    s_barrier
    s_add_u32 m0, s96, 34816
    s_nop 0
    buffer_load_dwordx4 v249, s[16:19], s66 offen nt lds
    s_add_u32 m0, s96, 34880
    s_nop 0
    buffer_load_dwordx4 v249, s[16:19], s66 offen offset:1024 nt lds
    s_add_u32 m0, s97, 34816
    s_nop 0
    buffer_load_dwordx4 v250, s[20:23], s66 offen nt lds
    s_add_u32 m0, s97, 35648
    s_nop 0
    buffer_load_dwordx4 v250, s[20:23], s66 offen offset:256 nt lds
    s_add_u32 s66, s66, 8192

    s_lshl_b32 s47, s4, 5
    s_add_u32 s47, s47, s7
    s_add_u32 s47, s47, 0
    s_mul_i32 s47, s47, 36864
    s_mul_i32 s48, s46, 9216
    s_add_u32 s47, s47, s48
    v_lshlrev_b32 v232, 7, v216
    buffer_load_dword v255, v232, s[28:31], s47 offen sc1
    s_add_u32 s47, s47, 8192
    s_mov_b64 exec, 0xff
    buffer_load_dword v255, v232, s[28:31], s47 offen sc1
    s_mov_b64 exec, -1

    s_waitcnt vmcnt(10) lgkmcnt(0)
    s_barrier
    s_add_u32 m0, s63, 69632
    s_add_u32 s50, s92, 0
    buffer_load_dwordx4 v224, s[28:31], s88 offen offset:0 sc1 lds
    s_add_u32 m0, s63, 73728
    s_nop 0
    buffer_load_dwordx4 v225, s[28:31], s88 offen offset:0 sc1 lds
    s_add_u32 m0, s64, 69632
    s_nop 0
    buffer_load_dwordx4 v227, s[24:27], s50 offen lds
    s_add_u32 m0, s64, 73728
    s_nop 0
    buffer_load_dwordx4 v228, s[24:27], s50 offen lds
    s_mov_b32 m0, 77824
    s_cmp_eq_u32 s46, 0
    s_cselect_b64 exec, -1, 0
    buffer_load_dwordx4 v226, s[28:31], s88 offen offset:0 sc1 lds
    s_mov_b64 exec, -1
    s_mov_b32 m0, 87040
    s_cmp_eq_u32 s46, 2
    s_cselect_b64 exec, -1, 0
    buffer_load_dwordx4 v229, s[24:27], s50 offen lds
    s_mov_b64 exec, -1
    s_add_u32 m0, s96, 52224
    s_nop 0
    buffer_load_dwordx4 v249, s[16:19], s66 offen nt lds
    s_add_u32 m0, s96, 52288
    s_nop 0
    buffer_load_dwordx4 v249, s[16:19], s66 offen offset:1024 nt lds
    s_add_u32 m0, s97, 52224
    s_nop 0
    buffer_load_dwordx4 v250, s[20:23], s66 offen nt lds
    s_add_u32 m0, s97, 53056
    s_nop 0
    buffer_load_dwordx4 v250, s[20:23], s66 offen offset:256 nt lds
    s_add_u32 s66, s66, 8192
    s_waitcnt vmcnt(14) lgkmcnt(0)
    s_barrier
    s_add_u32 m0, s63, 87040
    s_add_u32 s50, s92, 36864
    buffer_load_dwordx4 v224, s[28:31], s88 offen offset:1024 sc1 lds
    s_add_u32 m0, s63, 91136
    s_nop 0
    buffer_load_dwordx4 v225, s[28:31], s88 offen offset:1024 sc1 lds
    s_add_u32 m0, s64, 88064
    s_nop 0
    buffer_load_dwordx4 v227, s[24:27], s50 offen lds
    s_add_u32 m0, s64, 92160
    s_nop 0
    buffer_load_dwordx4 v228, s[24:27], s50 offen lds
    s_mov_b32 m0, 95232
    s_cmp_eq_u32 s46, 1
    s_cselect_b64 exec, -1, 0
    buffer_load_dwordx4 v226, s[28:31], s88 offen offset:1024 sc1 lds
    s_mov_b64 exec, -1
    s_mov_b32 m0, 105472
    s_cmp_eq_u32 s46, 3
    s_cselect_b64 exec, -1, 0
    buffer_load_dwordx4 v229, s[24:27], s50 offen lds
    s_mov_b64 exec, -1
    s_waitcnt vmcnt(14) lgkmcnt(0)
    s_barrier
    s_add_u32 m0, s63, 104448
    s_add_u32 s50, s92, 73728
    buffer_load_dwordx4 v224, s[28:31], s88 offen offset:2048 sc1 lds
    s_add_u32 m0, s63, 108544
    s_nop 0
    buffer_load_dwordx4 v225, s[28:31], s88 offen offset:2048 sc1 lds
    s_add_u32 m0, s64, 106496
    s_nop 0
    buffer_load_dwordx4 v227, s[24:27], s50 offen lds
    s_add_u32 m0, s64, 110592
    s_nop 0
    buffer_load_dwordx4 v228, s[24:27], s50 offen lds
    s_mov_b32 m0, 112640
    s_cmp_eq_u32 s46, 2
    s_cselect_b64 exec, -1, 0
    buffer_load_dwordx4 v226, s[28:31], s88 offen offset:2048 sc1 lds
    s_mov_b64 exec, -1
    s_mov_b32 m0, 123904
    s_cmp_eq_u32 s46, 0
    s_cselect_b64 exec, -1, 0
    buffer_load_dwordx4 v229, s[24:27], s50 offen lds
    s_mov_b64 exec, -1

    s_lshr_b32 s47, s2, 3
    s_mul_i32 s47, s47, 144
    s_mul_i32 s48, s46, 36
    s_add_u32 s47, s47, s48
    v_add_u32 v232, s47, v216
    v_mul_u32_u24 v233, 3641, v232
    v_lshrrev_b32 v233, 22, v233
    v_mul_u32_u24 v234, 1152, v233
    v_sub_u32 v232, v232, v234
    v_lshlrev_b32 v232, 7, v232
    v_lshlrev_b32 v233, 1, v233
    v_add_u32 v233, 1, v233
    s_lshl_b32 s47, s6, 3
    v_add_u32 v233, s47, v233
    s_mov_b32 s48, 147456
    v_mul_lo_u32 v233, v233, s48
    v_add_u32 v232, v232, v233
    s_mov_b32 exec_hi, 0xf
    buffer_load_dword v255, v232, s[24:27], 0 offen
    s_mov_b64 exec, -1

    s_waitcnt vmcnt(9) lgkmcnt(0)
    s_barrier
    s_add_u32 m0, s63, 121856
    s_add_u32 s50, s92, 110592
    buffer_load_dwordx4 v224, s[28:31], s88 offen offset:3072 sc1 lds
    s_add_u32 m0, s63, 125952
    s_nop 0
    buffer_load_dwordx4 v225, s[28:31], s88 offen offset:3072 sc1 lds
    s_add_u32 m0, s64, 124928
    s_nop 0
    buffer_load_dwordx4 v227, s[24:27], s50 offen lds
    s_add_u32 m0, s64, 129024
    s_nop 0
    buffer_load_dwordx4 v228, s[24:27], s50 offen lds
    s_mov_b32 m0, 130048
    s_cmp_eq_u32 s46, 3
    s_cselect_b64 exec, -1, 0
    buffer_load_dwordx4 v226, s[28:31], s88 offen offset:3072 sc1 lds
    s_mov_b64 exec, -1
    s_mov_b32 m0, 142336
    s_cmp_eq_u32 s46, 1
    s_cselect_b64 exec, -1, 0
    buffer_load_dwordx4 v229, s[24:27], s50 offen lds
    s_mov_b64 exec, -1
    s_waitcnt vmcnt(0)
    s_waitcnt lgkmcnt(0)
L_pmid1e:
    s_barrier

    v_mov_b32 v240, 161792
    ds_read_b128 v[232:235], v240
    v_and_b32 v240, 15, v216
    v_lshlrev_b32 v240, 2, v240
    v_add_u32 v240, 161792, v240
    ds_read_b32 v236, v240 offset:64
    ds_read_b32 v237, v240 offset:128
    ds_read_b32 v238, v240 offset:192
    ds_read_b32 v239, v240 offset:256
    s_waitcnt lgkmcnt(0)
    v_or_b32 v232, v232, v233
    v_or_b32 v234, v234, v235
    v_add_f32 v236, v236, v237
    v_add_f32 v238, v238, v239
    v_or_b32 v232, v232, v234
    v_add_f32 v236, v236, v238
    s_mov_b32 s48, 796917760
    s_mov_b32 s49, 1199570944
    v_cmp_nle_f32 vcc, s48, v236
    v_cmp_nge_f32 s[68:69], s49, v236
    v_cmp_ne_u32 s[70:71], 0, v232

    s_nop 0

    s_nop 0
    s_or_b64 vcc, vcc, s[68:69]
    s_or_b64 vcc, vcc, s[70:71]
    s_cmp_lg_u64 vcc, 0
    s_cbranch_scc1 L_p_safe1

L_p_back1:
    ds_read_b64_tr_b16 v[120:121], v220 offset:0
    ds_read_b64_tr_b16 v[122:123], v220 offset:4096
    ds_read_b64_tr_b16 v[124:125], v221 offset:0
    ds_read_b64_tr_b16 v[126:127], v221 offset:4096
    ds_read_b64_tr_b16 v[128:129], v223 offset:0
    ds_read_b64_tr_b16 v[130:131], v223 offset:512
    ds_read_b128 v[84:87], v217 offset:0
    ds_read_b128 v[88:91], v217 offset:1024
    ds_read_b128 v[92:95], v217 offset:2048
    ds_read_b128 v[96:99], v218 offset:0
    ds_read_b128 v[100:103], v218 offset:1024
    ds_read_b128 v[104:107], v218 offset:2048
    ds_read_b128 v[108:111], v219 offset:0
    ds_read_b128 v[112:115], v219 offset:1024
    ds_read_b128 v[116:119], v219 offset:2048
    s_waitcnt lgkmcnt(0)
    v_mfma_f32_16x16x32_bf16 v[0:3], v[120:123], v[84:87], 0
    ds_read_b64_tr_b16 v[168:169], v220 offset:18432
    v_mfma_f32_16x16x32_bf16 v[36:39], v[124:127], v[84:87], 0
    ds_read_b64_tr_b16 v[170:171], v220 offset:22528
    v_mfma_f32_16x16x32_bf16 v[4:7], v[120:123], v[88:91], 0
    ds_read_b64_tr_b16 v[172:173], v221 offset:18432
    v_mfma_f32_16x16x32_bf16 v[40:43], v[124:127], v[88:91], 0
    ds_read_b64_tr_b16 v[174:175], v221 offset:22528
    v_mfma_f32_16x16x32_bf16 v[8:11], v[120:123], v[92:95], 0
    ds_read_b64_tr_b16 v[176:177], v223 offset:18432
    v_mfma_f32_16x16x32_bf16 v[44:47], v[124:127], v[92:95], 0
    ds_read_b64_tr_b16 v[178:179], v223 offset:18944
    v_mfma_f32_16x16x32_bf16 v[12:15], v[120:123], v[96:99], 0
    ds_read_b128 v[132:135], v217 offset:18432
    v_mfma_f32_16x16x32_bf16 v[48:51], v[124:127], v[96:99], 0
    ds_read_b128 v[136:139], v217 offset:19456
    v_mfma_f32_16x16x32_bf16 v[16:19], v[120:123], v[100:103], 0
    ds_read_b128 v[140:143], v217 offset:20480
    v_mfma_f32_16x16x32_bf16 v[52:55], v[124:127], v[100:103], 0
    ds_read_b128 v[144:147], v218 offset:18432
    v_mfma_f32_16x16x32_bf16 v[20:23], v[120:123], v[104:107], 0
    ds_read_b128 v[148:151], v218 offset:19456
    v_mfma_f32_16x16x32_bf16 v[56:59], v[124:127], v[104:107], 0
    ds_read_b128 v[152:155], v218 offset:20480
    v_mfma_f32_16x16x32_bf16 v[24:27], v[120:123], v[108:111], 0
    ds_read_b128 v[156:159], v219 offset:18432
    v_mfma_f32_16x16x32_bf16 v[60:63], v[124:127], v[108:111], 0
    ds_read_b128 v[160:163], v219 offset:19456
    v_mfma_f32_16x16x32_bf16 v[28:31], v[120:123], v[112:115], 0
    ds_read_b128 v[164:167], v219 offset:20480
    v_mfma_f32_16x16x32_bf16 v[64:67], v[124:127], v[112:115], 0
    v_mfma_f32_16x16x32_bf16 v[32:35], v[120:123], v[116:119], 0
    v_mfma_f32_16x16x32_bf16 v[68:71], v[124:127], v[116:119], 0
    v_mfma_f32_16x16x32_bf16 v[72:75], v[128:131], v[84:87], 0
    v_mfma_f32_16x16x32_bf16 v[76:79], v[128:131], v[88:91], 0
    v_mfma_f32_16x16x32_bf16 v[80:83], v[128:131], v[92:95], 0
    s_waitcnt lgkmcnt(0)
    v_mfma_f32_16x16x32_bf16 v[0:3], v[168:171], v[132:135], v[0:3]
    ds_read_b64_tr_b16 v[120:121], v220 offset:36864
    v_mfma_f32_16x16x32_bf16 v[36:39], v[172:175], v[132:135], v[36:39]
    ds_read_b64_tr_b16 v[122:123], v220 offset:40960
    v_mfma_f32_16x16x32_bf16 v[4:7], v[168:171], v[136:139], v[4:7]
    ds_read_b64_tr_b16 v[124:125], v221 offset:36864
    v_mfma_f32_16x16x32_bf16 v[40:43], v[172:175], v[136:139], v[40:43]
    ds_read_b64_tr_b16 v[126:127], v221 offset:40960
    v_mfma_f32_16x16x32_bf16 v[8:11], v[168:171], v[140:143], v[8:11]
    ds_read_b64_tr_b16 v[128:129], v223 offset:36864
    v_mfma_f32_16x16x32_bf16 v[44:47], v[172:175], v[140:143], v[44:47]
    ds_read_b64_tr_b16 v[130:131], v223 offset:37376
    v_mfma_f32_16x16x32_bf16 v[12:15], v[168:171], v[144:147], v[12:15]
    ds_read_b128 v[84:87], v217 offset:36864
    v_mfma_f32_16x16x32_bf16 v[48:51], v[172:175], v[144:147], v[48:51]
    ds_read_b128 v[88:91], v217 offset:37888
    v_mfma_f32_16x16x32_bf16 v[16:19], v[168:171], v[148:151], v[16:19]
    ds_read_b128 v[92:95], v217 offset:38912
    v_mfma_f32_16x16x32_bf16 v[52:55], v[172:175], v[148:151], v[52:55]
    ds_read_b128 v[96:99], v218 offset:36864
    v_mfma_f32_16x16x32_bf16 v[20:23], v[168:171], v[152:155], v[20:23]
    ds_read_b128 v[100:103], v218 offset:37888
    v_mfma_f32_16x16x32_bf16 v[56:59], v[172:175], v[152:155], v[56:59]
    ds_read_b128 v[104:107], v218 offset:38912
    v_mfma_f32_16x16x32_bf16 v[24:27], v[168:171], v[156:159], v[24:27]
    ds_read_b128 v[108:111], v219 offset:36864
    v_mfma_f32_16x16x32_bf16 v[60:63], v[172:175], v[156:159], v[60:63]
    ds_read_b128 v[112:115], v219 offset:37888
    v_mfma_f32_16x16x32_bf16 v[28:31], v[168:171], v[160:163], v[28:31]
    ds_read_b128 v[116:119], v219 offset:38912
    v_mfma_f32_16x16x32_bf16 v[64:67], v[172:175], v[160:163], v[64:67]
    v_mfma_f32_16x16x32_bf16 v[32:35], v[168:171], v[164:167], v[32:35]
    v_mfma_f32_16x16x32_bf16 v[68:71], v[172:175], v[164:167], v[68:71]
    v_mfma_f32_16x16x32_bf16 v[72:75], v[176:179], v[132:135], v[72:75]
    v_mfma_f32_16x16x32_bf16 v[76:79], v[176:179], v[136:139], v[76:79]
    v_mfma_f32_16x16x32_bf16 v[80:83], v[176:179], v[140:143], v[80:83]
    s_waitcnt lgkmcnt(0)
    s_barrier
    v_mfma_f32_16x16x32_bf16 v[0:3], v[120:123], v[84:87], v[0:3]
    ds_read_b64_tr_b16 v[168:169], v220 offset:55296
    v_mfma_f32_16x16x32_bf16 v[36:39], v[124:127], v[84:87], v[36:39]
    ds_read_b64_tr_b16 v[170:171], v220 offset:59392
    v_mfma_f32_16x16x32_bf16 v[4:7], v[120:123], v[88:91], v[4:7]
    ds_read_b64_tr_b16 v[172:173], v221 offset:55296
    v_mfma_f32_16x16x32_bf16 v[40:43], v[124:127], v[88:91], v[40:43]
    ds_read_b64_tr_b16 v[174:175], v221 offset:59392
    v_mfma_f32_16x16x32_bf16 v[8:11], v[120:123], v[92:95], v[8:11]
    ds_read_b64_tr_b16 v[176:177], v223 offset:55296
    v_mfma_f32_16x16x32_bf16 v[44:47], v[124:127], v[92:95], v[44:47]
    ds_read_b64_tr_b16 v[178:179], v223 offset:55808
    v_mfma_f32_16x16x32_bf16 v[12:15], v[120:123], v[96:99], v[12:15]
    ds_read_b128 v[132:135], v217 offset:55296
    v_mfma_f32_16x16x32_bf16 v[48:51], v[124:127], v[96:99], v[48:51]
    ds_read_b128 v[136:139], v217 offset:56320
    v_mfma_f32_16x16x32_bf16 v[16:19], v[120:123], v[100:103], v[16:19]
    ds_read_b128 v[140:143], v217 offset:57344
    v_mfma_f32_16x16x32_bf16 v[52:55], v[124:127], v[100:103], v[52:55]
    ds_read_b128 v[144:147], v218 offset:55296
    v_mfma_f32_16x16x32_bf16 v[20:23], v[120:123], v[104:107], v[20:23]
    ds_read_b128 v[148:151], v218 offset:56320
    v_mfma_f32_16x16x32_bf16 v[56:59], v[124:127], v[104:107], v[56:59]
    ds_read_b128 v[152:155], v218 offset:57344
    v_mfma_f32_16x16x32_bf16 v[24:27], v[120:123], v[108:111], v[24:27]
    ds_read_b128 v[156:159], v219 offset:55296
    v_mfma_f32_16x16x32_bf16 v[60:63], v[124:127], v[108:111], v[60:63]
    ds_read_b128 v[160:163], v219 offset:56320
    v_mfma_f32_16x16x32_bf16 v[28:31], v[120:123], v[112:115], v[28:31]
    ds_read_b128 v[164:167], v219 offset:57344
    v_mfma_f32_16x16x32_bf16 v[64:67], v[124:127], v[112:115], v[64:67]
    v_mfma_f32_16x16x32_bf16 v[32:35], v[120:123], v[116:119], v[32:35]
    v_mfma_f32_16x16x32_bf16 v[68:71], v[124:127], v[116:119], v[68:71]
    v_mfma_f32_16x16x32_bf16 v[72:75], v[128:131], v[84:87], v[72:75]
    v_mfma_f32_16x16x32_bf16 v[76:79], v[128:131], v[88:91], v[76:79]
    v_mfma_f32_16x16x32_bf16 v[80:83], v[128:131], v[92:95], v[80:83]
    s_waitcnt lgkmcnt(0)
    s_barrier
    v_mfma_f32_16x16x32_bf16 v[0:3], v[168:171], v[132:135], v[0:3]
    ds_read_b64_tr_b16 v[120:121], v220 offset:0
    v_mfma_f32_16x16x32_bf16 v[36:39], v[172:175], v[132:135], v[36:39]
    ds_read_b64_tr_b16 v[122:123], v220 offset:4096
    v_mfma_f32_16x16x32_bf16 v[4:7], v[168:171], v[136:139], v[4:7]
    ds_read_b64_tr_b16 v[124:125], v221 offset:0
    v_mfma_f32_16x16x32_bf16 v[40:43], v[172:175], v[136:139], v[40:43]
    ds_read_b64_tr_b16 v[126:127], v221 offset:4096
    v_mfma_f32_16x16x32_bf16 v[8:11], v[168:171], v[140:143], v[8:11]
    ds_read_b64_tr_b16 v[128:129], v223 offset:0
    v_mfma_f32_16x16x32_bf16 v[44:47], v[172:175], v[140:143], v[44:47]
    ds_read_b64_tr_b16 v[130:131], v223 offset:512
    v_mfma_f32_16x16x32_bf16 v[12:15], v[168:171], v[144:147], v[12:15]
    ds_read_b128 v[84:87], v217 offset:0
    v_mfma_f32_16x16x32_bf16 v[48:51], v[172:175], v[144:147], v[48:51]
    ds_read_b128 v[88:91], v217 offset:1024
    v_mfma_f32_16x16x32_bf16 v[16:19], v[168:171], v[148:151], v[16:19]
    ds_read_b128 v[92:95], v217 offset:2048
    v_mfma_f32_16x16x32_bf16 v[52:55], v[172:175], v[148:151], v[52:55]
    ds_read_b128 v[96:99], v218 offset:0
    v_mfma_f32_16x16x32_bf16 v[20:23], v[168:171], v[152:155], v[20:23]
    ds_read_b128 v[100:103], v218 offset:1024
    v_mfma_f32_16x16x32_bf16 v[56:59], v[172:175], v[152:155], v[56:59]
    ds_read_b128 v[104:107], v218 offset:2048
    v_mfma_f32_16x16x32_bf16 v[24:27], v[168:171], v[156:159], v[24:27]
    ds_read_b128 v[108:111], v219 offset:0
    v_mfma_f32_16x16x32_bf16 v[60:63], v[172:175], v[156:159], v[60:63]
    ds_read_b128 v[112:115], v219 offset:1024
    v_mfma_f32_16x16x32_bf16 v[28:31], v[168:171], v[160:163], v[28:31]
    ds_read_b128 v[116:119], v219 offset:2048
    v_mfma_f32_16x16x32_bf16 v[64:67], v[172:175], v[160:163], v[64:67]
    v_mfma_f32_16x16x32_bf16 v[32:35], v[168:171], v[164:167], v[32:35]
    v_mfma_f32_16x16x32_bf16 v[68:71], v[172:175], v[164:167], v[68:71]
    v_mfma_f32_16x16x32_bf16 v[72:75], v[176:179], v[132:135], v[72:75]
    v_mfma_f32_16x16x32_bf16 v[76:79], v[176:179], v[136:139], v[76:79]
    v_mfma_f32_16x16x32_bf16 v[80:83], v[176:179], v[140:143], v[80:83]
    s_waitcnt lgkmcnt(0)
    s_barrier
    v_mfma_f32_16x16x32_bf16 v[0:3], v[120:123], v[84:87], v[0:3]
    ds_read_b64_tr_b16 v[168:169], v220 offset:18432
    v_mfma_f32_16x16x32_bf16 v[36:39], v[124:127], v[84:87], v[36:39]
    ds_read_b64_tr_b16 v[170:171], v220 offset:22528
    v_mfma_f32_16x16x32_bf16 v[4:7], v[120:123], v[88:91], v[4:7]
    ds_read_b64_tr_b16 v[172:173], v221 offset:18432
    v_mfma_f32_16x16x32_bf16 v[40:43], v[124:127], v[88:91], v[40:43]
    ds_read_b64_tr_b16 v[174:175], v221 offset:22528
    v_mfma_f32_16x16x32_bf16 v[8:11], v[120:123], v[92:95], v[8:11]
    ds_read_b64_tr_b16 v[176:177], v223 offset:18432
    v_mfma_f32_16x16x32_bf16 v[44:47], v[124:127], v[92:95], v[44:47]
    ds_read_b64_tr_b16 v[178:179], v223 offset:18944
    v_mfma_f32_16x16x32_bf16 v[12:15], v[120:123], v[96:99], v[12:15]
    ds_read_b128 v[132:135], v217 offset:18432
    v_mfma_f32_16x16x32_bf16 v[48:51], v[124:127], v[96:99], v[48:51]
    ds_read_b128 v[136:139], v217 offset:19456
    v_mfma_f32_16x16x32_bf16 v[16:19], v[120:123], v[100:103], v[16:19]
    ds_read_b128 v[140:143], v217 offset:20480
    v_mfma_f32_16x16x32_bf16 v[52:55], v[124:127], v[100:103], v[52:55]
    ds_read_b128 v[144:147], v218 offset:18432
    v_mfma_f32_16x16x32_bf16 v[20:23], v[120:123], v[104:107], v[20:23]
    ds_read_b128 v[148:151], v218 offset:19456
    v_mfma_f32_16x16x32_bf16 v[56:59], v[124:127], v[104:107], v[56:59]
    ds_read_b128 v[152:155], v218 offset:20480
    v_mfma_f32_16x16x32_bf16 v[24:27], v[120:123], v[108:111], v[24:27]
    ds_read_b128 v[156:159], v219 offset:18432
    v_mfma_f32_16x16x32_bf16 v[60:63], v[124:127], v[108:111], v[60:63]
    ds_read_b128 v[160:163], v219 offset:19456
    v_mfma_f32_16x16x32_bf16 v[28:31], v[120:123], v[112:115], v[28:31]
    ds_read_b128 v[164:167], v219 offset:20480
    v_mfma_f32_16x16x32_bf16 v[64:67], v[124:127], v[112:115], v[64:67]
    v_mfma_f32_16x16x32_bf16 v[32:35], v[120:123], v[116:119], v[32:35]
    v_mfma_f32_16x16x32_bf16 v[68:71], v[124:127], v[116:119], v[68:71]
    v_mfma_f32_16x16x32_bf16 v[72:75], v[128:131], v[84:87], v[72:75]
    v_mfma_f32_16x16x32_bf16 v[76:79], v[128:131], v[88:91], v[76:79]
    v_mfma_f32_16x16x32_bf16 v[80:83], v[128:131], v[92:95], v[80:83]
    s_waitcnt lgkmcnt(0)
    s_barrier
    v_mfma_f32_16x16x32_bf16 v[0:3], v[168:171], v[132:135], v[0:3]
    ds_read_b64_tr_b16 v[120:121], v220 offset:36864
    v_mfma_f32_16x16x32_bf16 v[36:39], v[172:175], v[132:135], v[36:39]
    ds_read_b64_tr_b16 v[122:123], v220 offset:40960
    v_mfma_f32_16x16x32_bf16 v[4:7], v[168:171], v[136:139], v[4:7]
    ds_read_b64_tr_b16 v[124:125], v221 offset:36864
    v_mfma_f32_16x16x32_bf16 v[40:43], v[172:175], v[136:139], v[40:43]
    ds_read_b64_tr_b16 v[126:127], v221 offset:40960
    v_mfma_f32_16x16x32_bf16 v[8:11], v[168:171], v[140:143], v[8:11]
    ds_read_b64_tr_b16 v[128:129], v223 offset:36864
    v_mfma_f32_16x16x32_bf16 v[44:47], v[172:175], v[140:143], v[44:47]
    ds_read_b64_tr_b16 v[130:131], v223 offset:37376
    v_mfma_f32_16x16x32_bf16 v[12:15], v[168:171], v[144:147], v[12:15]
    ds_read_b128 v[84:87], v217 offset:36864
    v_mfma_f32_16x16x32_bf16 v[48:51], v[172:175], v[144:147], v[48:51]
    ds_read_b128 v[88:91], v217 offset:37888
    v_mfma_f32_16x16x32_bf16 v[16:19], v[168:171], v[148:151], v[16:19]
    ds_read_b128 v[92:95], v217 offset:38912
    v_mfma_f32_16x16x32_bf16 v[52:55], v[172:175], v[148:151], v[52:55]
    ds_read_b128 v[96:99], v218 offset:36864
    v_mfma_f32_16x16x32_bf16 v[20:23], v[168:171], v[152:155], v[20:23]
    ds_read_b128 v[100:103], v218 offset:37888
    v_mfma_f32_16x16x32_bf16 v[56:59], v[172:175], v[152:155], v[56:59]
    ds_read_b128 v[104:107], v218 offset:38912
    v_mfma_f32_16x16x32_bf16 v[24:27], v[168:171], v[156:159], v[24:27]
    ds_read_b128 v[108:111], v219 offset:36864
    v_mfma_f32_16x16x32_bf16 v[60:63], v[172:175], v[156:159], v[60:63]
    ds_read_b128 v[112:115], v219 offset:37888
    v_mfma_f32_16x16x32_bf16 v[28:31], v[168:171], v[160:163], v[28:31]
    ds_read_b128 v[116:119], v219 offset:38912
    v_mfma_f32_16x16x32_bf16 v[64:67], v[172:175], v[160:163], v[64:67]
    v_mfma_f32_16x16x32_bf16 v[32:35], v[168:171], v[164:167], v[32:35]
    v_mfma_f32_16x16x32_bf16 v[68:71], v[172:175], v[164:167], v[68:71]
    v_mfma_f32_16x16x32_bf16 v[72:75], v[176:179], v[132:135], v[72:75]
    v_mfma_f32_16x16x32_bf16 v[76:79], v[176:179], v[136:139], v[76:79]
    v_mfma_f32_16x16x32_bf16 v[80:83], v[176:179], v[140:143], v[80:83]
    s_waitcnt lgkmcnt(0)
    s_barrier
    v_mfma_f32_16x16x32_bf16 v[0:3], v[120:123], v[84:87], v[0:3]
    ds_read_b64_tr_b16 v[168:169], v220 offset:55296
    v_mfma_f32_16x16x32_bf16 v[36:39], v[124:127], v[84:87], v[36:39]
    ds_read_b64_tr_b16 v[170:171], v220 offset:59392
    v_mfma_f32_16x16x32_bf16 v[4:7], v[120:123], v[88:91], v[4:7]
    ds_read_b64_tr_b16 v[172:173], v221 offset:55296
    v_mfma_f32_16x16x32_bf16 v[40:43], v[124:127], v[88:91], v[40:43]
    ds_read_b64_tr_b16 v[174:175], v221 offset:59392
    v_mfma_f32_16x16x32_bf16 v[8:11], v[120:123], v[92:95], v[8:11]
    ds_read_b64_tr_b16 v[176:177], v223 offset:55296
    v_mfma_f32_16x16x32_bf16 v[44:47], v[124:127], v[92:95], v[44:47]
    ds_read_b64_tr_b16 v[178:179], v223 offset:55808
    v_mfma_f32_16x16x32_bf16 v[12:15], v[120:123], v[96:99], v[12:15]
    ds_read_b128 v[132:135], v217 offset:55296
    v_mfma_f32_16x16x32_bf16 v[48:51], v[124:127], v[96:99], v[48:51]
    ds_read_b128 v[136:139], v217 offset:56320
    v_mfma_f32_16x16x32_bf16 v[16:19], v[120:123], v[100:103], v[16:19]
    ds_read_b128 v[140:143], v217 offset:57344
    v_mfma_f32_16x16x32_bf16 v[52:55], v[124:127], v[100:103], v[52:55]
    ds_read_b128 v[144:147], v218 offset:55296
    v_mfma_f32_16x16x32_bf16 v[20:23], v[120:123], v[104:107], v[20:23]
    ds_read_b128 v[148:151], v218 offset:56320
    v_mfma_f32_16x16x32_bf16 v[56:59], v[124:127], v[104:107], v[56:59]
    ds_read_b128 v[152:155], v218 offset:57344
    v_mfma_f32_16x16x32_bf16 v[24:27], v[120:123], v[108:111], v[24:27]
    ds_read_b128 v[156:159], v219 offset:55296
    v_mfma_f32_16x16x32_bf16 v[60:63], v[124:127], v[108:111], v[60:63]
    ds_read_b128 v[160:163], v219 offset:56320
    v_mfma_f32_16x16x32_bf16 v[28:31], v[120:123], v[112:115], v[28:31]
    ds_read_b128 v[164:167], v219 offset:57344
    v_mfma_f32_16x16x32_bf16 v[64:67], v[124:127], v[112:115], v[64:67]
    v_mfma_f32_16x16x32_bf16 v[32:35], v[120:123], v[116:119], v[32:35]
    v_mfma_f32_16x16x32_bf16 v[68:71], v[124:127], v[116:119], v[68:71]
    v_mfma_f32_16x16x32_bf16 v[72:75], v[128:131], v[84:87], v[72:75]
    v_mfma_f32_16x16x32_bf16 v[76:79], v[128:131], v[88:91], v[76:79]
    v_mfma_f32_16x16x32_bf16 v[80:83], v[128:131], v[92:95], v[80:83]
    s_waitcnt lgkmcnt(0)
    s_barrier
    v_mfma_f32_16x16x32_bf16 v[0:3], v[168:171], v[132:135], v[0:3]
    ds_read_b64_tr_b16 v[120:121], v220 offset:0
    v_mfma_f32_16x16x32_bf16 v[36:39], v[172:175], v[132:135], v[36:39]
    ds_read_b64_tr_b16 v[122:123], v220 offset:4096
    v_mfma_f32_16x16x32_bf16 v[4:7], v[168:171], v[136:139], v[4:7]
    ds_read_b64_tr_b16 v[124:125], v221 offset:0
    v_mfma_f32_16x16x32_bf16 v[40:43], v[172:175], v[136:139], v[40:43]
    ds_read_b64_tr_b16 v[126:127], v221 offset:4096
    v_mfma_f32_16x16x32_bf16 v[8:11], v[168:171], v[140:143], v[8:11]
    ds_read_b64_tr_b16 v[128:129], v223 offset:0
    v_mfma_f32_16x16x32_bf16 v[44:47], v[172:175], v[140:143], v[44:47]
    ds_read_b64_tr_b16 v[130:131], v223 offset:512
    v_mfma_f32_16x16x32_bf16 v[12:15], v[168:171], v[144:147], v[12:15]
    ds_read_b128 v[84:87], v217 offset:0
    v_mfma_f32_16x16x32_bf16 v[48:51], v[172:175], v[144:147], v[48:51]
    ds_read_b128 v[88:91], v217 offset:1024
    v_mfma_f32_16x16x32_bf16 v[16:19], v[168:171], v[148:151], v[16:19]
    ds_read_b128 v[92:95], v217 offset:2048
    v_mfma_f32_16x16x32_bf16 v[52:55], v[172:175], v[148:151], v[52:55]
    ds_read_b128 v[96:99], v218 offset:0
    v_mfma_f32_16x16x32_bf16 v[20:23], v[168:171], v[152:155], v[20:23]
    ds_read_b128 v[100:103], v218 offset:1024
    v_mfma_f32_16x16x32_bf16 v[56:59], v[172:175], v[152:155], v[56:59]
    ds_read_b128 v[104:107], v218 offset:2048
    v_mfma_f32_16x16x32_bf16 v[24:27], v[168:171], v[156:159], v[24:27]
    ds_read_b128 v[108:111], v219 offset:0
    v_mfma_f32_16x16x32_bf16 v[60:63], v[172:175], v[156:159], v[60:63]
    ds_read_b128 v[112:115], v219 offset:1024
    v_mfma_f32_16x16x32_bf16 v[28:31], v[168:171], v[160:163], v[28:31]
    ds_read_b128 v[116:119], v219 offset:2048
    v_mfma_f32_16x16x32_bf16 v[64:67], v[172:175], v[160:163], v[64:67]
    v_mfma_f32_16x16x32_bf16 v[32:35], v[168:171], v[164:167], v[32:35]
    v_mfma_f32_16x16x32_bf16 v[68:71], v[172:175], v[164:167], v[68:71]
    v_mfma_f32_16x16x32_bf16 v[72:75], v[176:179], v[132:135], v[72:75]
    v_mfma_f32_16x16x32_bf16 v[76:79], v[176:179], v[136:139], v[76:79]
    v_mfma_f32_16x16x32_bf16 v[80:83], v[176:179], v[140:143], v[80:83]
    s_waitcnt lgkmcnt(0)
    s_barrier
    v_mfma_f32_16x16x32_bf16 v[0:3], v[120:123], v[84:87], v[0:3]
    ds_read_b64_tr_b16 v[168:169], v220 offset:18432
    v_mfma_f32_16x16x32_bf16 v[36:39], v[124:127], v[84:87], v[36:39]
    ds_read_b64_tr_b16 v[170:171], v220 offset:22528
    v_mfma_f32_16x16x32_bf16 v[4:7], v[120:123], v[88:91], v[4:7]
    ds_read_b64_tr_b16 v[172:173], v221 offset:18432
    v_mfma_f32_16x16x32_bf16 v[40:43], v[124:127], v[88:91], v[40:43]
    ds_read_b64_tr_b16 v[174:175], v221 offset:22528
    v_mfma_f32_16x16x32_bf16 v[8:11], v[120:123], v[92:95], v[8:11]
    ds_read_b64_tr_b16 v[176:177], v223 offset:18432
    v_mfma_f32_16x16x32_bf16 v[44:47], v[124:127], v[92:95], v[44:47]
    ds_read_b64_tr_b16 v[178:179], v223 offset:18944
    v_mfma_f32_16x16x32_bf16 v[12:15], v[120:123], v[96:99], v[12:15]
    ds_read_b128 v[132:135], v217 offset:18432
    v_mfma_f32_16x16x32_bf16 v[48:51], v[124:127], v[96:99], v[48:51]
    ds_read_b128 v[136:139], v217 offset:19456
    v_mfma_f32_16x16x32_bf16 v[16:19], v[120:123], v[100:103], v[16:19]
    ds_read_b128 v[140:143], v217 offset:20480
    v_mfma_f32_16x16x32_bf16 v[52:55], v[124:127], v[100:103], v[52:55]
    ds_read_b128 v[144:147], v218 offset:18432
    v_mfma_f32_16x16x32_bf16 v[20:23], v[120:123], v[104:107], v[20:23]
    ds_read_b128 v[148:151], v218 offset:19456
    v_mfma_f32_16x16x32_bf16 v[56:59], v[124:127], v[104:107], v[56:59]
    ds_read_b128 v[152:155], v218 offset:20480
    v_mfma_f32_16x16x32_bf16 v[24:27], v[120:123], v[108:111], v[24:27]
    ds_read_b128 v[156:159], v219 offset:18432
    v_mfma_f32_16x16x32_bf16 v[60:63], v[124:127], v[108:111], v[60:63]
    ds_read_b128 v[160:163], v219 offset:19456
    v_mfma_f32_16x16x32_bf16 v[28:31], v[120:123], v[112:115], v[28:31]
    ds_read_b128 v[164:167], v219 offset:20480
    v_mfma_f32_16x16x32_bf16 v[64:67], v[124:127], v[112:115], v[64:67]
    v_mfma_f32_16x16x32_bf16 v[32:35], v[120:123], v[116:119], v[32:35]
    v_mfma_f32_16x16x32_bf16 v[68:71], v[124:127], v[116:119], v[68:71]
    v_mfma_f32_16x16x32_bf16 v[72:75], v[128:131], v[84:87], v[72:75]
    v_mfma_f32_16x16x32_bf16 v[76:79], v[128:131], v[88:91], v[76:79]
    v_mfma_f32_16x16x32_bf16 v[80:83], v[128:131], v[92:95], v[80:83]
    s_waitcnt lgkmcnt(0)
    s_barrier
    v_mfma_f32_16x16x32_bf16 v[0:3], v[168:171], v[132:135], v[0:3]
    ds_read_b64_tr_b16 v[120:121], v220 offset:36864
    v_mfma_f32_16x16x32_bf16 v[36:39], v[172:175], v[132:135], v[36:39]
    ds_read_b64_tr_b16 v[122:123], v220 offset:40960
    v_mfma_f32_16x16x32_bf16 v[4:7], v[168:171], v[136:139], v[4:7]
    ds_read_b64_tr_b16 v[124:125], v221 offset:36864
    v_mfma_f32_16x16x32_bf16 v[40:43], v[172:175], v[136:139], v[40:43]
    ds_read_b64_tr_b16 v[126:127], v221 offset:40960
    v_mfma_f32_16x16x32_bf16 v[8:11], v[168:171], v[140:143], v[8:11]
    ds_read_b64_tr_b16 v[128:129], v223 offset:36864
    v_mfma_f32_16x16x32_bf16 v[44:47], v[172:175], v[140:143], v[44:47]
    ds_read_b64_tr_b16 v[130:131], v223 offset:37376
    v_mfma_f32_16x16x32_bf16 v[12:15], v[168:171], v[144:147], v[12:15]
    ds_read_b128 v[84:87], v217 offset:36864
    v_mfma_f32_16x16x32_bf16 v[48:51], v[172:175], v[144:147], v[48:51]
    ds_read_b128 v[88:91], v217 offset:37888
    v_mfma_f32_16x16x32_bf16 v[16:19], v[168:171], v[148:151], v[16:19]
    ds_read_b128 v[92:95], v217 offset:38912
    v_mfma_f32_16x16x32_bf16 v[52:55], v[172:175], v[148:151], v[52:55]
    ds_read_b128 v[96:99], v218 offset:36864
    v_mfma_f32_16x16x32_bf16 v[20:23], v[168:171], v[152:155], v[20:23]
    ds_read_b128 v[100:103], v218 offset:37888
    v_mfma_f32_16x16x32_bf16 v[56:59], v[172:175], v[152:155], v[56:59]
    ds_read_b128 v[104:107], v218 offset:38912
    v_mfma_f32_16x16x32_bf16 v[24:27], v[168:171], v[156:159], v[24:27]
    ds_read_b128 v[108:111], v219 offset:36864
    v_mfma_f32_16x16x32_bf16 v[60:63], v[172:175], v[156:159], v[60:63]
    ds_read_b128 v[112:115], v219 offset:37888
    v_mfma_f32_16x16x32_bf16 v[28:31], v[168:171], v[160:163], v[28:31]
    ds_read_b128 v[116:119], v219 offset:38912
    v_mfma_f32_16x16x32_bf16 v[64:67], v[172:175], v[160:163], v[64:67]
    v_mfma_f32_16x16x32_bf16 v[32:35], v[168:171], v[164:167], v[32:35]
    v_mfma_f32_16x16x32_bf16 v[68:71], v[172:175], v[164:167], v[68:71]
    v_mfma_f32_16x16x32_bf16 v[72:75], v[176:179], v[132:135], v[72:75]
    v_mfma_f32_16x16x32_bf16 v[76:79], v[176:179], v[136:139], v[76:79]
    v_mfma_f32_16x16x32_bf16 v[80:83], v[176:179], v[140:143], v[80:83]
    s_waitcnt lgkmcnt(0)
    s_barrier
    v_mfma_f32_16x16x32_bf16 v[0:3], v[120:123], v[84:87], v[0:3]
    ds_read_b64_tr_b16 v[168:169], v220 offset:55296
    v_mfma_f32_16x16x32_bf16 v[36:39], v[124:127], v[84:87], v[36:39]
    ds_read_b64_tr_b16 v[170:171], v220 offset:59392
    v_mfma_f32_16x16x32_bf16 v[4:7], v[120:123], v[88:91], v[4:7]
    ds_read_b64_tr_b16 v[172:173], v221 offset:55296
    v_mfma_f32_16x16x32_bf16 v[40:43], v[124:127], v[88:91], v[40:43]
    ds_read_b64_tr_b16 v[174:175], v221 offset:59392
    v_mfma_f32_16x16x32_bf16 v[8:11], v[120:123], v[92:95], v[8:11]
    ds_read_b64_tr_b16 v[176:177], v223 offset:55296
    v_mfma_f32_16x16x32_bf16 v[44:47], v[124:127], v[92:95], v[44:47]
    ds_read_b64_tr_b16 v[178:179], v223 offset:55808
    v_mfma_f32_16x16x32_bf16 v[12:15], v[120:123], v[96:99], v[12:15]
    ds_read_b128 v[132:135], v217 offset:55296
    v_mfma_f32_16x16x32_bf16 v[48:51], v[124:127], v[96:99], v[48:51]
    ds_read_b128 v[136:139], v217 offset:56320
    v_mfma_f32_16x16x32_bf16 v[16:19], v[120:123], v[100:103], v[16:19]
    ds_read_b128 v[140:143], v217 offset:57344
    v_mfma_f32_16x16x32_bf16 v[52:55], v[124:127], v[100:103], v[52:55]
    ds_read_b128 v[144:147], v218 offset:55296
    v_mfma_f32_16x16x32_bf16 v[20:23], v[120:123], v[104:107], v[20:23]
    ds_read_b128 v[148:151], v218 offset:56320
    v_mfma_f32_16x16x32_bf16 v[56:59], v[124:127], v[104:107], v[56:59]
    ds_read_b128 v[152:155], v218 offset:57344
    v_mfma_f32_16x16x32_bf16 v[24:27], v[120:123], v[108:111], v[24:27]
    ds_read_b128 v[156:159], v219 offset:55296
    v_mfma_f32_16x16x32_bf16 v[60:63], v[124:127], v[108:111], v[60:63]
    ds_read_b128 v[160:163], v219 offset:56320
    v_mfma_f32_16x16x32_bf16 v[28:31], v[120:123], v[112:115], v[28:31]
    ds_read_b128 v[164:167], v219 offset:57344
    v_mfma_f32_16x16x32_bf16 v[64:67], v[124:127], v[112:115], v[64:67]
    v_mfma_f32_16x16x32_bf16 v[32:35], v[120:123], v[116:119], v[32:35]
    v_mfma_f32_16x16x32_bf16 v[68:71], v[124:127], v[116:119], v[68:71]
    v_mfma_f32_16x16x32_bf16 v[72:75], v[128:131], v[84:87], v[72:75]
    v_mfma_f32_16x16x32_bf16 v[76:79], v[128:131], v[88:91], v[76:79]
    v_mfma_f32_16x16x32_bf16 v[80:83], v[128:131], v[92:95], v[80:83]
    s_waitcnt lgkmcnt(0)
    s_barrier
    v_mfma_f32_16x16x32_bf16 v[0:3], v[168:171], v[132:135], v[0:3]
    ds_read_b64_tr_b16 v[120:121], v220 offset:0
    v_mfma_f32_16x16x32_bf16 v[36:39], v[172:175], v[132:135], v[36:39]
    ds_read_b64_tr_b16 v[122:123], v220 offset:4096
    v_mfma_f32_16x16x32_bf16 v[4:7], v[168:171], v[136:139], v[4:7]
    ds_read_b64_tr_b16 v[124:125], v221 offset:0
    v_mfma_f32_16x16x32_bf16 v[40:43], v[172:175], v[136:139], v[40:43]
    ds_read_b64_tr_b16 v[126:127], v221 offset:4096
    v_mfma_f32_16x16x32_bf16 v[8:11], v[168:171], v[140:143], v[8:11]
    ds_read_b64_tr_b16 v[128:129], v223 offset:0
    v_mfma_f32_16x16x32_bf16 v[44:47], v[172:175], v[140:143], v[44:47]
    ds_read_b64_tr_b16 v[130:131], v223 offset:512
    v_mfma_f32_16x16x32_bf16 v[12:15], v[168:171], v[144:147], v[12:15]
    ds_read_b128 v[84:87], v217 offset:0
    v_mfma_f32_16x16x32_bf16 v[48:51], v[172:175], v[144:147], v[48:51]
    ds_read_b128 v[88:91], v217 offset:1024
    v_mfma_f32_16x16x32_bf16 v[16:19], v[168:171], v[148:151], v[16:19]
    ds_read_b128 v[92:95], v217 offset:2048
    v_mfma_f32_16x16x32_bf16 v[52:55], v[172:175], v[148:151], v[52:55]
    ds_read_b128 v[96:99], v218 offset:0
    v_mfma_f32_16x16x32_bf16 v[20:23], v[168:171], v[152:155], v[20:23]
    ds_read_b128 v[100:103], v218 offset:1024
    v_mfma_f32_16x16x32_bf16 v[56:59], v[172:175], v[152:155], v[56:59]
    ds_read_b128 v[104:107], v218 offset:2048
    v_mfma_f32_16x16x32_bf16 v[24:27], v[168:171], v[156:159], v[24:27]
    ds_read_b128 v[108:111], v219 offset:0
    v_mfma_f32_16x16x32_bf16 v[60:63], v[172:175], v[156:159], v[60:63]
    ds_read_b128 v[112:115], v219 offset:1024
    v_mfma_f32_16x16x32_bf16 v[28:31], v[168:171], v[160:163], v[28:31]
    ds_read_b128 v[116:119], v219 offset:2048
    v_mfma_f32_16x16x32_bf16 v[64:67], v[172:175], v[160:163], v[64:67]
    v_mfma_f32_16x16x32_bf16 v[32:35], v[168:171], v[164:167], v[32:35]
    v_mfma_f32_16x16x32_bf16 v[68:71], v[172:175], v[164:167], v[68:71]
    v_mfma_f32_16x16x32_bf16 v[72:75], v[176:179], v[132:135], v[72:75]
    v_mfma_f32_16x16x32_bf16 v[76:79], v[176:179], v[136:139], v[76:79]
    v_mfma_f32_16x16x32_bf16 v[80:83], v[176:179], v[140:143], v[80:83]
    s_waitcnt lgkmcnt(0)
    s_barrier
    v_mfma_f32_16x16x32_bf16 v[0:3], v[120:123], v[84:87], v[0:3]
    ds_read_b64_tr_b16 v[168:169], v220 offset:18432
    v_mfma_f32_16x16x32_bf16 v[36:39], v[124:127], v[84:87], v[36:39]
    ds_read_b64_tr_b16 v[170:171], v220 offset:22528
    v_mfma_f32_16x16x32_bf16 v[4:7], v[120:123], v[88:91], v[4:7]
    ds_read_b64_tr_b16 v[172:173], v221 offset:18432
    v_mfma_f32_16x16x32_bf16 v[40:43], v[124:127], v[88:91], v[40:43]
    ds_read_b64_tr_b16 v[174:175], v221 offset:22528
    v_mfma_f32_16x16x32_bf16 v[8:11], v[120:123], v[92:95], v[8:11]
    ds_read_b64_tr_b16 v[176:177], v223 offset:18432
    v_mfma_f32_16x16x32_bf16 v[44:47], v[124:127], v[92:95], v[44:47]
    ds_read_b64_tr_b16 v[178:179], v223 offset:18944
    v_mfma_f32_16x16x32_bf16 v[12:15], v[120:123], v[96:99], v[12:15]
    ds_read_b128 v[132:135], v217 offset:18432
    v_mfma_f32_16x16x32_bf16 v[48:51], v[124:127], v[96:99], v[48:51]
    ds_read_b128 v[136:139], v217 offset:19456
    v_mfma_f32_16x16x32_bf16 v[16:19], v[120:123], v[100:103], v[16:19]
    ds_read_b128 v[140:143], v217 offset:20480
    v_mfma_f32_16x16x32_bf16 v[52:55], v[124:127], v[100:103], v[52:55]
    ds_read_b128 v[144:147], v218 offset:18432
    v_mfma_f32_16x16x32_bf16 v[20:23], v[120:123], v[104:107], v[20:23]
    ds_read_b128 v[148:151], v218 offset:19456
    v_mfma_f32_16x16x32_bf16 v[56:59], v[124:127], v[104:107], v[56:59]
    ds_read_b128 v[152:155], v218 offset:20480
    v_mfma_f32_16x16x32_bf16 v[24:27], v[120:123], v[108:111], v[24:27]
    ds_read_b128 v[156:159], v219 offset:18432
    v_mfma_f32_16x16x32_bf16 v[60:63], v[124:127], v[108:111], v[60:63]
    ds_read_b128 v[160:163], v219 offset:19456
    v_mfma_f32_16x16x32_bf16 v[28:31], v[120:123], v[112:115], v[28:31]
    ds_read_b128 v[164:167], v219 offset:20480
    v_mfma_f32_16x16x32_bf16 v[64:67], v[124:127], v[112:115], v[64:67]
    v_mfma_f32_16x16x32_bf16 v[32:35], v[120:123], v[116:119], v[32:35]
    v_mfma_f32_16x16x32_bf16 v[68:71], v[124:127], v[116:119], v[68:71]
    v_mfma_f32_16x16x32_bf16 v[72:75], v[128:131], v[84:87], v[72:75]
    v_mfma_f32_16x16x32_bf16 v[76:79], v[128:131], v[88:91], v[76:79]
    v_mfma_f32_16x16x32_bf16 v[80:83], v[128:131], v[92:95], v[80:83]
    s_waitcnt lgkmcnt(0)
    s_barrier
    v_mfma_f32_16x16x32_bf16 v[0:3], v[168:171], v[132:135], v[0:3]
    ds_read_b64_tr_b16 v[120:121], v220 offset:36864
    v_mfma_f32_16x16x32_bf16 v[36:39], v[172:175], v[132:135], v[36:39]
    ds_read_b64_tr_b16 v[122:123], v220 offset:40960
    v_mfma_f32_16x16x32_bf16 v[4:7], v[168:171], v[136:139], v[4:7]
    ds_read_b64_tr_b16 v[124:125], v221 offset:36864
    v_mfma_f32_16x16x32_bf16 v[40:43], v[172:175], v[136:139], v[40:43]
    ds_read_b64_tr_b16 v[126:127], v221 offset:40960
    v_mfma_f32_16x16x32_bf16 v[8:11], v[168:171], v[140:143], v[8:11]
    ds_read_b64_tr_b16 v[128:129], v223 offset:36864
    v_mfma_f32_16x16x32_bf16 v[44:47], v[172:175], v[140:143], v[44:47]
    ds_read_b64_tr_b16 v[130:131], v223 offset:37376
    v_mfma_f32_16x16x32_bf16 v[12:15], v[168:171], v[144:147], v[12:15]
    ds_read_b128 v[84:87], v217 offset:36864
    v_mfma_f32_16x16x32_bf16 v[48:51], v[172:175], v[144:147], v[48:51]
    ds_read_b128 v[88:91], v217 offset:37888
    v_mfma_f32_16x16x32_bf16 v[16:19], v[168:171], v[148:151], v[16:19]
    ds_read_b128 v[92:95], v217 offset:38912
    v_mfma_f32_16x16x32_bf16 v[52:55], v[172:175], v[148:151], v[52:55]
    ds_read_b128 v[96:99], v218 offset:36864
    v_mfma_f32_16x16x32_bf16 v[20:23], v[168:171], v[152:155], v[20:23]
    ds_read_b128 v[100:103], v218 offset:37888
    v_mfma_f32_16x16x32_bf16 v[56:59], v[172:175], v[152:155], v[56:59]
    ds_read_b128 v[104:107], v218 offset:38912
    v_mfma_f32_16x16x32_bf16 v[24:27], v[168:171], v[156:159], v[24:27]
    ds_read_b128 v[108:111], v219 offset:36864
    v_mfma_f32_16x16x32_bf16 v[60:63], v[172:175], v[156:159], v[60:63]
    ds_read_b128 v[112:115], v219 offset:37888
    v_mfma_f32_16x16x32_bf16 v[28:31], v[168:171], v[160:163], v[28:31]
    ds_read_b128 v[116:119], v219 offset:38912
    v_mfma_f32_16x16x32_bf16 v[64:67], v[172:175], v[160:163], v[64:67]
    v_mfma_f32_16x16x32_bf16 v[32:35], v[168:171], v[164:167], v[32:35]
    v_mfma_f32_16x16x32_bf16 v[68:71], v[172:175], v[164:167], v[68:71]
    v_mfma_f32_16x16x32_bf16 v[72:75], v[176:179], v[132:135], v[72:75]
    v_mfma_f32_16x16x32_bf16 v[76:79], v[176:179], v[136:139], v[76:79]
    v_mfma_f32_16x16x32_bf16 v[80:83], v[176:179], v[140:143], v[80:83]
    s_waitcnt lgkmcnt(0)
    s_barrier
    v_mfma_f32_16x16x32_bf16 v[0:3], v[120:123], v[84:87], v[0:3]
    ds_read_b64_tr_b16 v[168:169], v220 offset:55296
    v_mfma_f32_16x16x32_bf16 v[36:39], v[124:127], v[84:87], v[36:39]
    ds_read_b64_tr_b16 v[170:171], v220 offset:59392
    v_mfma_f32_16x16x32_bf16 v[4:7], v[120:123], v[88:91], v[4:7]
    ds_read_b64_tr_b16 v[172:173], v221 offset:55296
    v_mfma_f32_16x16x32_bf16 v[40:43], v[124:127], v[88:91], v[40:43]
    ds_read_b64_tr_b16 v[174:175], v221 offset:59392
    v_mfma_f32_16x16x32_bf16 v[8:11], v[120:123], v[92:95], v[8:11]
    ds_read_b64_tr_b16 v[176:177], v223 offset:55296
    v_mfma_f32_16x16x32_bf16 v[44:47], v[124:127], v[92:95], v[44:47]
    ds_read_b64_tr_b16 v[178:179], v223 offset:55808
    v_mfma_f32_16x16x32_bf16 v[12:15], v[120:123], v[96:99], v[12:15]
    ds_read_b128 v[132:135], v217 offset:55296
    v_mfma_f32_16x16x32_bf16 v[48:51], v[124:127], v[96:99], v[48:51]
    ds_read_b128 v[136:139], v217 offset:56320
    v_mfma_f32_16x16x32_bf16 v[16:19], v[120:123], v[100:103], v[16:19]
    ds_read_b128 v[140:143], v217 offset:57344
    v_mfma_f32_16x16x32_bf16 v[52:55], v[124:127], v[100:103], v[52:55]
    ds_read_b128 v[144:147], v218 offset:55296
    v_mfma_f32_16x16x32_bf16 v[20:23], v[120:123], v[104:107], v[20:23]
    ds_read_b128 v[148:151], v218 offset:56320
    v_mfma_f32_16x16x32_bf16 v[56:59], v[124:127], v[104:107], v[56:59]
    ds_read_b128 v[152:155], v218 offset:57344
    v_mfma_f32_16x16x32_bf16 v[24:27], v[120:123], v[108:111], v[24:27]
    ds_read_b128 v[156:159], v219 offset:55296
    v_mfma_f32_16x16x32_bf16 v[60:63], v[124:127], v[108:111], v[60:63]
    ds_read_b128 v[160:163], v219 offset:56320
    v_mfma_f32_16x16x32_bf16 v[28:31], v[120:123], v[112:115], v[28:31]
    ds_read_b128 v[164:167], v219 offset:57344
    v_mfma_f32_16x16x32_bf16 v[64:67], v[124:127], v[112:115], v[64:67]
    v_mfma_f32_16x16x32_bf16 v[32:35], v[120:123], v[116:119], v[32:35]
    v_mfma_f32_16x16x32_bf16 v[68:71], v[124:127], v[116:119], v[68:71]
    v_mfma_f32_16x16x32_bf16 v[72:75], v[128:131], v[84:87], v[72:75]
    v_mfma_f32_16x16x32_bf16 v[76:79], v[128:131], v[88:91], v[76:79]
    v_mfma_f32_16x16x32_bf16 v[80:83], v[128:131], v[92:95], v[80:83]
    s_waitcnt lgkmcnt(0)
    s_barrier
    v_mfma_f32_16x16x32_bf16 v[0:3], v[168:171], v[132:135], v[0:3]
    ds_read_b64_tr_b16 v[120:121], v220 offset:0
    v_mfma_f32_16x16x32_bf16 v[36:39], v[172:175], v[132:135], v[36:39]
    ds_read_b64_tr_b16 v[122:123], v220 offset:4096
    v_mfma_f32_16x16x32_bf16 v[4:7], v[168:171], v[136:139], v[4:7]
    ds_read_b64_tr_b16 v[124:125], v221 offset:0
    v_mfma_f32_16x16x32_bf16 v[40:43], v[172:175], v[136:139], v[40:43]
    ds_read_b64_tr_b16 v[126:127], v221 offset:4096
    v_mfma_f32_16x16x32_bf16 v[8:11], v[168:171], v[140:143], v[8:11]
    ds_read_b64_tr_b16 v[128:129], v223 offset:0
    v_mfma_f32_16x16x32_bf16 v[44:47], v[172:175], v[140:143], v[44:47]
    ds_read_b64_tr_b16 v[130:131], v223 offset:512
    v_mfma_f32_16x16x32_bf16 v[12:15], v[168:171], v[144:147], v[12:15]
    ds_read_b128 v[84:87], v217 offset:0
    v_mfma_f32_16x16x32_bf16 v[48:51], v[172:175], v[144:147], v[48:51]
    ds_read_b128 v[88:91], v217 offset:1024
    v_mfma_f32_16x16x32_bf16 v[16:19], v[168:171], v[148:151], v[16:19]
    ds_read_b128 v[92:95], v217 offset:2048
    v_mfma_f32_16x16x32_bf16 v[52:55], v[172:175], v[148:151], v[52:55]
    ds_read_b128 v[96:99], v218 offset:0
    v_mfma_f32_16x16x32_bf16 v[20:23], v[168:171], v[152:155], v[20:23]
    ds_read_b128 v[100:103], v218 offset:1024
    v_mfma_f32_16x16x32_bf16 v[56:59], v[172:175], v[152:155], v[56:59]
    ds_read_b128 v[104:107], v218 offset:2048
    v_mfma_f32_16x16x32_bf16 v[24:27], v[168:171], v[156:159], v[24:27]
    ds_read_b128 v[108:111], v219 offset:0
    v_mfma_f32_16x16x32_bf16 v[60:63], v[172:175], v[156:159], v[60:63]
    ds_read_b128 v[112:115], v219 offset:1024
    v_mfma_f32_16x16x32_bf16 v[28:31], v[168:171], v[160:163], v[28:31]
    ds_read_b128 v[116:119], v219 offset:2048
    v_mfma_f32_16x16x32_bf16 v[64:67], v[172:175], v[160:163], v[64:67]
    v_mfma_f32_16x16x32_bf16 v[32:35], v[168:171], v[164:167], v[32:35]
    v_mfma_f32_16x16x32_bf16 v[68:71], v[172:175], v[164:167], v[68:71]
    v_mfma_f32_16x16x32_bf16 v[72:75], v[176:179], v[132:135], v[72:75]
    v_mfma_f32_16x16x32_bf16 v[76:79], v[176:179], v[136:139], v[76:79]
    v_mfma_f32_16x16x32_bf16 v[80:83], v[176:179], v[140:143], v[80:83]
    s_waitcnt lgkmcnt(0)
    s_barrier
    v_mfma_f32_16x16x32_bf16 v[0:3], v[120:123], v[84:87], v[0:3]
    ds_read_b64_tr_b16 v[168:169], v220 offset:18432
    v_mfma_f32_16x16x32_bf16 v[36:39], v[124:127], v[84:87], v[36:39]
    ds_read_b64_tr_b16 v[170:171], v220 offset:22528
    v_mfma_f32_16x16x32_bf16 v[4:7], v[120:123], v[88:91], v[4:7]
    ds_read_b64_tr_b16 v[172:173], v221 offset:18432
    v_mfma_f32_16x16x32_bf16 v[40:43], v[124:127], v[88:91], v[40:43]
    ds_read_b64_tr_b16 v[174:175], v221 offset:22528
    v_mfma_f32_16x16x32_bf16 v[8:11], v[120:123], v[92:95], v[8:11]
    ds_read_b64_tr_b16 v[176:177], v223 offset:18432
    v_mfma_f32_16x16x32_bf16 v[44:47], v[124:127], v[92:95], v[44:47]
    ds_read_b64_tr_b16 v[178:179], v223 offset:18944
    v_mfma_f32_16x16x32_bf16 v[12:15], v[120:123], v[96:99], v[12:15]
    ds_read_b128 v[132:135], v217 offset:18432
    v_mfma_f32_16x16x32_bf16 v[48:51], v[124:127], v[96:99], v[48:51]
    ds_read_b128 v[136:139], v217 offset:19456
    v_mfma_f32_16x16x32_bf16 v[16:19], v[120:123], v[100:103], v[16:19]
    ds_read_b128 v[140:143], v217 offset:20480
    v_mfma_f32_16x16x32_bf16 v[52:55], v[124:127], v[100:103], v[52:55]
    ds_read_b128 v[144:147], v218 offset:18432
    v_mfma_f32_16x16x32_bf16 v[20:23], v[120:123], v[104:107], v[20:23]
    ds_read_b128 v[148:151], v218 offset:19456
    v_mfma_f32_16x16x32_bf16 v[56:59], v[124:127], v[104:107], v[56:59]
    ds_read_b128 v[152:155], v218 offset:20480
    v_mfma_f32_16x16x32_bf16 v[24:27], v[120:123], v[108:111], v[24:27]
    ds_read_b128 v[156:159], v219 offset:18432
    v_mfma_f32_16x16x32_bf16 v[60:63], v[124:127], v[108:111], v[60:63]
    ds_read_b128 v[160:163], v219 offset:19456
    v_mfma_f32_16x16x32_bf16 v[28:31], v[120:123], v[112:115], v[28:31]
    ds_read_b128 v[164:167], v219 offset:20480
    v_mfma_f32_16x16x32_bf16 v[64:67], v[124:127], v[112:115], v[64:67]
    v_mfma_f32_16x16x32_bf16 v[32:35], v[120:123], v[116:119], v[32:35]
    v_mfma_f32_16x16x32_bf16 v[68:71], v[124:127], v[116:119], v[68:71]
    v_mfma_f32_16x16x32_bf16 v[72:75], v[128:131], v[84:87], v[72:75]
    v_mfma_f32_16x16x32_bf16 v[76:79], v[128:131], v[88:91], v[76:79]
    v_mfma_f32_16x16x32_bf16 v[80:83], v[128:131], v[92:95], v[80:83]
    s_waitcnt lgkmcnt(0)
    s_barrier
    v_mfma_f32_16x16x32_bf16 v[0:3], v[168:171], v[132:135], v[0:3]
    ds_read_b64_tr_b16 v[120:121], v220 offset:36864
    v_mfma_f32_16x16x32_bf16 v[36:39], v[172:175], v[132:135], v[36:39]
    ds_read_b64_tr_b16 v[122:123], v220 offset:40960
    v_mfma_f32_16x16x32_bf16 v[4:7], v[168:171], v[136:139], v[4:7]
    ds_read_b64_tr_b16 v[124:125], v221 offset:36864
    v_mfma_f32_16x16x32_bf16 v[40:43], v[172:175], v[136:139], v[40:43]
    ds_read_b64_tr_b16 v[126:127], v221 offset:40960
    v_mfma_f32_16x16x32_bf16 v[8:11], v[168:171], v[140:143], v[8:11]
    ds_read_b64_tr_b16 v[128:129], v223 offset:36864
    v_mfma_f32_16x16x32_bf16 v[44:47], v[172:175], v[140:143], v[44:47]
    ds_read_b64_tr_b16 v[130:131], v223 offset:37376
    v_mfma_f32_16x16x32_bf16 v[12:15], v[168:171], v[144:147], v[12:15]
    ds_read_b128 v[84:87], v217 offset:36864
    v_mfma_f32_16x16x32_bf16 v[48:51], v[172:175], v[144:147], v[48:51]
    ds_read_b128 v[88:91], v217 offset:37888
    v_mfma_f32_16x16x32_bf16 v[16:19], v[168:171], v[148:151], v[16:19]
    ds_read_b128 v[92:95], v217 offset:38912
    v_mfma_f32_16x16x32_bf16 v[52:55], v[172:175], v[148:151], v[52:55]
    ds_read_b128 v[96:99], v218 offset:36864
    v_mfma_f32_16x16x32_bf16 v[20:23], v[168:171], v[152:155], v[20:23]
    ds_read_b128 v[100:103], v218 offset:37888
    v_mfma_f32_16x16x32_bf16 v[56:59], v[172:175], v[152:155], v[56:59]
    ds_read_b128 v[104:107], v218 offset:38912
    v_mfma_f32_16x16x32_bf16 v[24:27], v[168:171], v[156:159], v[24:27]
    ds_read_b128 v[108:111], v219 offset:36864
    v_mfma_f32_16x16x32_bf16 v[60:63], v[172:175], v[156:159], v[60:63]
    ds_read_b128 v[112:115], v219 offset:37888
    v_mfma_f32_16x16x32_bf16 v[28:31], v[168:171], v[160:163], v[28:31]
    ds_read_b128 v[116:119], v219 offset:38912
    v_mfma_f32_16x16x32_bf16 v[64:67], v[172:175], v[160:163], v[64:67]
    v_mfma_f32_16x16x32_bf16 v[32:35], v[168:171], v[164:167], v[32:35]
    v_mfma_f32_16x16x32_bf16 v[68:71], v[172:175], v[164:167], v[68:71]
    v_mfma_f32_16x16x32_bf16 v[72:75], v[176:179], v[132:135], v[72:75]
    v_mfma_f32_16x16x32_bf16 v[76:79], v[176:179], v[136:139], v[76:79]
    v_mfma_f32_16x16x32_bf16 v[80:83], v[176:179], v[140:143], v[80:83]
    s_waitcnt lgkmcnt(0)
    s_barrier
    v_mfma_f32_16x16x32_bf16 v[0:3], v[120:123], v[84:87], v[0:3]
    ds_read_b64_tr_b16 v[168:169], v220 offset:55296
    v_mfma_f32_16x16x32_bf16 v[36:39], v[124:127], v[84:87], v[36:39]
    ds_read_b64_tr_b16 v[170:171], v220 offset:59392
    v_mfma_f32_16x16x32_bf16 v[4:7], v[120:123], v[88:91], v[4:7]
    ds_read_b64_tr_b16 v[172:173], v221 offset:55296
    v_mfma_f32_16x16x32_bf16 v[40:43], v[124:127], v[88:91], v[40:43]
    ds_read_b64_tr_b16 v[174:175], v221 offset:59392
    v_mfma_f32_16x16x32_bf16 v[8:11], v[120:123], v[92:95], v[8:11]
    ds_read_b64_tr_b16 v[176:177], v223 offset:55296
    v_mfma_f32_16x16x32_bf16 v[44:47], v[124:127], v[92:95], v[44:47]
    ds_read_b64_tr_b16 v[178:179], v223 offset:55808
    v_mfma_f32_16x16x32_bf16 v[12:15], v[120:123], v[96:99], v[12:15]
    ds_read_b128 v[132:135], v217 offset:55296
    v_mfma_f32_16x16x32_bf16 v[48:51], v[124:127], v[96:99], v[48:51]
    ds_read_b128 v[136:139], v217 offset:56320
    v_mfma_f32_16x16x32_bf16 v[16:19], v[120:123], v[100:103], v[16:19]
    ds_read_b128 v[140:143], v217 offset:57344
    v_mfma_f32_16x16x32_bf16 v[52:55], v[124:127], v[100:103], v[52:55]
    ds_read_b128 v[144:147], v218 offset:55296
    v_mfma_f32_16x16x32_bf16 v[20:23], v[120:123], v[104:107], v[20:23]
    ds_read_b128 v[148:151], v218 offset:56320
    v_mfma_f32_16x16x32_bf16 v[56:59], v[124:127], v[104:107], v[56:59]
    ds_read_b128 v[152:155], v218 offset:57344
    v_mfma_f32_16x16x32_bf16 v[24:27], v[120:123], v[108:111], v[24:27]
    ds_read_b128 v[156:159], v219 offset:55296
    v_mfma_f32_16x16x32_bf16 v[60:63], v[124:127], v[108:111], v[60:63]
    ds_read_b128 v[160:163], v219 offset:56320
    v_mfma_f32_16x16x32_bf16 v[28:31], v[120:123], v[112:115], v[28:31]
    ds_read_b128 v[164:167], v219 offset:57344
    v_mfma_f32_16x16x32_bf16 v[64:67], v[124:127], v[112:115], v[64:67]
    v_mfma_f32_16x16x32_bf16 v[32:35], v[120:123], v[116:119], v[32:35]
    v_mfma_f32_16x16x32_bf16 v[68:71], v[124:127], v[116:119], v[68:71]
    v_mfma_f32_16x16x32_bf16 v[72:75], v[128:131], v[84:87], v[72:75]
    v_mfma_f32_16x16x32_bf16 v[76:79], v[128:131], v[88:91], v[76:79]
    v_mfma_f32_16x16x32_bf16 v[80:83], v[128:131], v[92:95], v[80:83]
    s_waitcnt lgkmcnt(0)
    s_barrier
    v_mfma_f32_16x16x32_bf16 v[0:3], v[168:171], v[132:135], v[0:3]
    ds_read_b64_tr_b16 v[120:121], v220 offset:0
    v_mfma_f32_16x16x32_bf16 v[36:39], v[172:175], v[132:135], v[36:39]
    ds_read_b64_tr_b16 v[122:123], v220 offset:4096
    v_mfma_f32_16x16x32_bf16 v[4:7], v[168:171], v[136:139], v[4:7]
    ds_read_b64_tr_b16 v[124:125], v221 offset:0
    v_mfma_f32_16x16x32_bf16 v[40:43], v[172:175], v[136:139], v[40:43]
    ds_read_b64_tr_b16 v[126:127], v221 offset:4096
    v_mfma_f32_16x16x32_bf16 v[8:11], v[168:171], v[140:143], v[8:11]
    ds_read_b64_tr_b16 v[128:129], v223 offset:0
    v_mfma_f32_16x16x32_bf16 v[44:47], v[172:175], v[140:143], v[44:47]
    ds_read_b64_tr_b16 v[130:131], v223 offset:512
    v_mfma_f32_16x16x32_bf16 v[12:15], v[168:171], v[144:147], v[12:15]
    ds_read_b128 v[84:87], v217 offset:0
    v_mfma_f32_16x16x32_bf16 v[48:51], v[172:175], v[144:147], v[48:51]
    ds_read_b128 v[88:91], v217 offset:1024
    v_mfma_f32_16x16x32_bf16 v[16:19], v[168:171], v[148:151], v[16:19]
    ds_read_b128 v[92:95], v217 offset:2048
    v_mfma_f32_16x16x32_bf16 v[52:55], v[172:175], v[148:151], v[52:55]
    ds_read_b128 v[96:99], v218 offset:0
    v_mfma_f32_16x16x32_bf16 v[20:23], v[168:171], v[152:155], v[20:23]
    ds_read_b128 v[100:103], v218 offset:1024
    v_mfma_f32_16x16x32_bf16 v[56:59], v[172:175], v[152:155], v[56:59]
    ds_read_b128 v[104:107], v218 offset:2048
    v_mfma_f32_16x16x32_bf16 v[24:27], v[168:171], v[156:159], v[24:27]
    ds_read_b128 v[108:111], v219 offset:0
    v_mfma_f32_16x16x32_bf16 v[60:63], v[172:175], v[156:159], v[60:63]
    ds_read_b128 v[112:115], v219 offset:1024
    v_mfma_f32_16x16x32_bf16 v[28:31], v[168:171], v[160:163], v[28:31]
    ds_read_b128 v[116:119], v219 offset:2048
    v_mfma_f32_16x16x32_bf16 v[64:67], v[172:175], v[160:163], v[64:67]
    v_mfma_f32_16x16x32_bf16 v[32:35], v[168:171], v[164:167], v[32:35]
    v_mfma_f32_16x16x32_bf16 v[68:71], v[172:175], v[164:167], v[68:71]
    v_mfma_f32_16x16x32_bf16 v[72:75], v[176:179], v[132:135], v[72:75]
    v_mfma_f32_16x16x32_bf16 v[76:79], v[176:179], v[136:139], v[76:79]
    v_mfma_f32_16x16x32_bf16 v[80:83], v[176:179], v[140:143], v[80:83]
    s_waitcnt lgkmcnt(0)
    s_barrier
    v_mfma_f32_16x16x32_bf16 v[0:3], v[120:123], v[84:87], v[0:3]
    ds_read_b64_tr_b16 v[168:169], v220 offset:18432
    v_mfma_f32_16x16x32_bf16 v[36:39], v[124:127], v[84:87], v[36:39]
    ds_read_b64_tr_b16 v[170:171], v220 offset:22528
    v_mfma_f32_16x16x32_bf16 v[4:7], v[120:123], v[88:91], v[4:7]
    ds_read_b64_tr_b16 v[172:173], v221 offset:18432
    v_mfma_f32_16x16x32_bf16 v[40:43], v[124:127], v[88:91], v[40:43]
    ds_read_b64_tr_b16 v[174:175], v221 offset:22528
    v_mfma_f32_16x16x32_bf16 v[8:11], v[120:123], v[92:95], v[8:11]
    ds_read_b64_tr_b16 v[176:177], v223 offset:18432
    v_mfma_f32_16x16x32_bf16 v[44:47], v[124:127], v[92:95], v[44:47]
    ds_read_b64_tr_b16 v[178:179], v223 offset:18944
    v_mfma_f32_16x16x32_bf16 v[12:15], v[120:123], v[96:99], v[12:15]
    ds_read_b128 v[132:135], v217 offset:18432
    v_mfma_f32_16x16x32_bf16 v[48:51], v[124:127], v[96:99], v[48:51]
    ds_read_b128 v[136:139], v217 offset:19456
    v_mfma_f32_16x16x32_bf16 v[16:19], v[120:123], v[100:103], v[16:19]
    ds_read_b128 v[140:143], v217 offset:20480
    v_mfma_f32_16x16x32_bf16 v[52:55], v[124:127], v[100:103], v[52:55]
    ds_read_b128 v[144:147], v218 offset:18432
    v_mfma_f32_16x16x32_bf16 v[20:23], v[120:123], v[104:107], v[20:23]
    ds_read_b128 v[148:151], v218 offset:19456
    v_mfma_f32_16x16x32_bf16 v[56:59], v[124:127], v[104:107], v[56:59]
    ds_read_b128 v[152:155], v218 offset:20480
    v_mfma_f32_16x16x32_bf16 v[24:27], v[120:123], v[108:111], v[24:27]
    ds_read_b128 v[156:159], v219 offset:18432
    v_mfma_f32_16x16x32_bf16 v[60:63], v[124:127], v[108:111], v[60:63]
    ds_read_b128 v[160:163], v219 offset:19456
    v_mfma_f32_16x16x32_bf16 v[28:31], v[120:123], v[112:115], v[28:31]
    ds_read_b128 v[164:167], v219 offset:20480
    v_mfma_f32_16x16x32_bf16 v[64:67], v[124:127], v[112:115], v[64:67]
    v_mfma_f32_16x16x32_bf16 v[32:35], v[120:123], v[116:119], v[32:35]
    v_mfma_f32_16x16x32_bf16 v[68:71], v[124:127], v[116:119], v[68:71]
    v_mfma_f32_16x16x32_bf16 v[72:75], v[128:131], v[84:87], v[72:75]
    v_mfma_f32_16x16x32_bf16 v[76:79], v[128:131], v[88:91], v[76:79]
    v_mfma_f32_16x16x32_bf16 v[80:83], v[128:131], v[92:95], v[80:83]
    s_waitcnt lgkmcnt(0)
    s_barrier
    v_mfma_f32_16x16x32_bf16 v[0:3], v[168:171], v[132:135], v[0:3]
    ds_read_b64_tr_b16 v[120:121], v220 offset:36864
    v_mfma_f32_16x16x32_bf16 v[36:39], v[172:175], v[132:135], v[36:39]
    ds_read_b64_tr_b16 v[122:123], v220 offset:40960
    v_mfma_f32_16x16x32_bf16 v[4:7], v[168:171], v[136:139], v[4:7]
    ds_read_b64_tr_b16 v[124:125], v221 offset:36864
    v_mfma_f32_16x16x32_bf16 v[40:43], v[172:175], v[136:139], v[40:43]
    ds_read_b64_tr_b16 v[126:127], v221 offset:40960
    v_mfma_f32_16x16x32_bf16 v[8:11], v[168:171], v[140:143], v[8:11]
    ds_read_b64_tr_b16 v[128:129], v223 offset:36864
    v_mfma_f32_16x16x32_bf16 v[44:47], v[172:175], v[140:143], v[44:47]
    ds_read_b64_tr_b16 v[130:131], v223 offset:37376
    v_mfma_f32_16x16x32_bf16 v[12:15], v[168:171], v[144:147], v[12:15]
    ds_read_b128 v[84:87], v217 offset:36864
    v_mfma_f32_16x16x32_bf16 v[48:51], v[172:175], v[144:147], v[48:51]
    ds_read_b128 v[88:91], v217 offset:37888
    v_mfma_f32_16x16x32_bf16 v[16:19], v[168:171], v[148:151], v[16:19]
    ds_read_b128 v[92:95], v217 offset:38912
    v_mfma_f32_16x16x32_bf16 v[52:55], v[172:175], v[148:151], v[52:55]
    ds_read_b128 v[96:99], v218 offset:36864
    v_mfma_f32_16x16x32_bf16 v[20:23], v[168:171], v[152:155], v[20:23]
    ds_read_b128 v[100:103], v218 offset:37888
    v_mfma_f32_16x16x32_bf16 v[56:59], v[172:175], v[152:155], v[56:59]
    ds_read_b128 v[104:107], v218 offset:38912
    v_mfma_f32_16x16x32_bf16 v[24:27], v[168:171], v[156:159], v[24:27]
    ds_read_b128 v[108:111], v219 offset:36864
    v_mfma_f32_16x16x32_bf16 v[60:63], v[172:175], v[156:159], v[60:63]
    ds_read_b128 v[112:115], v219 offset:37888
    v_mfma_f32_16x16x32_bf16 v[28:31], v[168:171], v[160:163], v[28:31]
    ds_read_b128 v[116:119], v219 offset:38912
    v_mfma_f32_16x16x32_bf16 v[64:67], v[172:175], v[160:163], v[64:67]
    v_mfma_f32_16x16x32_bf16 v[32:35], v[168:171], v[164:167], v[32:35]
    v_mfma_f32_16x16x32_bf16 v[68:71], v[172:175], v[164:167], v[68:71]
    v_mfma_f32_16x16x32_bf16 v[72:75], v[176:179], v[132:135], v[72:75]
    v_mfma_f32_16x16x32_bf16 v[76:79], v[176:179], v[136:139], v[76:79]
    v_mfma_f32_16x16x32_bf16 v[80:83], v[176:179], v[140:143], v[80:83]
    s_waitcnt lgkmcnt(0)
    s_barrier
    v_mfma_f32_16x16x32_bf16 v[0:3], v[120:123], v[84:87], v[0:3]
    ds_read_b64_tr_b16 v[168:169], v220 offset:55296
    v_mfma_f32_16x16x32_bf16 v[36:39], v[124:127], v[84:87], v[36:39]
    ds_read_b64_tr_b16 v[170:171], v220 offset:59392
    v_mfma_f32_16x16x32_bf16 v[4:7], v[120:123], v[88:91], v[4:7]
    ds_read_b64_tr_b16 v[172:173], v221 offset:55296
    v_mfma_f32_16x16x32_bf16 v[40:43], v[124:127], v[88:91], v[40:43]
    ds_read_b64_tr_b16 v[174:175], v221 offset:59392
    v_mfma_f32_16x16x32_bf16 v[8:11], v[120:123], v[92:95], v[8:11]
    ds_read_b64_tr_b16 v[176:177], v223 offset:55296
    v_mfma_f32_16x16x32_bf16 v[44:47], v[124:127], v[92:95], v[44:47]
    ds_read_b64_tr_b16 v[178:179], v223 offset:55808
    v_mfma_f32_16x16x32_bf16 v[12:15], v[120:123], v[96:99], v[12:15]
    ds_read_b128 v[132:135], v217 offset:55296
    v_mfma_f32_16x16x32_bf16 v[48:51], v[124:127], v[96:99], v[48:51]
    ds_read_b128 v[136:139], v217 offset:56320
    v_mfma_f32_16x16x32_bf16 v[16:19], v[120:123], v[100:103], v[16:19]
    ds_read_b128 v[140:143], v217 offset:57344
    v_mfma_f32_16x16x32_bf16 v[52:55], v[124:127], v[100:103], v[52:55]
    ds_read_b128 v[144:147], v218 offset:55296
    v_mfma_f32_16x16x32_bf16 v[20:23], v[120:123], v[104:107], v[20:23]
    ds_read_b128 v[148:151], v218 offset:56320
    v_mfma_f32_16x16x32_bf16 v[56:59], v[124:127], v[104:107], v[56:59]
    ds_read_b128 v[152:155], v218 offset:57344
    v_mfma_f32_16x16x32_bf16 v[24:27], v[120:123], v[108:111], v[24:27]
    ds_read_b128 v[156:159], v219 offset:55296
    v_mfma_f32_16x16x32_bf16 v[60:63], v[124:127], v[108:111], v[60:63]
    ds_read_b128 v[160:163], v219 offset:56320
    v_mfma_f32_16x16x32_bf16 v[28:31], v[120:123], v[112:115], v[28:31]
    ds_read_b128 v[164:167], v219 offset:57344
    v_mfma_f32_16x16x32_bf16 v[64:67], v[124:127], v[112:115], v[64:67]
    v_mfma_f32_16x16x32_bf16 v[32:35], v[120:123], v[116:119], v[32:35]
    v_mfma_f32_16x16x32_bf16 v[68:71], v[124:127], v[116:119], v[68:71]
    v_mfma_f32_16x16x32_bf16 v[72:75], v[128:131], v[84:87], v[72:75]
    v_mfma_f32_16x16x32_bf16 v[76:79], v[128:131], v[88:91], v[76:79]
    v_mfma_f32_16x16x32_bf16 v[80:83], v[128:131], v[92:95], v[80:83]
    s_waitcnt lgkmcnt(0)
    s_barrier
    v_mfma_f32_16x16x32_bf16 v[0:3], v[168:171], v[132:135], v[0:3]
    ds_read_b64_tr_b16 v[120:121], v220 offset:0
    v_mfma_f32_16x16x32_bf16 v[36:39], v[172:175], v[132:135], v[36:39]
    ds_read_b64_tr_b16 v[122:123], v220 offset:4096
    v_mfma_f32_16x16x32_bf16 v[4:7], v[168:171], v[136:139], v[4:7]
    ds_read_b64_tr_b16 v[124:125], v221 offset:0
    v_mfma_f32_16x16x32_bf16 v[40:43], v[172:175], v[136:139], v[40:43]
    ds_read_b64_tr_b16 v[126:127], v221 offset:4096
    v_mfma_f32_16x16x32_bf16 v[8:11], v[168:171], v[140:143], v[8:11]
    ds_read_b64_tr_b16 v[128:129], v223 offset:0
    v_mfma_f32_16x16x32_bf16 v[44:47], v[172:175], v[140:143], v[44:47]
    ds_read_b64_tr_b16 v[130:131], v223 offset:512
    v_mfma_f32_16x16x32_bf16 v[12:15], v[168:171], v[144:147], v[12:15]
    ds_read_b128 v[84:87], v217 offset:0
    v_mfma_f32_16x16x32_bf16 v[48:51], v[172:175], v[144:147], v[48:51]
    ds_read_b128 v[88:91], v217 offset:1024
    v_mfma_f32_16x16x32_bf16 v[16:19], v[168:171], v[148:151], v[16:19]
    ds_read_b128 v[92:95], v217 offset:2048
    v_mfma_f32_16x16x32_bf16 v[52:55], v[172:175], v[148:151], v[52:55]
    ds_read_b128 v[96:99], v218 offset:0
    v_mfma_f32_16x16x32_bf16 v[20:23], v[168:171], v[152:155], v[20:23]
    ds_read_b128 v[100:103], v218 offset:1024
    v_mfma_f32_16x16x32_bf16 v[56:59], v[172:175], v[152:155], v[56:59]
    ds_read_b128 v[104:107], v218 offset:2048
    v_mfma_f32_16x16x32_bf16 v[24:27], v[168:171], v[156:159], v[24:27]
    ds_read_b128 v[108:111], v219 offset:0
    v_mfma_f32_16x16x32_bf16 v[60:63], v[172:175], v[156:159], v[60:63]
    ds_read_b128 v[112:115], v219 offset:1024
    v_mfma_f32_16x16x32_bf16 v[28:31], v[168:171], v[160:163], v[28:31]
    ds_read_b128 v[116:119], v219 offset:2048
    v_mfma_f32_16x16x32_bf16 v[64:67], v[172:175], v[160:163], v[64:67]
    v_mfma_f32_16x16x32_bf16 v[32:35], v[168:171], v[164:167], v[32:35]
    v_mfma_f32_16x16x32_bf16 v[68:71], v[172:175], v[164:167], v[68:71]
    v_mfma_f32_16x16x32_bf16 v[72:75], v[176:179], v[132:135], v[72:75]
    v_mfma_f32_16x16x32_bf16 v[76:79], v[176:179], v[136:139], v[76:79]
    v_mfma_f32_16x16x32_bf16 v[80:83], v[176:179], v[140:143], v[80:83]
    s_waitcnt lgkmcnt(0)
    s_barrier
    v_mfma_f32_16x16x32_bf16 v[0:3], v[120:123], v[84:87], v[0:3]
    ds_read_b64_tr_b16 v[168:169], v220 offset:18432
    v_mfma_f32_16x16x32_bf16 v[36:39], v[124:127], v[84:87], v[36:39]
    ds_read_b64_tr_b16 v[170:171], v220 offset:22528
    v_mfma_f32_16x16x32_bf16 v[4:7], v[120:123], v[88:91], v[4:7]
    ds_read_b64_tr_b16 v[172:173], v221 offset:18432
    v_mfma_f32_16x16x32_bf16 v[40:43], v[124:127], v[88:91], v[40:43]
    ds_read_b64_tr_b16 v[174:175], v221 offset:22528
    v_mfma_f32_16x16x32_bf16 v[8:11], v[120:123], v[92:95], v[8:11]
    ds_read_b64_tr_b16 v[176:177], v223 offset:18432
    v_mfma_f32_16x16x32_bf16 v[44:47], v[124:127], v[92:95], v[44:47]
    ds_read_b64_tr_b16 v[178:179], v223 offset:18944
    v_mfma_f32_16x16x32_bf16 v[12:15], v[120:123], v[96:99], v[12:15]
    ds_read_b128 v[132:135], v217 offset:18432
    v_mfma_f32_16x16x32_bf16 v[48:51], v[124:127], v[96:99], v[48:51]
    ds_read_b128 v[136:139], v217 offset:19456
    v_mfma_f32_16x16x32_bf16 v[16:19], v[120:123], v[100:103], v[16:19]
    ds_read_b128 v[140:143], v217 offset:20480
    v_mfma_f32_16x16x32_bf16 v[52:55], v[124:127], v[100:103], v[52:55]
    ds_read_b128 v[144:147], v218 offset:18432
    v_mfma_f32_16x16x32_bf16 v[20:23], v[120:123], v[104:107], v[20:23]
    ds_read_b128 v[148:151], v218 offset:19456
    v_mfma_f32_16x16x32_bf16 v[56:59], v[124:127], v[104:107], v[56:59]
    ds_read_b128 v[152:155], v218 offset:20480
    v_mfma_f32_16x16x32_bf16 v[24:27], v[120:123], v[108:111], v[24:27]
    ds_read_b128 v[156:159], v219 offset:18432
    v_mfma_f32_16x16x32_bf16 v[60:63], v[124:127], v[108:111], v[60:63]
    ds_read_b128 v[160:163], v219 offset:19456
    v_mfma_f32_16x16x32_bf16 v[28:31], v[120:123], v[112:115], v[28:31]
    ds_read_b128 v[164:167], v219 offset:20480
    v_mfma_f32_16x16x32_bf16 v[64:67], v[124:127], v[112:115], v[64:67]
    v_mfma_f32_16x16x32_bf16 v[32:35], v[120:123], v[116:119], v[32:35]
    v_mfma_f32_16x16x32_bf16 v[68:71], v[124:127], v[116:119], v[68:71]
    v_mfma_f32_16x16x32_bf16 v[72:75], v[128:131], v[84:87], v[72:75]
    v_mfma_f32_16x16x32_bf16 v[76:79], v[128:131], v[88:91], v[76:79]
    v_mfma_f32_16x16x32_bf16 v[80:83], v[128:131], v[92:95], v[80:83]
    s_waitcnt lgkmcnt(0)
    s_barrier
    v_mfma_f32_16x16x32_bf16 v[0:3], v[168:171], v[132:135], v[0:3]
    ds_read_b64_tr_b16 v[120:121], v220 offset:36864
    v_mfma_f32_16x16x32_bf16 v[36:39], v[172:175], v[132:135], v[36:39]
    ds_read_b64_tr_b16 v[122:123], v220 offset:40960
    v_mfma_f32_16x16x32_bf16 v[4:7], v[168:171], v[136:139], v[4:7]
    ds_read_b64_tr_b16 v[124:125], v221 offset:36864
    v_mfma_f32_16x16x32_bf16 v[40:43], v[172:175], v[136:139], v[40:43]
    ds_read_b64_tr_b16 v[126:127], v221 offset:40960
    v_mfma_f32_16x16x32_bf16 v[8:11], v[168:171], v[140:143], v[8:11]
    ds_read_b64_tr_b16 v[128:129], v223 offset:36864
    v_mfma_f32_16x16x32_bf16 v[44:47], v[172:175], v[140:143], v[44:47]
    ds_read_b64_tr_b16 v[130:131], v223 offset:37376
    v_mfma_f32_16x16x32_bf16 v[12:15], v[168:171], v[144:147], v[12:15]
    ds_read_b128 v[84:87], v217 offset:36864
    v_mfma_f32_16x16x32_bf16 v[48:51], v[172:175], v[144:147], v[48:51]
    ds_read_b128 v[88:91], v217 offset:37888
    v_mfma_f32_16x16x32_bf16 v[16:19], v[168:171], v[148:151], v[16:19]
    ds_read_b128 v[92:95], v217 offset:38912
    v_mfma_f32_16x16x32_bf16 v[52:55], v[172:175], v[148:151], v[52:55]
    ds_read_b128 v[96:99], v218 offset:36864
    v_mfma_f32_16x16x32_bf16 v[20:23], v[168:171], v[152:155], v[20:23]
    ds_read_b128 v[100:103], v218 offset:37888
    v_mfma_f32_16x16x32_bf16 v[56:59], v[172:175], v[152:155], v[56:59]
    ds_read_b128 v[104:107], v218 offset:38912
    v_mfma_f32_16x16x32_bf16 v[24:27], v[168:171], v[156:159], v[24:27]
    ds_read_b128 v[108:111], v219 offset:36864
    v_mfma_f32_16x16x32_bf16 v[60:63], v[172:175], v[156:159], v[60:63]
    ds_read_b128 v[112:115], v219 offset:37888
    v_mfma_f32_16x16x32_bf16 v[28:31], v[168:171], v[160:163], v[28:31]
    ds_read_b128 v[116:119], v219 offset:38912
    v_mfma_f32_16x16x32_bf16 v[64:67], v[172:175], v[160:163], v[64:67]
    v_mfma_f32_16x16x32_bf16 v[32:35], v[168:171], v[164:167], v[32:35]
    v_mfma_f32_16x16x32_bf16 v[68:71], v[172:175], v[164:167], v[68:71]
    v_mfma_f32_16x16x32_bf16 v[72:75], v[176:179], v[132:135], v[72:75]
    v_mfma_f32_16x16x32_bf16 v[76:79], v[176:179], v[136:139], v[76:79]
    v_mfma_f32_16x16x32_bf16 v[80:83], v[176:179], v[140:143], v[80:83]
    s_waitcnt lgkmcnt(0)
    s_barrier
    v_mfma_f32_16x16x32_bf16 v[0:3], v[120:123], v[84:87], v[0:3]
    ds_read_b64_tr_b16 v[168:169], v220 offset:55296
    v_mfma_f32_16x16x32_bf16 v[36:39], v[124:127], v[84:87], v[36:39]
    ds_read_b64_tr_b16 v[170:171], v220 offset:59392
    v_mfma_f32_16x16x32_bf16 v[4:7], v[120:123], v[88:91], v[4:7]
    ds_read_b64_tr_b16 v[172:173], v221 offset:55296
    v_mfma_f32_16x16x32_bf16 v[40:43], v[124:127], v[88:91], v[40:43]
    ds_read_b64_tr_b16 v[174:175], v221 offset:59392
    v_mfma_f32_16x16x32_bf16 v[8:11], v[120:123], v[92:95], v[8:11]
    ds_read_b64_tr_b16 v[176:177], v223 offset:55296
    v_mfma_f32_16x16x32_bf16 v[44:47], v[124:127], v[92:95], v[44:47]
    ds_read_b64_tr_b16 v[178:179], v223 offset:55808
    v_mfma_f32_16x16x32_bf16 v[12:15], v[120:123], v[96:99], v[12:15]
    ds_read_b128 v[132:135], v217 offset:55296
    v_mfma_f32_16x16x32_bf16 v[48:51], v[124:127], v[96:99], v[48:51]
    ds_read_b128 v[136:139], v217 offset:56320
    v_mfma_f32_16x16x32_bf16 v[16:19], v[120:123], v[100:103], v[16:19]
    ds_read_b128 v[140:143], v217 offset:57344
    v_mfma_f32_16x16x32_bf16 v[52:55], v[124:127], v[100:103], v[52:55]
    ds_read_b128 v[144:147], v218 offset:55296
    v_mfma_f32_16x16x32_bf16 v[20:23], v[120:123], v[104:107], v[20:23]
    ds_read_b128 v[148:151], v218 offset:56320
    v_mfma_f32_16x16x32_bf16 v[56:59], v[124:127], v[104:107], v[56:59]
    ds_read_b128 v[152:155], v218 offset:57344
    v_mfma_f32_16x16x32_bf16 v[24:27], v[120:123], v[108:111], v[24:27]
    ds_read_b128 v[156:159], v219 offset:55296
    v_mfma_f32_16x16x32_bf16 v[60:63], v[124:127], v[108:111], v[60:63]
    ds_read_b128 v[160:163], v219 offset:56320
    v_mfma_f32_16x16x32_bf16 v[28:31], v[120:123], v[112:115], v[28:31]
    ds_read_b128 v[164:167], v219 offset:57344
    v_mfma_f32_16x16x32_bf16 v[64:67], v[124:127], v[112:115], v[64:67]
    v_mfma_f32_16x16x32_bf16 v[32:35], v[120:123], v[116:119], v[32:35]
    v_mfma_f32_16x16x32_bf16 v[68:71], v[124:127], v[116:119], v[68:71]
    v_mfma_f32_16x16x32_bf16 v[72:75], v[128:131], v[84:87], v[72:75]
    v_mfma_f32_16x16x32_bf16 v[76:79], v[128:131], v[88:91], v[76:79]
    v_mfma_f32_16x16x32_bf16 v[80:83], v[128:131], v[92:95], v[80:83]
    s_waitcnt lgkmcnt(0)
    s_barrier
    v_mfma_f32_16x16x32_bf16 v[0:3], v[168:171], v[132:135], v[0:3]
    ds_read_b64_tr_b16 v[120:121], v220 offset:0
    v_mfma_f32_16x16x32_bf16 v[36:39], v[172:175], v[132:135], v[36:39]
    ds_read_b64_tr_b16 v[122:123], v220 offset:4096
    v_mfma_f32_16x16x32_bf16 v[4:7], v[168:171], v[136:139], v[4:7]
    ds_read_b64_tr_b16 v[124:125], v221 offset:0
    v_mfma_f32_16x16x32_bf16 v[40:43], v[172:175], v[136:139], v[40:43]
    ds_read_b64_tr_b16 v[126:127], v221 offset:4096
    v_mfma_f32_16x16x32_bf16 v[8:11], v[168:171], v[140:143], v[8:11]
    ds_read_b64_tr_b16 v[128:129], v223 offset:0
    v_mfma_f32_16x16x32_bf16 v[44:47], v[172:175], v[140:143], v[44:47]
    ds_read_b64_tr_b16 v[130:131], v223 offset:512
    v_mfma_f32_16x16x32_bf16 v[12:15], v[168:171], v[144:147], v[12:15]
    ds_read_b128 v[84:87], v217 offset:0
    v_mfma_f32_16x16x32_bf16 v[48:51], v[172:175], v[144:147], v[48:51]
    ds_read_b128 v[88:91], v217 offset:1024
    v_mfma_f32_16x16x32_bf16 v[16:19], v[168:171], v[148:151], v[16:19]
    ds_read_b128 v[92:95], v217 offset:2048
    v_mfma_f32_16x16x32_bf16 v[52:55], v[172:175], v[148:151], v[52:55]
    ds_read_b128 v[96:99], v218 offset:0
    v_mfma_f32_16x16x32_bf16 v[20:23], v[168:171], v[152:155], v[20:23]
    ds_read_b128 v[100:103], v218 offset:1024
    v_mfma_f32_16x16x32_bf16 v[56:59], v[172:175], v[152:155], v[56:59]
    ds_read_b128 v[104:107], v218 offset:2048
    v_mfma_f32_16x16x32_bf16 v[24:27], v[168:171], v[156:159], v[24:27]
    ds_read_b128 v[108:111], v219 offset:0
    v_mfma_f32_16x16x32_bf16 v[60:63], v[172:175], v[156:159], v[60:63]
    ds_read_b128 v[112:115], v219 offset:1024
    v_mfma_f32_16x16x32_bf16 v[28:31], v[168:171], v[160:163], v[28:31]
    ds_read_b128 v[116:119], v219 offset:2048
    v_mfma_f32_16x16x32_bf16 v[64:67], v[172:175], v[160:163], v[64:67]
    v_mfma_f32_16x16x32_bf16 v[32:35], v[168:171], v[164:167], v[32:35]
    v_mfma_f32_16x16x32_bf16 v[68:71], v[172:175], v[164:167], v[68:71]
    v_mfma_f32_16x16x32_bf16 v[72:75], v[176:179], v[132:135], v[72:75]
    v_mfma_f32_16x16x32_bf16 v[76:79], v[176:179], v[136:139], v[76:79]
    v_mfma_f32_16x16x32_bf16 v[80:83], v[176:179], v[140:143], v[80:83]
    s_waitcnt lgkmcnt(0)
    s_barrier
    v_mfma_f32_16x16x32_bf16 v[0:3], v[120:123], v[84:87], v[0:3]
    ds_read_b64_tr_b16 v[168:169], v220 offset:18432
    v_mfma_f32_16x16x32_bf16 v[36:39], v[124:127], v[84:87], v[36:39]
    ds_read_b64_tr_b16 v[170:171], v220 offset:22528
    v_mfma_f32_16x16x32_bf16 v[4:7], v[120:123], v[88:91], v[4:7]
    ds_read_b64_tr_b16 v[172:173], v221 offset:18432
    v_mfma_f32_16x16x32_bf16 v[40:43], v[124:127], v[88:91], v[40:43]
    ds_read_b64_tr_b16 v[174:175], v221 offset:22528
    v_mfma_f32_16x16x32_bf16 v[8:11], v[120:123], v[92:95], v[8:11]
    ds_read_b64_tr_b16 v[176:177], v223 offset:18432
    v_mfma_f32_16x16x32_bf16 v[44:47], v[124:127], v[92:95], v[44:47]
    ds_read_b64_tr_b16 v[178:179], v223 offset:18944
    v_mfma_f32_16x16x32_bf16 v[12:15], v[120:123], v[96:99], v[12:15]
    ds_read_b128 v[132:135], v217 offset:18432
    v_mfma_f32_16x16x32_bf16 v[48:51], v[124:127], v[96:99], v[48:51]
    ds_read_b128 v[136:139], v217 offset:19456
    v_mfma_f32_16x16x32_bf16 v[16:19], v[120:123], v[100:103], v[16:19]
    ds_read_b128 v[140:143], v217 offset:20480
    v_mfma_f32_16x16x32_bf16 v[52:55], v[124:127], v[100:103], v[52:55]
    ds_read_b128 v[144:147], v218 offset:18432
    v_mfma_f32_16x16x32_bf16 v[20:23], v[120:123], v[104:107], v[20:23]
    ds_read_b128 v[148:151], v218 offset:19456
    v_mfma_f32_16x16x32_bf16 v[56:59], v[124:127], v[104:107], v[56:59]
    ds_read_b128 v[152:155], v218 offset:20480
    v_mfma_f32_16x16x32_bf16 v[24:27], v[120:123], v[108:111], v[24:27]
    ds_read_b128 v[156:159], v219 offset:18432
    v_mfma_f32_16x16x32_bf16 v[60:63], v[124:127], v[108:111], v[60:63]
    ds_read_b128 v[160:163], v219 offset:19456
    v_mfma_f32_16x16x32_bf16 v[28:31], v[120:123], v[112:115], v[28:31]
    ds_read_b128 v[164:167], v219 offset:20480
    v_mfma_f32_16x16x32_bf16 v[64:67], v[124:127], v[112:115], v[64:67]
    v_mfma_f32_16x16x32_bf16 v[32:35], v[120:123], v[116:119], v[32:35]
    v_mfma_f32_16x16x32_bf16 v[68:71], v[124:127], v[116:119], v[68:71]
    v_mfma_f32_16x16x32_bf16 v[72:75], v[128:131], v[84:87], v[72:75]
    v_mfma_f32_16x16x32_bf16 v[76:79], v[128:131], v[88:91], v[76:79]
    v_mfma_f32_16x16x32_bf16 v[80:83], v[128:131], v[92:95], v[80:83]
    s_waitcnt lgkmcnt(0)
    s_barrier
    v_mfma_f32_16x16x32_bf16 v[0:3], v[168:171], v[132:135], v[0:3]
    ds_read_b64_tr_b16 v[120:121], v220 offset:36864
    v_mfma_f32_16x16x32_bf16 v[36:39], v[172:175], v[132:135], v[36:39]
    ds_read_b64_tr_b16 v[122:123], v220 offset:40960
    v_mfma_f32_16x16x32_bf16 v[4:7], v[168:171], v[136:139], v[4:7]
    ds_read_b64_tr_b16 v[124:125], v221 offset:36864
    v_mfma_f32_16x16x32_bf16 v[40:43], v[172:175], v[136:139], v[40:43]
    ds_read_b64_tr_b16 v[126:127], v221 offset:40960
    v_mfma_f32_16x16x32_bf16 v[8:11], v[168:171], v[140:143], v[8:11]
    ds_read_b64_tr_b16 v[128:129], v223 offset:36864
    v_mfma_f32_16x16x32_bf16 v[44:47], v[172:175], v[140:143], v[44:47]
    ds_read_b64_tr_b16 v[130:131], v223 offset:37376
    v_mfma_f32_16x16x32_bf16 v[12:15], v[168:171], v[144:147], v[12:15]
    ds_read_b128 v[84:87], v217 offset:36864
    v_mfma_f32_16x16x32_bf16 v[48:51], v[172:175], v[144:147], v[48:51]
    ds_read_b128 v[88:91], v217 offset:37888
    v_mfma_f32_16x16x32_bf16 v[16:19], v[168:171], v[148:151], v[16:19]
    ds_read_b128 v[92:95], v217 offset:38912
    v_mfma_f32_16x16x32_bf16 v[52:55], v[172:175], v[148:151], v[52:55]
    ds_read_b128 v[96:99], v218 offset:36864
    v_mfma_f32_16x16x32_bf16 v[20:23], v[168:171], v[152:155], v[20:23]
    ds_read_b128 v[100:103], v218 offset:37888
    v_mfma_f32_16x16x32_bf16 v[56:59], v[172:175], v[152:155], v[56:59]
    ds_read_b128 v[104:107], v218 offset:38912
    v_mfma_f32_16x16x32_bf16 v[24:27], v[168:171], v[156:159], v[24:27]
    ds_read_b128 v[108:111], v219 offset:36864
    v_mfma_f32_16x16x32_bf16 v[60:63], v[172:175], v[156:159], v[60:63]
    ds_read_b128 v[112:115], v219 offset:37888
    v_mfma_f32_16x16x32_bf16 v[28:31], v[168:171], v[160:163], v[28:31]
    ds_read_b128 v[116:119], v219 offset:38912
    v_mfma_f32_16x16x32_bf16 v[64:67], v[172:175], v[160:163], v[64:67]
    v_mfma_f32_16x16x32_bf16 v[32:35], v[168:171], v[164:167], v[32:35]
    v_mfma_f32_16x16x32_bf16 v[68:71], v[172:175], v[164:167], v[68:71]
    v_mfma_f32_16x16x32_bf16 v[72:75], v[176:179], v[132:135], v[72:75]
    v_mfma_f32_16x16x32_bf16 v[76:79], v[176:179], v[136:139], v[76:79]
    v_mfma_f32_16x16x32_bf16 v[80:83], v[176:179], v[140:143], v[80:83]
    s_waitcnt lgkmcnt(0)
    s_barrier
    v_mfma_f32_16x16x32_bf16 v[0:3], v[120:123], v[84:87], v[0:3]
    ds_read_b64_tr_b16 v[168:169], v220 offset:55296
    v_mfma_f32_16x16x32_bf16 v[36:39], v[124:127], v[84:87], v[36:39]
    ds_read_b64_tr_b16 v[170:171], v220 offset:59392
    v_mfma_f32_16x16x32_bf16 v[4:7], v[120:123], v[88:91], v[4:7]
    ds_read_b64_tr_b16 v[172:173], v221 offset:55296
    v_mfma_f32_16x16x32_bf16 v[40:43], v[124:127], v[88:91], v[40:43]
    ds_read_b64_tr_b16 v[174:175], v221 offset:59392
    v_mfma_f32_16x16x32_bf16 v[8:11], v[120:123], v[92:95], v[8:11]
    ds_read_b64_tr_b16 v[176:177], v223 offset:55296
    v_mfma_f32_16x16x32_bf16 v[44:47], v[124:127], v[92:95], v[44:47]
    ds_read_b64_tr_b16 v[178:179], v223 offset:55808
    v_mfma_f32_16x16x32_bf16 v[12:15], v[120:123], v[96:99], v[12:15]
    ds_read_b128 v[132:135], v217 offset:55296
    v_mfma_f32_16x16x32_bf16 v[48:51], v[124:127], v[96:99], v[48:51]
    ds_read_b128 v[136:139], v217 offset:56320
    v_mfma_f32_16x16x32_bf16 v[16:19], v[120:123], v[100:103], v[16:19]
    ds_read_b128 v[140:143], v217 offset:57344
    v_mfma_f32_16x16x32_bf16 v[52:55], v[124:127], v[100:103], v[52:55]
    ds_read_b128 v[144:147], v218 offset:55296
    v_mfma_f32_16x16x32_bf16 v[20:23], v[120:123], v[104:107], v[20:23]
    ds_read_b128 v[148:151], v218 offset:56320
    v_mfma_f32_16x16x32_bf16 v[56:59], v[124:127], v[104:107], v[56:59]
    ds_read_b128 v[152:155], v218 offset:57344
    v_mfma_f32_16x16x32_bf16 v[24:27], v[120:123], v[108:111], v[24:27]
    ds_read_b128 v[156:159], v219 offset:55296
    v_mfma_f32_16x16x32_bf16 v[60:63], v[124:127], v[108:111], v[60:63]
    ds_read_b128 v[160:163], v219 offset:56320
    v_mfma_f32_16x16x32_bf16 v[28:31], v[120:123], v[112:115], v[28:31]
    ds_read_b128 v[164:167], v219 offset:57344
    v_mfma_f32_16x16x32_bf16 v[64:67], v[124:127], v[112:115], v[64:67]
    v_mfma_f32_16x16x32_bf16 v[32:35], v[120:123], v[116:119], v[32:35]
    v_mfma_f32_16x16x32_bf16 v[68:71], v[124:127], v[116:119], v[68:71]
    v_mfma_f32_16x16x32_bf16 v[72:75], v[128:131], v[84:87], v[72:75]
    v_mfma_f32_16x16x32_bf16 v[76:79], v[128:131], v[88:91], v[76:79]
    v_mfma_f32_16x16x32_bf16 v[80:83], v[128:131], v[92:95], v[80:83]
    s_waitcnt lgkmcnt(0)
    s_barrier
    v_mfma_f32_16x16x32_bf16 v[0:3], v[168:171], v[132:135], v[0:3]
    v_mfma_f32_16x16x32_bf16 v[36:39], v[172:175], v[132:135], v[36:39]
    v_mfma_f32_16x16x32_bf16 v[4:7], v[168:171], v[136:139], v[4:7]
    v_mfma_f32_16x16x32_bf16 v[40:43], v[172:175], v[136:139], v[40:43]
    v_mfma_f32_16x16x32_bf16 v[8:11], v[168:171], v[140:143], v[8:11]
    v_mfma_f32_16x16x32_bf16 v[44:47], v[172:175], v[140:143], v[44:47]
    v_mfma_f32_16x16x32_bf16 v[12:15], v[168:171], v[144:147], v[12:15]
    v_mfma_f32_16x16x32_bf16 v[48:51], v[172:175], v[144:147], v[48:51]
    v_mfma_f32_16x16x32_bf16 v[16:19], v[168:171], v[148:151], v[16:19]
    v_mfma_f32_16x16x32_bf16 v[52:55], v[172:175], v[148:151], v[52:55]
    v_mfma_f32_16x16x32_bf16 v[20:23], v[168:171], v[152:155], v[20:23]
    v_mfma_f32_16x16x32_bf16 v[56:59], v[172:175], v[152:155], v[56:59]
    v_mfma_f32_16x16x32_bf16 v[24:27], v[168:171], v[156:159], v[24:27]
    v_mfma_f32_16x16x32_bf16 v[60:63], v[172:175], v[156:159], v[60:63]
    v_mfma_f32_16x16x32_bf16 v[28:31], v[168:171], v[160:163], v[28:31]
    v_mfma_f32_16x16x32_bf16 v[64:67], v[172:175], v[160:163], v[64:67]
    v_mfma_f32_16x16x32_bf16 v[32:35], v[168:171], v[164:167], v[32:35]
    v_mfma_f32_16x16x32_bf16 v[68:71], v[172:175], v[164:167], v[68:71]
    v_mfma_f32_16x16x32_bf16 v[72:75], v[176:179], v[132:135], v[72:75]
    v_mfma_f32_16x16x32_bf16 v[76:79], v[176:179], v[136:139], v[76:79]
    v_mfma_f32_16x16x32_bf16 v[80:83], v[176:179], v[140:143], v[80:83]
    s_waitcnt lgkmcnt(0)
    s_nop 7

    s_lshl_b32 s47, s4, 2
    s_add_u32 s47, s47, s5
    s_lshl_b32 s47, s47, 2
    s_add_u32 s47, s47, s6
    s_mul_i32 s53, s47, 41472
    v_lshlrev_b32 v232, 4, v216
    v_lshlrev_b32 v233, 3, v216
    s_cmp_eq_u32 s46, 3
    s_cselect_b32 s61, 0, s46

    s_add_u32 s49, s61, 0
    s_cmp_ge_u32 s49, 3
    s_cselect_b32 s50, 3, 0
    s_sub_u32 s49, s49, s50
    s_mul_i32 s49, s49, 3072
    s_mul_i32 s50, s46, 9216
    s_add_u32 s49, s49, s50
    s_add_u32 s49, s49, s53

    v_cvt_pk_bf16_f32 v84, v0, v1
    v_cvt_pk_bf16_f32 v85, v2, v3
    v_cvt_pk_bf16_f32 v86, v36, v37
    v_cvt_pk_bf16_f32 v87, v38, v39
    buffer_store_dwordx4 v[84:87], v232, s[32:35], s49 offen offset:0 sc1
    v_cvt_pk_bf16_f32 v88, v4, v5
    v_cvt_pk_bf16_f32 v89, v6, v7
    v_cvt_pk_bf16_f32 v90, v40, v41
    v_cvt_pk_bf16_f32 v91, v42, v43
    buffer_store_dwordx4 v[88:91], v232, s[32:35], s49 offen offset:1024 sc1
    v_cvt_pk_bf16_f32 v92, v8, v9
    v_cvt_pk_bf16_f32 v93, v10, v11
    v_cvt_pk_bf16_f32 v94, v44, v45
    v_cvt_pk_bf16_f32 v95, v46, v47
    buffer_store_dwordx4 v[92:95], v232, s[32:35], s49 offen offset:2048 sc1

    s_add_u32 s49, s61, 1
    s_cmp_ge_u32 s49, 3
    s_cselect_b32 s50, 3, 0
    s_sub_u32 s49, s49, s50
    s_mul_i32 s49, s49, 3072
    s_mul_i32 s50, s46, 9216
    s_add_u32 s49, s49, s50
    s_add_u32 s49, s49, s53

    v_cvt_pk_bf16_f32 v96, v12, v13
    v_cvt_pk_bf16_f32 v97, v14, v15
    v_cvt_pk_bf16_f32 v98, v48, v49
    v_cvt_pk_bf16_f32 v99, v50, v51
    buffer_store_dwordx4 v[96:99], v232, s[32:35], s49 offen offset:0 sc1
    v_cvt_pk_bf16_f32 v100, v16, v17
    v_cvt_pk_bf16_f32 v101, v18, v19
    v_cvt_pk_bf16_f32 v102, v52, v53
    v_cvt_pk_bf16_f32 v103, v54, v55
    buffer_store_dwordx4 v[100:103], v232, s[32:35], s49 offen offset:1024 sc1
    v_cvt_pk_bf16_f32 v104, v20, v21
    v_cvt_pk_bf16_f32 v105, v22, v23
    v_cvt_pk_bf16_f32 v106, v56, v57
    v_cvt_pk_bf16_f32 v107, v58, v59
    buffer_store_dwordx4 v[104:107], v232, s[32:35], s49 offen offset:2048 sc1

    s_add_u32 s49, s61, 2
    s_cmp_ge_u32 s49, 3
    s_cselect_b32 s50, 3, 0
    s_sub_u32 s49, s49, s50
    s_mul_i32 s49, s49, 3072
    s_mul_i32 s50, s46, 9216
    s_add_u32 s49, s49, s50
    s_add_u32 s49, s49, s53

    v_cvt_pk_bf16_f32 v108, v24, v25
    v_cvt_pk_bf16_f32 v109, v26, v27
    v_cvt_pk_bf16_f32 v110, v60, v61
    v_cvt_pk_bf16_f32 v111, v62, v63
    buffer_store_dwordx4 v[108:111], v232, s[32:35], s49 offen offset:0 sc1
    v_cvt_pk_bf16_f32 v112, v28, v29
    v_cvt_pk_bf16_f32 v113, v30, v31
    v_cvt_pk_bf16_f32 v114, v64, v65
    v_cvt_pk_bf16_f32 v115, v66, v67
    buffer_store_dwordx4 v[112:115], v232, s[32:35], s49 offen offset:1024 sc1
    v_cvt_pk_bf16_f32 v116, v32, v33
    v_cvt_pk_bf16_f32 v117, v34, v35
    v_cvt_pk_bf16_f32 v118, v68, v69
    v_cvt_pk_bf16_f32 v119, v70, v71
    buffer_store_dwordx4 v[116:119], v232, s[32:35], s49 offen offset:2048 sc1

    s_cmp_eq_u32 s46, 3
    s_cbranch_scc1 L_p_skipx_43
    s_mul_i32 s49, s61, 1536
    s_add_u32 s49, s49, 36864
    s_add_u32 s49, s49, s53

    v_cvt_pk_bf16_f32 v120, v72, v73
    v_cvt_pk_bf16_f32 v121, v74, v75
    buffer_store_dwordx2 v[120:121], v233, s[32:35], s49 offen offset:0 sc1
    v_cvt_pk_bf16_f32 v122, v76, v77
    v_cvt_pk_bf16_f32 v123, v78, v79
    buffer_store_dwordx2 v[122:123], v233, s[32:35], s49 offen offset:512 sc1
    v_cvt_pk_bf16_f32 v124, v80, v81
    v_cvt_pk_bf16_f32 v125, v82, v83
    buffer_store_dwordx2 v[124:125], v233, s[32:35], s49 offen offset:1024 sc1
L_p_skipx_43:
    s_waitcnt vmcnt(0)
    s_barrier

    s_cmp_lg_u32 s46, 0
    s_cbranch_scc1 L_fw_44
    s_lshl_b32 s47, s2, 9
    s_add_u32 s47, s47, 50331904
    v_mov_b32 v232, s44
    v_mov_b32 v233, s45
    v_mov_b32 v234, s47
    s_mov_b64 exec, 1
    global_store_dwordx2 v234, v[232:233], s[40:41] sc1
    s_mov_b64 exec, -1

L_fw_44:

    s_andn2_b32 s47, s2, 6
    v_and_b32 v234, 3, v216
    v_lshlrev_b32 v234, 1, v234
    v_add_u32 v234, s47, v234
    v_lshlrev_b32 v234, 9, v234
    v_add_u32 v234, 50331904, v234
    s_mov_b32 s57, 100000

L_poll_45:

    global_load_dwordx2 v[232:233], v234, s[40:41] sc1
    s_waitcnt vmcnt(0)
    v_cmp_ne_u32 vcc, s44, v232
    v_cmp_ne_u32 s[68:69], s45, v233
    s_sub_u32 s57, s57, 1
    s_cmp_eq_u32 s57, 0
    s_cbranch_scc1 L_polld_46
    s_or_b64 vcc, vcc, s[68:69]
    s_cmp_lg_u64 vcc, 0
    s_cbranch_scc0 L_polld_46
    s_sleep 1
    s_branch L_poll_45

L_polld_46:

    s_lshl_b32 s47, s4, 2
    s_add_u32 s47, s47, s5
    s_mul_i32 s53, s47, 165888
    s_lshl_b32 s61, s6, 3
    s_add_u32 s61, s61, s3
    v_lshlrev_b32 v232, 4, v216
    v_lshlrev_b32 v233, 3, v216
    v_and_b32 v234, 15, v216
    v_mul_u32_u24 v234, 1152, v234
    v_lshrrev_b32 v235, 4, v216
    v_lshl_add_u32 v234, v235, 3, v234
    s_mul_i32 s54, s4, 165888
    s_mul_i32 s47, s5, 288
    s_add_u32 s54, s54, s47

    s_lshl_b32 s48, s61, 10
    s_add_u32 s48, s48, s53
    buffer_load_dwordx4 v[0:3], v232, s[32:35], s48 offen sc1
    s_add_u32 s48, s48, 41472
    buffer_load_dwordx4 v[4:7], v232, s[32:35], s48 offen sc1
    s_add_u32 s48, s48, 41472
    buffer_load_dwordx4 v[8:11], v232, s[32:35], s48 offen sc1
    s_add_u32 s48, s48, 41472
    buffer_load_dwordx4 v[12:15], v232, s[32:35], s48 offen sc1

    s_add_u32 s65, s61, 32
    s_cmp_ge_u32 s65, 45
    s_cbranch_scc1 L_fr_w_49
    s_cmp_ge_u32 s65, 36
    s_cbranch_scc1 L_fr_h_47
    s_lshl_b32 s48, s65, 10
    s_add_u32 s48, s48, s53

    buffer_load_dwordx4 v[16:19], v232, s[32:35], s48 offen sc1
    s_add_u32 s48, s48, 41472
    buffer_load_dwordx4 v[20:23], v232, s[32:35], s48 offen sc1
    s_add_u32 s48, s48, 41472
    buffer_load_dwordx4 v[24:27], v232, s[32:35], s48 offen sc1
    s_add_u32 s48, s48, 41472
    buffer_load_dwordx4 v[28:31], v232, s[32:35], s48 offen sc1
    s_branch L_fr_w_49
L_fr_h_47:

    s_sub_u32 s48, s65, 36
    s_lshl_b32 s48, s48, 9
    s_add_u32 s48, s48, 36864
    s_add_u32 s48, s48, s53

    buffer_load_dwordx2 v[16:17], v233, s[32:35], s48 offen sc1
    s_add_u32 s48, s48, 41472
    buffer_load_dwordx2 v[20:21], v233, s[32:35], s48 offen sc1
    s_add_u32 s48, s48, 41472
    buffer_load_dwordx2 v[24:25], v233, s[32:35], s48 offen sc1
    s_add_u32 s48, s48, 41472
    buffer_load_dwordx2 v[28:29], v233, s[32:35], s48 offen sc1
L_fr_w_49:
    s_waitcnt vmcnt(0)
    v_lshlrev_b32 v40, 16, v0
    v_and_b32 v44, 0xffff0000, v0
    v_lshlrev_b32 v41, 16, v4
    v_and_b32 v45, 0xffff0000, v4
    v_lshlrev_b32 v42, 16, v8
    v_and_b32 v46, 0xffff0000, v8
    v_lshlrev_b32 v43, 16, v12
    v_and_b32 v47, 0xffff0000, v12
    v_add_f32 v40, v40, v41
    v_add_f32 v42, v42, v43
    v_add_f32 v44, v44, v45
    v_add_f32 v46, v46, v47
    v_add_f32 v40, v40, v42
    v_add_f32 v44, v44, v46
    v_cvt_pk_bf16_f32 v48, v40, v44
    v_lshlrev_b32 v40, 16, v1
    v_and_b32 v44, 0xffff0000, v1
    v_lshlrev_b32 v41, 16, v5
    v_and_b32 v45, 0xffff0000, v5
    v_lshlrev_b32 v42, 16, v9
    v_and_b32 v46, 0xffff0000, v9
    v_lshlrev_b32 v43, 16, v13
    v_and_b32 v47, 0xffff0000, v13
    v_add_f32 v40, v40, v41
    v_add_f32 v42, v42, v43
    v_add_f32 v44, v44, v45
    v_add_f32 v46, v46, v47
    v_add_f32 v40, v40, v42
    v_add_f32 v44, v44, v46
    v_cvt_pk_bf16_f32 v49, v40, v44
    v_lshlrev_b32 v40, 16, v2
    v_and_b32 v44, 0xffff0000, v2
    v_lshlrev_b32 v41, 16, v6
    v_and_b32 v45, 0xffff0000, v6
    v_lshlrev_b32 v42, 16, v10
    v_and_b32 v46, 0xffff0000, v10
    v_lshlrev_b32 v43, 16, v14
    v_and_b32 v47, 0xffff0000, v14
    v_add_f32 v40, v40, v41
    v_add_f32 v42, v42, v43
    v_add_f32 v44, v44, v45
    v_add_f32 v46, v46, v47
    v_add_f32 v40, v40, v42
    v_add_f32 v44, v44, v46
    v_cvt_pk_bf16_f32 v50, v40, v44
    v_lshlrev_b32 v40, 16, v3
    v_and_b32 v44, 0xffff0000, v3
    v_lshlrev_b32 v41, 16, v7
    v_and_b32 v45, 0xffff0000, v7
    v_lshlrev_b32 v42, 16, v11
    v_and_b32 v46, 0xffff0000, v11
    v_lshlrev_b32 v43, 16, v15
    v_and_b32 v47, 0xffff0000, v15
    v_add_f32 v40, v40, v41
    v_add_f32 v42, v42, v43
    v_add_f32 v44, v44, v45
    v_add_f32 v46, v46, v47
    v_add_f32 v40, v40, v42
    v_add_f32 v44, v44, v46
    v_cvt_pk_bf16_f32 v51, v40, v44

    s_mul_i32 s48, s61, 57
    s_lshr_b32 s48, s48, 9
    s_mul_i32 s49, s48, 9
    s_sub_u32 s49, s61, s49
    s_mul_i32 s49, s49, 18432
    s_lshl_b32 s48, s48, 6
    s_add_u32 s49, s49, s48
    s_add_u32 s49, s49, s54

    buffer_store_dwordx2 v[48:49], v234, s[36:39], s49 offen
    buffer_store_dwordx2 v[50:51], v234, s[36:39], s49 offen offset:32

    s_cmp_ge_u32 s65, 45
    s_cbranch_scc1 L_fr_e_50
    s_cmp_ge_u32 s65, 36
    s_cbranch_scc1 L_fr_h2_51
    s_nop 1

    v_lshlrev_b32 v40, 16, v16
    v_and_b32 v44, 0xffff0000, v16
    v_lshlrev_b32 v41, 16, v20
    v_and_b32 v45, 0xffff0000, v20
    v_lshlrev_b32 v42, 16, v24
    v_and_b32 v46, 0xffff0000, v24
    v_lshlrev_b32 v43, 16, v28
    v_and_b32 v47, 0xffff0000, v28
    v_add_f32 v40, v40, v41
    v_add_f32 v42, v42, v43
    v_add_f32 v44, v44, v45
    v_add_f32 v46, v46, v47
    v_add_f32 v40, v40, v42
    v_add_f32 v44, v44, v46
    v_cvt_pk_bf16_f32 v48, v40, v44
    v_lshlrev_b32 v40, 16, v17
    v_and_b32 v44, 0xffff0000, v17
    v_lshlrev_b32 v41, 16, v21
    v_and_b32 v45, 0xffff0000, v21
    v_lshlrev_b32 v42, 16, v25
    v_and_b32 v46, 0xffff0000, v25
    v_lshlrev_b32 v43, 16, v29
    v_and_b32 v47, 0xffff0000, v29
    v_add_f32 v40, v40, v41
    v_add_f32 v42, v42, v43
    v_add_f32 v44, v44, v45
    v_add_f32 v46, v46, v47
    v_add_f32 v40, v40, v42
    v_add_f32 v44, v44, v46
    v_cvt_pk_bf16_f32 v49, v40, v44
    v_lshlrev_b32 v40, 16, v18
    v_and_b32 v44, 0xffff0000, v18
    v_lshlrev_b32 v41, 16, v22
    v_and_b32 v45, 0xffff0000, v22
    v_lshlrev_b32 v42, 16, v26
    v_and_b32 v46, 0xffff0000, v26
    v_lshlrev_b32 v43, 16, v30
    v_and_b32 v47, 0xffff0000, v30
    v_add_f32 v40, v40, v41
    v_add_f32 v42, v42, v43
    v_add_f32 v44, v44, v45
    v_add_f32 v46, v46, v47
    v_add_f32 v40, v40, v42
    v_add_f32 v44, v44, v46
    v_cvt_pk_bf16_f32 v50, v40, v44
    v_lshlrev_b32 v40, 16, v19
    v_and_b32 v44, 0xffff0000, v19
    v_lshlrev_b32 v41, 16, v23
    v_and_b32 v45, 0xffff0000, v23
    v_lshlrev_b32 v42, 16, v27
    v_and_b32 v46, 0xffff0000, v27
    v_lshlrev_b32 v43, 16, v31
    v_and_b32 v47, 0xffff0000, v31
    v_add_f32 v40, v40, v41
    v_add_f32 v42, v42, v43
    v_add_f32 v44, v44, v45
    v_add_f32 v46, v46, v47
    v_add_f32 v40, v40, v42
    v_add_f32 v44, v44, v46
    v_cvt_pk_bf16_f32 v51, v40, v44

    s_mul_i32 s48, s65, 57
    s_lshr_b32 s48, s48, 9
    s_mul_i32 s49, s48, 9
    s_sub_u32 s49, s65, s49
    s_mul_i32 s49, s49, 18432
    s_lshl_b32 s48, s48, 6
    s_add_u32 s49, s49, s48
    s_add_u32 s49, s49, s54

    buffer_store_dwordx2 v[48:49], v234, s[36:39], s49 offen
    buffer_store_dwordx2 v[50:51], v234, s[36:39], s49 offen offset:32
    s_branch L_fr_e_50
L_fr_h2_51:
    s_nop 1
    v_lshlrev_b32 v40, 16, v16
    v_and_b32 v44, 0xffff0000, v16
    v_lshlrev_b32 v41, 16, v20
    v_and_b32 v45, 0xffff0000, v20
    v_lshlrev_b32 v42, 16, v24
    v_and_b32 v46, 0xffff0000, v24
    v_lshlrev_b32 v43, 16, v28
    v_and_b32 v47, 0xffff0000, v28
    v_add_f32 v40, v40, v41
    v_add_f32 v42, v42, v43
    v_add_f32 v44, v44, v45
    v_add_f32 v46, v46, v47
    v_add_f32 v40, v40, v42
    v_add_f32 v44, v44, v46
    v_cvt_pk_bf16_f32 v48, v40, v44
    v_lshlrev_b32 v40, 16, v17
    v_and_b32 v44, 0xffff0000, v17
    v_lshlrev_b32 v41, 16, v21
    v_and_b32 v45, 0xffff0000, v21
    v_lshlrev_b32 v42, 16, v25
    v_and_b32 v46, 0xffff0000, v25
    v_lshlrev_b32 v43, 16, v29
    v_and_b32 v47, 0xffff0000, v29
    v_add_f32 v40, v40, v41
    v_add_f32 v42, v42, v43
    v_add_f32 v44, v44, v45
    v_add_f32 v46, v46, v47
    v_add_f32 v40, v40, v42
    v_add_f32 v44, v44, v46
    v_cvt_pk_bf16_f32 v49, v40, v44

    s_sub_u32 s49, s65, 36
    s_mul_i32 s49, s49, 18432
    s_add_u32 s49, s49, 256
    s_add_u32 s49, s49, s54
    buffer_store_dwordx2 v[48:49], v234, s[36:39], s49 offen

L_fr_e_50:
    s_waitcnt vmcnt(0)
    s_waitcnt vmcnt(0)
    s_endpgm
L_p_safe0:
    s_barrier
    s_mov_b32 s57, 32
L_p_safe0_loop:
    s_barrier
    s_sub_u32 s57, s57, 1
    s_cmp_lg_u32 s57, 0
    s_cbranch_scc1 L_p_safe0_loop
    s_branch L_p_back0
L_p_safe1:
    s_barrier
    s_mov_b32 s57, 32
L_p_safe1_loop:
    s_barrier
    s_sub_u32 s57, s57, 1
    s_cmp_lg_u32 s57, 0
    s_cbranch_scc1 L_p_safe1_loop
    s_branch L_p_back1
L_end:
    s_endpgm

.section .rodata,"a"
.p2align 6
.amdhsa_kernel standalone__mha_block_cached__near_ridge_kernel
  .amdhsa_next_free_vgpr 256
  .amdhsa_next_free_sgpr 102
  .amdhsa_accum_offset 256
  .amdhsa_group_segment_fixed_size 0
  .amdhsa_kernarg_size 64
  .amdhsa_user_sgpr_count 2
  .amdhsa_user_sgpr_kernarg_segment_ptr 1
  .amdhsa_system_sgpr_workgroup_id_x 1
.end_amdhsa_kernel
```
